```python
import torch

def _softmax(x, axis=-1):
    return torch.softmax(x, dim=axis)

def _gelu(x):
    return torch.nn.functional.gelu(x, approximate='tanh')

def _silu(x):
    return torch.nn.functional.silu(x)

def _sigmoid(x):
    return torch.sigmoid(x)

def _layernorm(x, axis=-1, eps=1e-05):
    m = x.mean(dim=axis, keepdim=True)
    v = x.var(dim=axis, keepdim=True, unbiased=False)
    return (x - m) / torch.sqrt(v + eps)

def _scatter_add(tgt, idx, src, axis=0):
    return tgt.clone().index_add_(axis, idx, src)

def _segment_sum(src, seg, n):
    out = torch.zeros((n,) + src.shape[1:], dtype=src.dtype)
    return out.index_add_(0, seg, src)

def _pad(x, pw):
    flat = tuple((v for pair in reversed(pw) for v in pair))
    return torch.nn.functional.pad(x, flat)
kernel_name = 'gated_mix__memory_aug_recurrent_mem_tr__swiglu_ffn__prompt'

def setup_inputs():

    _w = lambda a: (lambda t: t.to(torch.bfloat16) if t.is_floating_point() else t)(torch.as_tensor(a))

    def _A_setup():
        B, S, Dm = (1, 2048, 512)
        H, Dh = (32, 128)
        M, seg = (8, 32)
        seg = min(seg, S)
        S = S // seg * seg
        return {'x': _w((lambda *s: torch.randn(*s, dtype=torch.bfloat16) * 0.05)(B, S, Dm)), 'mem0': _w((lambda *s: torch.randn(*s, dtype=torch.bfloat16) * 0.4)(B, M, Dm)), 'Wq': _w((lambda *s: torch.randn(*s, dtype=torch.bfloat16) * 6.4)(Dm, H, Dh) * Dm ** (-0.5)), 'Wk': _w((lambda *s: torch.randn(*s, dtype=torch.bfloat16) * 6.4)(Dm, H, Dh) * Dm ** (-0.5)), 'Wv': _w((lambda *s: torch.randn(*s, dtype=torch.bfloat16) * 0.4)(Dm, H, Dh) * Dm ** (-0.5)), 'Wo': _w((lambda *s: torch.randn(*s, dtype=torch.bfloat16) * 0.4)(H, Dh, Dm) * (H * Dh) ** (-0.5)), 'seg_len': seg}
    _A_in = _A_setup()

    def _B_setup():
        B, S, D, F = (1, 2048, 512, 1376)
        return {'x': _w((lambda *s: torch.randn(*s, dtype=torch.bfloat16) * 0.05)(B, S, D)), 'w_gate': _w((lambda *s: torch.randn(*s, dtype=torch.bfloat16) * 0.05)(D, F)), 'w_up': _w((lambda *s: torch.randn(*s, dtype=torch.bfloat16) * 0.05)(D, F)), 'w_down': _w((lambda *s: torch.randn(*s, dtype=torch.bfloat16) * 0.05)(F, D))}
    _B_in = _B_setup()
    return {'A_x': _A_in['x'], 'A_mem0': _A_in['mem0'], 'A_Wq': _A_in['Wq'], 'A_Wk': _A_in['Wk'], 'A_Wv': _A_in['Wv'], 'A_Wo': _A_in['Wo'], 'A_seg_len': _A_in['seg_len'], 'B_x': _B_in['x'], 'B_w_gate': _B_in['w_gate'], 'B_w_up': _B_in['w_up'], 'B_w_down': _B_in['w_down'], 'gate_w': _w((lambda *s: torch.randn(*s, dtype=torch.bfloat16) * 0.05)(512) * 16.0)}

def reference(A_x, A_mem0, A_Wq, A_Wk, A_Wv, A_Wo, A_seg_len, B_x, B_w_gate, B_w_up, B_w_down, gate_w):

    def _A_ref(x, mem0, Wq, Wk, Wv, Wo, seg_len):
        B, S, Dm = x.shape
        H, Dh = (Wq.shape[1], Wq.shape[2])
        M = mem0.shape[1]
        scale = Dh ** (-0.5)
        n_seg = S // seg_len
        L = M + seg_len
        idx = torch.arange(L)
        mask = (idx[:, None] < M) | (idx[:, None] >= idx[None, :])
        mem = mem0
        outs = []
        for s in range(n_seg):
            xs = x[:, s * seg_len:(s + 1) * seg_len, :].clone()
            h = torch.concatenate([mem, xs], axis=1)
            q = torch.einsum('btd,dhe->bhte', h, Wq)
            k = torch.einsum('btd,dhe->bhte', h, Wk)
            v = torch.einsum('btd,dhe->bhte', h, Wv)
            scores = torch.einsum('bhqe,bhke->bhqk', q, k) * scale
            scores = torch.where(mask[None, None], scores, -1000000000.0)
            p = _softmax(scores, axis=-1)
            o = torch.einsum('bhqk,bhke->bhqe', p, v)
            o = torch.einsum('bhte,hed->btd', o, Wo)
            mem = o[:, :M, :].clone()
            outs.append(o[:, M:, :])
        return torch.concatenate(outs, axis=1)

    def _B_ref(x, w_gate, w_up, w_down):
        g = _silu(x @ w_gate)
        u = x @ w_up
        return g * u @ w_down
    x = A_x
    g = _sigmoid((x * gate_w).sum(-1, keepdims=True))
    a = _A_ref(x, A_mem0, A_Wq, A_Wk, A_Wv, A_Wo, A_seg_len)
    b = _B_ref(x, B_w_gate, B_w_up, B_w_down)
    return g * a + (1 - g) * b
```

```asm
; @launch grid=(256,1,1) block=(256,1,1) lds=163840
.amdgcn_target "amdgcn-amd-amdhsa--gfx950"
.text
.globl gated_mix__memory_aug_recurrent_mem_tr__swiglu_ffn__prompt_kernel
.p2align 8
.type gated_mix__memory_aug_recurrent_mem_tr__swiglu_ffn__prompt_kernel,@function
gated_mix__memory_aug_recurrent_mem_tr__swiglu_ffn__prompt_kernel:
    s_cmp_ge_u32 s2, 256
    s_cbranch_scc1 L_exit
    s_load_dwordx2 s[8:9], s[0:1], 112
    s_mov_b32 s10, 0x10000000
    s_mov_b32 s11, 0x20000
    s_load_dwordx2 s[12:13], s[0:1], 104
    s_mov_b32 s14, 0x100
    s_mov_b32 s15, 0x20000
    s_load_dwordx2 s[16:17], s[0:1], 16
    s_mov_b32 s18, 0x400000
    s_mov_b32 s19, 0x20000
    s_getreg_b32 s3, hwreg(HW_REG_XCC_ID, 0, 3)
    s_xor_b32 s3, s3, 3
    v_lshrrev_b32 v1, 6, v0
    s_nop 0
    v_readfirstlane_b32 s4, v1
    s_lshl_b32 s6, s3, 2
    s_add_u32 s6, s6, 128
    s_cmp_eq_u32 s3, 0
    s_cselect_b32 s6, 0, s6
    v_mov_b32 v2, s6
    v_mov_b32 v3, 1
    v_mov_b32 v4, 163584
    v_mov_b64 v[8:9], 0
    v_mov_b64 v[10:11], 0
    v_lshlrev_b32 v5, 4, v0
    s_lshl_b32 s7, s2, 6
    s_waitcnt lgkmcnt(0)
    s_mov_b32 s99, s4
    s_cmp_lg_u32 s4, 0
    s_cbranch_scc1 L_hint
    s_mov_b64 exec, 1
    buffer_atomic_add v3, v2, s[12:15], 0 offen sc0
    s_mov_b64 exec, 15
    buffer_store_dwordx4 v[8:11], v5, s[8:11], s7 offen sc1
    s_mov_b64 exec, 1
    s_barrier
    s_waitcnt vmcnt(0)
    ds_write_b32 v4, v3
    s_waitcnt lgkmcnt(0)
    s_mov_b64 exec, -1
    s_branch L_tk
L_hint:
    v_and_b32 v12, 63, v0
    v_lshlrev_b32 v12, 7, v12
    s_lshr_b32 s40, s2, 3
    s_barrier
    s_cmp_lg_u32 s3, 0
    s_cbranch_scc1 L_h1
    s_cmp_lg_u32 s4, 1
    s_cbranch_scc1 L_h2
    s_and_b32 s41, s40, 7
    s_lshl_b32 s41, s41, 23
    v_lshlrev_b32 v13, 13, v12
    s_mov_b64 exec, 0xff
    buffer_load_dword v250, v13, s[8:11], s41 offen sc1
    s_mov_b64 exec, -1
    s_branch L_h2
L_h1:
    s_lshl_b32 s41, s2, 14
    s_add_u32 s42, s41, 0x2000
    s_cmp_eq_u32 s4, 1
    s_cbranch_scc1 L_m1
    s_branch L_h2
L_m1:
    buffer_load_dword v250, v12, s[16:19], s41 offen
    buffer_load_dword v250, v12, s[16:19], s42 offen
L_h2:
L_tk:
    s_barrier
    ds_read_b32 v3, v4
    s_waitcnt lgkmcnt(0)
    v_readfirstlane_b32 s5, v3
    s_nop 0
    s_cmp_ge_u32 s5, 32
    s_cbranch_scc1 L_over
L_role:
    s_cmp_lg_u32 s3, 0
    s_cbranch_scc1 L_worker
    s_load_dwordx2 s[16:17], s[0:1], 16
    s_mov_b32 s18, 0x400000
    s_mov_b32 s19, 0x20000
    s_load_dwordx2 s[20:21], s[0:1], 24
    s_mov_b32 s22, 0x400000
    s_mov_b32 s23, 0x20000
    s_load_dwordx2 s[24:25], s[0:1], 32
    s_mov_b32 s26, 0x400000
    s_mov_b32 s27, 0x20000
    s_load_dwordx2 s[28:29], s[0:1], 40
    s_mov_b32 s30, 0x400000
    s_mov_b32 s31, 0x20000
    v_and_b32 v100, 63, v0
    v_bfe_u32 v103, v100, 4, 1
    v_lshlrev_b32 v106, 4, v103
    v_bfe_u32 v103, v100, 3, 1
    v_lshl_add_u32 v106, v103, 2, v106
    v_lshrrev_b32 v103, 5, v100
    v_add_u32 v106, v106, v103
    v_and_b32 v104, 7, v100
    v_lshlrev_b32 v104, 4, v104
    v_and_b32 v103, 8, v100
    v_lshlrev_b32 v103, 3, v103
    v_xor_b32 v104, v104, v103
    s_lshr_b32 s52, s4, 1
    s_lshl_b32 s50, s5, 8
    s_lshl_b32 s51, s52, 7
    s_add_u32 s50, s50, s51
    v_lshl_add_u32 v105, v106, 13, v104
    v_add_u32 v105, s50, v105
    s_lshl_b32 s58, s4, 20
    s_and_b32 s58, s58, 0x100000
    s_lshl_b32 s54, s52, 16
    s_and_b32 s52, s4, 1
    s_lshl_b32 s51, s52, 14
    s_add_u32 s54, s54, s51
    s_waitcnt lgkmcnt(0)
    s_add_u32 m0, s54, 0
    s_xor_b32 s51, s58, 0x0
    buffer_load_dwordx4 v105, s[16:19], s51 offen  lds
    s_add_u32 m0, s54, 1024
    s_xor_b32 s51, s58, 0x10000
    buffer_load_dwordx4 v105, s[16:19], s51 offen  lds
    s_add_u32 m0, s54, 2048
    s_xor_b32 s51, s58, 0x4000
    buffer_load_dwordx4 v105, s[16:19], s51 offen  lds
    s_add_u32 m0, s54, 3072
    s_xor_b32 s51, s58, 0x14000
    buffer_load_dwordx4 v105, s[16:19], s51 offen  lds
    s_add_u32 m0, s54, 4096
    s_xor_b32 s51, s58, 0x40000
    buffer_load_dwordx4 v105, s[16:19], s51 offen  lds
    s_add_u32 m0, s54, 5120
    s_xor_b32 s51, s58, 0x50000
    buffer_load_dwordx4 v105, s[16:19], s51 offen  lds
    s_add_u32 m0, s54, 6144
    s_xor_b32 s51, s58, 0x44000
    buffer_load_dwordx4 v105, s[16:19], s51 offen  lds
    s_add_u32 m0, s54, 7168
    s_xor_b32 s51, s58, 0x54000
    buffer_load_dwordx4 v105, s[16:19], s51 offen  lds
    s_add_u32 m0, s54, 8192
    s_xor_b32 s51, s58, 0x80000
    buffer_load_dwordx4 v105, s[16:19], s51 offen  lds
    s_add_u32 m0, s54, 9216
    s_xor_b32 s51, s58, 0x90000
    buffer_load_dwordx4 v105, s[16:19], s51 offen  lds
    s_add_u32 m0, s54, 10240
    s_xor_b32 s51, s58, 0x84000
    buffer_load_dwordx4 v105, s[16:19], s51 offen  lds
    s_add_u32 m0, s54, 11264
    s_xor_b32 s51, s58, 0x94000
    buffer_load_dwordx4 v105, s[16:19], s51 offen  lds
    s_add_u32 m0, s54, 12288
    s_xor_b32 s51, s58, 0xc0000
    buffer_load_dwordx4 v105, s[16:19], s51 offen  lds
    s_add_u32 m0, s54, 13312
    s_xor_b32 s51, s58, 0xd0000
    buffer_load_dwordx4 v105, s[16:19], s51 offen  lds
    s_add_u32 m0, s54, 14336
    s_xor_b32 s51, s58, 0xc4000
    buffer_load_dwordx4 v105, s[16:19], s51 offen  lds
    s_add_u32 m0, s54, 15360
    s_xor_b32 s51, s58, 0xd4000
    buffer_load_dwordx4 v105, s[16:19], s51 offen  lds
    s_add_u32 m0, s54, 32768
    s_xor_b32 s51, s58, 0x200000
    buffer_load_dwordx4 v105, s[16:19], s51 offen  lds
    s_add_u32 m0, s54, 33792
    s_xor_b32 s51, s58, 0x210000
    buffer_load_dwordx4 v105, s[16:19], s51 offen  lds
    s_add_u32 m0, s54, 34816
    s_xor_b32 s51, s58, 0x204000
    buffer_load_dwordx4 v105, s[16:19], s51 offen  lds
    s_add_u32 m0, s54, 35840
    s_xor_b32 s51, s58, 0x214000
    buffer_load_dwordx4 v105, s[16:19], s51 offen  lds
    s_add_u32 m0, s54, 36864
    s_xor_b32 s51, s58, 0x240000
    buffer_load_dwordx4 v105, s[16:19], s51 offen  lds
    s_add_u32 m0, s54, 37888
    s_xor_b32 s51, s58, 0x250000
    buffer_load_dwordx4 v105, s[16:19], s51 offen  lds
    s_add_u32 m0, s54, 38912
    s_xor_b32 s51, s58, 0x244000
    buffer_load_dwordx4 v105, s[16:19], s51 offen  lds
    s_add_u32 m0, s54, 39936
    s_xor_b32 s51, s58, 0x254000
    buffer_load_dwordx4 v105, s[16:19], s51 offen  lds
    s_add_u32 m0, s54, 40960
    s_xor_b32 s51, s58, 0x280000
    buffer_load_dwordx4 v105, s[16:19], s51 offen  lds
    s_add_u32 m0, s54, 41984
    s_xor_b32 s51, s58, 0x290000
    buffer_load_dwordx4 v105, s[16:19], s51 offen  lds
    s_add_u32 m0, s54, 43008
    s_xor_b32 s51, s58, 0x284000
    buffer_load_dwordx4 v105, s[16:19], s51 offen  lds
    s_add_u32 m0, s54, 44032
    s_xor_b32 s51, s58, 0x294000
    buffer_load_dwordx4 v105, s[16:19], s51 offen  lds
    s_add_u32 m0, s54, 45056
    s_xor_b32 s51, s58, 0x2c0000
    buffer_load_dwordx4 v105, s[16:19], s51 offen  lds
    s_add_u32 m0, s54, 46080
    s_xor_b32 s51, s58, 0x2d0000
    buffer_load_dwordx4 v105, s[16:19], s51 offen  lds
    s_add_u32 m0, s54, 47104
    s_xor_b32 s51, s58, 0x2c4000
    buffer_load_dwordx4 v105, s[16:19], s51 offen  lds
    s_add_u32 m0, s54, 48128
    s_xor_b32 s51, s58, 0x2d4000
    buffer_load_dwordx4 v105, s[16:19], s51 offen  lds
    v_and_b32 v101, 15, v100
    v_lshrrev_b32 v102, 4, v100
    v_lshlrev_b32 v0, 4, v100
    s_mov_b32 s37, 0x05040100
    s_mov_b32 s38, 0x07060302
    s_lshl_b32 s59, s5, 17
    s_lshl_b32 s50, s4, 15
    s_add_u32 s59, s59, s50
    s_add_u32 s59, s59, 0x200000
    v_add_u32 v11, s54, v0
    v_lshlrev_b32 v107, 7, v102
    v_lshl_add_u32 v107, v101, 2, v107
    s_lshl_b32 s51, s52, 6
    s_add_u32 s51, s51, s54
    s_and_b32 s51, s51, 0xffffbfff
    v_add_u32 v107, s51, v107
    v_and_b32 v103, 1, v102
    v_lshlrev_b32 v103, 6, v103
    v_xor_b32 v107, v107, v103
    v_add_u32 v109, 0x4000, v107
    v_and_b32 v110, 0xffffffe3, v107
    v_and_b32 v103, 1, v101
    v_lshl_add_u32 v110, v103, 4, v110
    v_and_b32 v103, 6, v101
    v_lshl_add_u32 v110, v103, 1, v110
    v_add_u32 v111, 0x4000, v110
    v_lshl_add_u32 v106, v106, 10, v104
    s_lshl_b32 s50, s52, 8
    s_lshr_b32 s51, s4, 1
    s_lshl_b32 s51, s51, 7
    s_add_u32 s50, s50, s51
    v_add_u32 v106, s50, v106
    s_mov_b32 s36, 0xffbfffbf
    s_mov_b32 s39, 0x3e0293ee
    s_mov_b32 s32, 0xcccccccc
    s_mov_b32 s33, 0xcccccccc
    s_mov_b32 s88, 0x000f000f
    s_mov_b32 s89, 0x000f000f
    s_lshr_b32 s6, s5, 1
    s_lshl_b32 s6, s6, 6
    s_add_u32 s6, s6, 0
    s_mov_b32 s34, 0x0000ffff
    s_mov_b32 s35, 0x0000ffff
    v_mov_b32 v103, 0x4444
    v_mov_b32 v104, 0xeeee
    v_cndmask_b32 v1, v103, v104, s[32:33]
    s_lshl_b32 s55, s4, 11
    s_lshl_b32 s53, s4, 6
    v_mov_b32 v2, s36
    v_mov_b32 v3, s36
    v_mov_b32 v4, s36
    v_mov_b32 v5, s36
    s_lshl_b32 s50, s4, 16
    s_lshl_b32 s51, s5, 6
    s_add_u32 s50, s50, s51
    v_lshrrev_b32 v103, 3, v100
    v_lshlrev_b32 v103, 13, v103
    v_and_b32 v104, 7, v101
    v_lshl_add_u32 v103, v104, 3, v103
    v_add_u32 v6, s50, v103
    s_lshr_b32 s50, s5, 3
    s_lshl_b32 s50, s50, 9
    s_add_u32 s50, s50, s55
    s_and_b32 s51, s5, 1
    s_lshl_b32 s51, s51, 8
    s_add_u32 s50, s50, s51
    s_and_b32 s51, s5, 6
    s_lshl_b32 s51, s51, 5
    s_add_u32 s50, s50, s51
    v_and_b32 v103, 3, v101
    v_lshlrev_b32 v103, 2, v103
    v_lshl_add_u32 v103, v102, 4, v103
    v_add_u32 v103, s50, v103
    v_and_b32 v104, 1, v101
    v_mov_b32 v7, 0x7fffff00
    v_cmp_gt_u32 vcc, 4, v101
    s_nop 1
    v_cndmask_b32 v7, v7, v103, vcc
    v_mul_u32_u24 v103, 576, v102
    v_lshl_add_u32 v103, v101, 2, v103
    v_add_u32 v103, s53, v103
    v_add_u32 v8, 152192, v103
    v_lshrrev_b32 v108, 2, v101
    v_lshl_add_u32 v108, v108, 1, v104
    v_mul_u32_u24 v103, 288, v108
    v_add_u32 v103, 147584, v103
    v_lshl_add_u32 v9, v102, 4, v103
    v_lshl_add_u32 v10, v102, 5, v103
    v_and_b32 v108, 2, v101
    v_lshl_add_u32 v10, v108, 3, v10
    v_mov_b32 v103, 0x3f80
    v_lshlrev_b32 v108, 4, v104
    v_lshlrev_b32 v103, v108, v103
    v_lshrrev_b32 v108, 1, v101
    v_cmp_eq_u32 vcc, 0, v108
    s_nop 1
    v_cndmask_b32 v16, 0, v103, vcc
    v_cmp_eq_u32 vcc, 2, v108
    s_nop 1
    v_cndmask_b32 v17, 0, v103, vcc
    v_cmp_eq_u32 vcc, 4, v108
    s_nop 1
    v_cndmask_b32 v18, 0, v103, vcc
    v_cmp_eq_u32 vcc, 6, v108
    s_nop 1
    v_cndmask_b32 v19, 0, v103, vcc
    v_mov_b32 v20, 0x3f803f80
    v_mov_b32 v21, 0x3e803e80
    v_mov_b32 v22, 0x3f803f80
    v_mov_b32 v23, 0x3e803e80
    s_mov_b32 s40, 0
    s_mov_b32 s41, 0x100000
    s_mov_b32 s42, 0x110000
    s_mov_b32 s43, 0x120000
    s_mov_b32 s44, 0x80000
    s_lshl_b32 s56, s5, 13
    s_add_u32 s56, s56, s55
    s_add_u32 s56, s56, 0x80000
    s_lshl_b32 s46, s5, 13
    s_add_u32 s46, s46, 0x2000000
    s_lshl_b32 s47, s5, 12
    s_lshl_b32 s50, s4, 10
    s_add_u32 s47, s47, s50
    s_add_u32 s47, s47, 0x7e0000
    s_add_u32 s46, s46, s55
    s_lshr_b32 s50, s4, 1
    s_lshl_b32 s50, s50, 5
    s_add_u32 s48, s55, s50
    s_add_u32 s57, s55, 154496
    s_load_dwordx2 s[64:65], s[0:1], 8
    s_mov_b32 s66, 0x2000
    s_mov_b32 s67, 0x20000
    buffer_store_dwordx4 v[2:5], v0, s[8:11], s56 offen offset:0 sc1
    buffer_store_dwordx4 v[2:5], v0, s[8:11], s56 offen offset:1024 sc1
    s_and_b32 s50, s5, 6
    s_lshl_b32 s50, s50, 10
    s_lshr_b32 s51, s5, 3
    s_lshl_b32 s51, s51, 6
    s_add_u32 s50, s50, s51
    s_lshl_b32 s51, s4, 8
    s_add_u32 s50, s50, s51
    s_and_b32 s51, s5, 1
    s_lshl_b32 s51, s51, 5
    s_add_u32 s50, s50, s51
    v_and_b32 v103, 1, v102
    v_lshlrev_b32 v103, 10, v103
    v_and_b32 v104, 3, v101
    v_lshl_add_u32 v103, v104, 2, v103
    v_lshrrev_b32 v104, 1, v102
    v_lshl_add_u32 v103, v104, 4, v103
    s_waitcnt lgkmcnt(0)
    buffer_load_dword v99, v103, s[64:67], s50 offen
    buffer_store_dword v2, v7, s[8:11], s42 offen sc1
    s_mov_b32 s63, 128
    s_cmp_eq_u32 s99, 0
    s_cselect_b32 s63, s63, 0x7fffff00
    s_mov_b32 s99, 1
    v_mov_b32 v98, 1
    s_mov_b64 exec, 1
    buffer_atomic_add v98, off, s[12:15], s63
    s_mov_b64 exec, -1
    s_waitcnt vmcnt(21)
    s_barrier
    ds_read2st64_b32 v[24:25], v107 offset0:0 offset1:2
    ds_read2st64_b32 v[26:27], v107 offset0:4 offset1:6
    ds_read2st64_b32 v[28:29], v107 offset0:8 offset1:10
    ds_read2st64_b32 v[30:31], v107 offset0:12 offset1:14
    ds_read2st64_b32 v[32:33], v107 offset0:16 offset1:18
    ds_read2st64_b32 v[34:35], v107 offset0:20 offset1:22
    ds_read2st64_b32 v[36:37], v107 offset0:24 offset1:26
    ds_read2st64_b32 v[38:39], v107 offset0:28 offset1:30
    ds_read2st64_b32 v[40:41], v107 offset0:32 offset1:34
    ds_read2st64_b32 v[42:43], v107 offset0:36 offset1:38
    ds_read2st64_b32 v[44:45], v107 offset0:40 offset1:42
    ds_read2st64_b32 v[46:47], v107 offset0:44 offset1:46
    ds_read2st64_b32 v[48:49], v107 offset0:48 offset1:50
    ds_read2st64_b32 v[50:51], v107 offset0:52 offset1:54
    ds_read2st64_b32 v[52:53], v107 offset0:56 offset1:58
    ds_read2st64_b32 v[54:55], v107 offset0:60 offset1:62
    ds_read2st64_b32 v[56:57], v109 offset0:0 offset1:2
    ds_read2st64_b32 v[58:59], v109 offset0:4 offset1:6
    ds_read2st64_b32 v[60:61], v109 offset0:8 offset1:10
    ds_read2st64_b32 v[62:63], v109 offset0:12 offset1:14
    ds_read2st64_b32 v[64:65], v109 offset0:16 offset1:18
    ds_read2st64_b32 v[66:67], v109 offset0:20 offset1:22
    ds_read2st64_b32 v[68:69], v109 offset0:24 offset1:26
    ds_read2st64_b32 v[70:71], v109 offset0:28 offset1:30
    ds_read2st64_b32 v[72:73], v109 offset0:32 offset1:34
    ds_read2st64_b32 v[74:75], v109 offset0:36 offset1:38
    ds_read2st64_b32 v[76:77], v109 offset0:40 offset1:42
    ds_read2st64_b32 v[78:79], v109 offset0:44 offset1:46
    ds_read2st64_b32 v[80:81], v109 offset0:48 offset1:50
    ds_read2st64_b32 v[82:83], v109 offset0:52 offset1:54
    ds_read2st64_b32 v[84:85], v109 offset0:56 offset1:58
    ds_read2st64_b32 v[86:87], v109 offset0:60 offset1:62
    s_waitcnt lgkmcnt(0)
    s_barrier
    s_add_u32 m0, s54, 0
    s_xor_b32 s51, s58, 0x0
    buffer_load_dwordx4 v105, s[20:23], s51 offen  lds
    s_add_u32 m0, s54, 1024
    s_xor_b32 s51, s58, 0x10000
    buffer_load_dwordx4 v105, s[20:23], s51 offen  lds
    s_add_u32 m0, s54, 2048
    s_xor_b32 s51, s58, 0x4000
    buffer_load_dwordx4 v105, s[20:23], s51 offen  lds
    s_add_u32 m0, s54, 3072
    s_xor_b32 s51, s58, 0x14000
    buffer_load_dwordx4 v105, s[20:23], s51 offen  lds
    s_add_u32 m0, s54, 4096
    s_xor_b32 s51, s58, 0x40000
    buffer_load_dwordx4 v105, s[20:23], s51 offen  lds
    s_add_u32 m0, s54, 5120
    s_xor_b32 s51, s58, 0x50000
    buffer_load_dwordx4 v105, s[20:23], s51 offen  lds
    s_add_u32 m0, s54, 6144
    s_xor_b32 s51, s58, 0x44000
    buffer_load_dwordx4 v105, s[20:23], s51 offen  lds
    s_add_u32 m0, s54, 7168
    s_xor_b32 s51, s58, 0x54000
    buffer_load_dwordx4 v105, s[20:23], s51 offen  lds
    s_add_u32 m0, s54, 8192
    s_xor_b32 s51, s58, 0x80000
    buffer_load_dwordx4 v105, s[20:23], s51 offen  lds
    s_add_u32 m0, s54, 9216
    s_xor_b32 s51, s58, 0x90000
    buffer_load_dwordx4 v105, s[20:23], s51 offen  lds
    s_add_u32 m0, s54, 10240
    s_xor_b32 s51, s58, 0x84000
    buffer_load_dwordx4 v105, s[20:23], s51 offen  lds
    s_add_u32 m0, s54, 11264
    s_xor_b32 s51, s58, 0x94000
    buffer_load_dwordx4 v105, s[20:23], s51 offen  lds
    s_add_u32 m0, s54, 12288
    s_xor_b32 s51, s58, 0xc0000
    buffer_load_dwordx4 v105, s[20:23], s51 offen  lds
    s_add_u32 m0, s54, 13312
    s_xor_b32 s51, s58, 0xd0000
    buffer_load_dwordx4 v105, s[20:23], s51 offen  lds
    s_add_u32 m0, s54, 14336
    s_xor_b32 s51, s58, 0xc4000
    buffer_load_dwordx4 v105, s[20:23], s51 offen  lds
    s_add_u32 m0, s54, 15360
    s_xor_b32 s51, s58, 0xd4000
    buffer_load_dwordx4 v105, s[20:23], s51 offen  lds
    v_perm_b32 v124, v25, v24, s37
    v_accvgpr_write_b32 a0, v124
    v_perm_b32 v125, v25, v24, s38
    v_accvgpr_write_b32 a8, v125
    v_perm_b32 v124, v27, v26, s37
    v_accvgpr_write_b32 a1, v124
    v_perm_b32 v125, v27, v26, s38
    v_accvgpr_write_b32 a9, v125
    v_perm_b32 v124, v29, v28, s37
    v_accvgpr_write_b32 a2, v124
    v_perm_b32 v125, v29, v28, s38
    v_accvgpr_write_b32 a10, v125
    v_perm_b32 v124, v31, v30, s37
    v_accvgpr_write_b32 a3, v124
    v_perm_b32 v125, v31, v30, s38
    v_accvgpr_write_b32 a11, v125
    v_perm_b32 v124, v33, v32, s37
    v_accvgpr_write_b32 a4, v124
    v_perm_b32 v125, v33, v32, s38
    v_accvgpr_write_b32 a12, v125
    v_perm_b32 v124, v35, v34, s37
    v_accvgpr_write_b32 a5, v124
    v_perm_b32 v125, v35, v34, s38
    v_accvgpr_write_b32 a13, v125
    v_perm_b32 v124, v37, v36, s37
    v_accvgpr_write_b32 a6, v124
    v_perm_b32 v125, v37, v36, s38
    v_accvgpr_write_b32 a14, v125
    v_perm_b32 v124, v39, v38, s37
    v_accvgpr_write_b32 a7, v124
    v_perm_b32 v125, v39, v38, s38
    v_accvgpr_write_b32 a15, v125
    v_perm_b32 v124, v41, v40, s37
    v_accvgpr_write_b32 a16, v124
    v_perm_b32 v125, v41, v40, s38
    v_accvgpr_write_b32 a24, v125
    v_perm_b32 v124, v43, v42, s37
    v_accvgpr_write_b32 a17, v124
    v_perm_b32 v125, v43, v42, s38
    v_accvgpr_write_b32 a25, v125
    v_perm_b32 v124, v45, v44, s37
    v_accvgpr_write_b32 a18, v124
    v_perm_b32 v125, v45, v44, s38
    v_accvgpr_write_b32 a26, v125
    v_perm_b32 v124, v47, v46, s37
    v_accvgpr_write_b32 a19, v124
    v_perm_b32 v125, v47, v46, s38
    v_accvgpr_write_b32 a27, v125
    v_perm_b32 v124, v49, v48, s37
    v_accvgpr_write_b32 a20, v124
    v_perm_b32 v125, v49, v48, s38
    v_accvgpr_write_b32 a28, v125
    v_perm_b32 v124, v51, v50, s37
    v_accvgpr_write_b32 a21, v124
    v_perm_b32 v125, v51, v50, s38
    v_accvgpr_write_b32 a29, v125
    v_perm_b32 v124, v53, v52, s37
    v_accvgpr_write_b32 a22, v124
    v_perm_b32 v125, v53, v52, s38
    v_accvgpr_write_b32 a30, v125
    v_perm_b32 v124, v55, v54, s37
    v_accvgpr_write_b32 a23, v124
    v_perm_b32 v125, v55, v54, s38
    v_accvgpr_write_b32 a31, v125
    v_perm_b32 v124, v57, v56, s37
    v_accvgpr_write_b32 a32, v124
    v_perm_b32 v125, v57, v56, s38
    v_accvgpr_write_b32 a40, v125
    v_perm_b32 v124, v59, v58, s37
    v_accvgpr_write_b32 a33, v124
    v_perm_b32 v125, v59, v58, s38
    v_accvgpr_write_b32 a41, v125
    v_perm_b32 v124, v61, v60, s37
    v_accvgpr_write_b32 a34, v124
    v_perm_b32 v125, v61, v60, s38
    v_accvgpr_write_b32 a42, v125
    v_perm_b32 v124, v63, v62, s37
    v_accvgpr_write_b32 a35, v124
    v_perm_b32 v125, v63, v62, s38
    v_accvgpr_write_b32 a43, v125
    v_perm_b32 v124, v65, v64, s37
    v_accvgpr_write_b32 a36, v124
    v_perm_b32 v125, v65, v64, s38
    v_accvgpr_write_b32 a44, v125
    v_perm_b32 v124, v67, v66, s37
    v_accvgpr_write_b32 a37, v124
    v_perm_b32 v125, v67, v66, s38
    v_accvgpr_write_b32 a45, v125
    v_perm_b32 v124, v69, v68, s37
    v_accvgpr_write_b32 a38, v124
    v_perm_b32 v125, v69, v68, s38
    v_accvgpr_write_b32 a46, v125
    v_perm_b32 v124, v71, v70, s37
    v_accvgpr_write_b32 a39, v124
    v_perm_b32 v125, v71, v70, s38
    v_accvgpr_write_b32 a47, v125
    v_perm_b32 v124, v73, v72, s37
    v_accvgpr_write_b32 a48, v124
    v_perm_b32 v125, v73, v72, s38
    v_accvgpr_write_b32 a56, v125
    v_perm_b32 v124, v75, v74, s37
    v_accvgpr_write_b32 a49, v124
    v_perm_b32 v125, v75, v74, s38
    v_accvgpr_write_b32 a57, v125
    v_perm_b32 v124, v77, v76, s37
    v_accvgpr_write_b32 a50, v124
    v_perm_b32 v125, v77, v76, s38
    v_accvgpr_write_b32 a58, v125
    v_perm_b32 v124, v79, v78, s37
    v_accvgpr_write_b32 a51, v124
    v_perm_b32 v125, v79, v78, s38
    v_accvgpr_write_b32 a59, v125
    v_perm_b32 v124, v81, v80, s37
    v_accvgpr_write_b32 a52, v124
    v_perm_b32 v125, v81, v80, s38
    v_accvgpr_write_b32 a60, v125
    v_perm_b32 v124, v83, v82, s37
    v_accvgpr_write_b32 a53, v124
    v_perm_b32 v125, v83, v82, s38
    v_accvgpr_write_b32 a61, v125
    v_perm_b32 v124, v85, v84, s37
    v_accvgpr_write_b32 a54, v124
    v_perm_b32 v125, v85, v84, s38
    v_accvgpr_write_b32 a62, v125
    v_perm_b32 v124, v87, v86, s37
    v_accvgpr_write_b32 a55, v124
    v_perm_b32 v125, v87, v86, s38
    v_accvgpr_write_b32 a63, v125
    s_waitcnt vmcnt(16)
    s_barrier
    ds_read2st64_b32 v[24:25], v107 offset0:128 offset1:130
    ds_read2st64_b32 v[26:27], v107 offset0:132 offset1:134
    ds_read2st64_b32 v[28:29], v107 offset0:136 offset1:138
    ds_read2st64_b32 v[30:31], v107 offset0:140 offset1:142
    ds_read2st64_b32 v[32:33], v107 offset0:144 offset1:146
    ds_read2st64_b32 v[34:35], v107 offset0:148 offset1:150
    ds_read2st64_b32 v[36:37], v107 offset0:152 offset1:154
    ds_read2st64_b32 v[38:39], v107 offset0:156 offset1:158
    ds_read2st64_b32 v[40:41], v107 offset0:160 offset1:162
    ds_read2st64_b32 v[42:43], v107 offset0:164 offset1:166
    ds_read2st64_b32 v[44:45], v107 offset0:168 offset1:170
    ds_read2st64_b32 v[46:47], v107 offset0:172 offset1:174
    ds_read2st64_b32 v[48:49], v107 offset0:176 offset1:178
    ds_read2st64_b32 v[50:51], v107 offset0:180 offset1:182
    ds_read2st64_b32 v[52:53], v107 offset0:184 offset1:186
    ds_read2st64_b32 v[54:55], v107 offset0:188 offset1:190
    ds_read2st64_b32 v[56:57], v109 offset0:128 offset1:130
    ds_read2st64_b32 v[58:59], v109 offset0:132 offset1:134
    ds_read2st64_b32 v[60:61], v109 offset0:136 offset1:138
    ds_read2st64_b32 v[62:63], v109 offset0:140 offset1:142
    ds_read2st64_b32 v[64:65], v109 offset0:144 offset1:146
    ds_read2st64_b32 v[66:67], v109 offset0:148 offset1:150
    ds_read2st64_b32 v[68:69], v109 offset0:152 offset1:154
    ds_read2st64_b32 v[70:71], v109 offset0:156 offset1:158
    ds_read2st64_b32 v[72:73], v109 offset0:160 offset1:162
    ds_read2st64_b32 v[74:75], v109 offset0:164 offset1:166
    ds_read2st64_b32 v[76:77], v109 offset0:168 offset1:170
    ds_read2st64_b32 v[78:79], v109 offset0:172 offset1:174
    ds_read2st64_b32 v[80:81], v109 offset0:176 offset1:178
    ds_read2st64_b32 v[82:83], v109 offset0:180 offset1:182
    ds_read2st64_b32 v[84:85], v109 offset0:184 offset1:186
    ds_read2st64_b32 v[86:87], v109 offset0:188 offset1:190
    s_waitcnt lgkmcnt(0)
    s_barrier
    s_add_u32 m0, s54, 32768
    s_xor_b32 s51, s58, 0x200000
    buffer_load_dwordx4 v105, s[20:23], s51 offen  lds
    s_add_u32 m0, s54, 33792
    s_xor_b32 s51, s58, 0x210000
    buffer_load_dwordx4 v105, s[20:23], s51 offen  lds
    s_add_u32 m0, s54, 34816
    s_xor_b32 s51, s58, 0x204000
    buffer_load_dwordx4 v105, s[20:23], s51 offen  lds
    s_add_u32 m0, s54, 35840
    s_xor_b32 s51, s58, 0x214000
    buffer_load_dwordx4 v105, s[20:23], s51 offen  lds
    s_add_u32 m0, s54, 36864
    s_xor_b32 s51, s58, 0x240000
    buffer_load_dwordx4 v105, s[20:23], s51 offen  lds
    s_add_u32 m0, s54, 37888
    s_xor_b32 s51, s58, 0x250000
    buffer_load_dwordx4 v105, s[20:23], s51 offen  lds
    s_add_u32 m0, s54, 38912
    s_xor_b32 s51, s58, 0x244000
    buffer_load_dwordx4 v105, s[20:23], s51 offen  lds
    s_add_u32 m0, s54, 39936
    s_xor_b32 s51, s58, 0x254000
    buffer_load_dwordx4 v105, s[20:23], s51 offen  lds
    s_add_u32 m0, s54, 40960
    s_xor_b32 s51, s58, 0x280000
    buffer_load_dwordx4 v105, s[20:23], s51 offen  lds
    s_add_u32 m0, s54, 41984
    s_xor_b32 s51, s58, 0x290000
    buffer_load_dwordx4 v105, s[20:23], s51 offen  lds
    s_add_u32 m0, s54, 43008
    s_xor_b32 s51, s58, 0x284000
    buffer_load_dwordx4 v105, s[20:23], s51 offen  lds
    s_add_u32 m0, s54, 44032
    s_xor_b32 s51, s58, 0x294000
    buffer_load_dwordx4 v105, s[20:23], s51 offen  lds
    s_add_u32 m0, s54, 45056
    s_xor_b32 s51, s58, 0x2c0000
    buffer_load_dwordx4 v105, s[20:23], s51 offen  lds
    s_add_u32 m0, s54, 46080
    s_xor_b32 s51, s58, 0x2d0000
    buffer_load_dwordx4 v105, s[20:23], s51 offen  lds
    s_add_u32 m0, s54, 47104
    s_xor_b32 s51, s58, 0x2c4000
    buffer_load_dwordx4 v105, s[20:23], s51 offen  lds
    s_add_u32 m0, s54, 48128
    s_xor_b32 s51, s58, 0x2d4000
    buffer_load_dwordx4 v105, s[20:23], s51 offen  lds
    s_mov_b32 s50, 0x100000
    buffer_store_dword v99, v7, s[8:11], s50 offen sc1
    v_perm_b32 v124, v25, v24, s37
    v_accvgpr_write_b32 a64, v124
    v_perm_b32 v125, v25, v24, s38
    v_accvgpr_write_b32 a72, v125
    v_perm_b32 v124, v27, v26, s37
    v_accvgpr_write_b32 a65, v124
    v_perm_b32 v125, v27, v26, s38
    v_accvgpr_write_b32 a73, v125
    v_perm_b32 v124, v29, v28, s37
    v_accvgpr_write_b32 a66, v124
    v_perm_b32 v125, v29, v28, s38
    v_accvgpr_write_b32 a74, v125
    v_perm_b32 v124, v31, v30, s37
    v_accvgpr_write_b32 a67, v124
    v_perm_b32 v125, v31, v30, s38
    v_accvgpr_write_b32 a75, v125
    v_perm_b32 v124, v33, v32, s37
    v_accvgpr_write_b32 a68, v124
    v_perm_b32 v125, v33, v32, s38
    v_accvgpr_write_b32 a76, v125
    v_perm_b32 v124, v35, v34, s37
    v_accvgpr_write_b32 a69, v124
    v_perm_b32 v125, v35, v34, s38
    v_accvgpr_write_b32 a77, v125
    v_perm_b32 v124, v37, v36, s37
    v_accvgpr_write_b32 a70, v124
    v_perm_b32 v125, v37, v36, s38
    v_accvgpr_write_b32 a78, v125
    v_perm_b32 v124, v39, v38, s37
    v_accvgpr_write_b32 a71, v124
    v_perm_b32 v125, v39, v38, s38
    v_accvgpr_write_b32 a79, v125
    v_perm_b32 v124, v41, v40, s37
    v_accvgpr_write_b32 a80, v124
    v_perm_b32 v125, v41, v40, s38
    v_accvgpr_write_b32 a88, v125
    v_perm_b32 v124, v43, v42, s37
    v_accvgpr_write_b32 a81, v124
    v_perm_b32 v125, v43, v42, s38
    v_accvgpr_write_b32 a89, v125
    v_perm_b32 v124, v45, v44, s37
    v_accvgpr_write_b32 a82, v124
    v_perm_b32 v125, v45, v44, s38
    v_accvgpr_write_b32 a90, v125
    v_perm_b32 v124, v47, v46, s37
    v_accvgpr_write_b32 a83, v124
    v_perm_b32 v125, v47, v46, s38
    v_accvgpr_write_b32 a91, v125
    v_perm_b32 v124, v49, v48, s37
    v_accvgpr_write_b32 a84, v124
    v_perm_b32 v125, v49, v48, s38
    v_accvgpr_write_b32 a92, v125
    v_perm_b32 v124, v51, v50, s37
    v_accvgpr_write_b32 a85, v124
    v_perm_b32 v125, v51, v50, s38
    v_accvgpr_write_b32 a93, v125
    v_perm_b32 v124, v53, v52, s37
    v_accvgpr_write_b32 a86, v124
    v_perm_b32 v125, v53, v52, s38
    v_accvgpr_write_b32 a94, v125
    v_perm_b32 v124, v55, v54, s37
    v_accvgpr_write_b32 a87, v124
    v_perm_b32 v125, v55, v54, s38
    v_accvgpr_write_b32 a95, v125
    v_perm_b32 v124, v57, v56, s37
    v_accvgpr_write_b32 a96, v124
    v_perm_b32 v125, v57, v56, s38
    v_accvgpr_write_b32 a104, v125
    v_perm_b32 v124, v59, v58, s37
    v_accvgpr_write_b32 a97, v124
    v_perm_b32 v125, v59, v58, s38
    v_accvgpr_write_b32 a105, v125
    v_perm_b32 v124, v61, v60, s37
    v_accvgpr_write_b32 a98, v124
    v_perm_b32 v125, v61, v60, s38
    v_accvgpr_write_b32 a106, v125
    v_perm_b32 v124, v63, v62, s37
    v_accvgpr_write_b32 a99, v124
    v_perm_b32 v125, v63, v62, s38
    v_accvgpr_write_b32 a107, v125
    v_perm_b32 v124, v65, v64, s37
    v_accvgpr_write_b32 a100, v124
    v_perm_b32 v125, v65, v64, s38
    v_accvgpr_write_b32 a108, v125
    v_perm_b32 v124, v67, v66, s37
    v_accvgpr_write_b32 a101, v124
    v_perm_b32 v125, v67, v66, s38
    v_accvgpr_write_b32 a109, v125
    v_perm_b32 v124, v69, v68, s37
    v_accvgpr_write_b32 a102, v124
    v_perm_b32 v125, v69, v68, s38
    v_accvgpr_write_b32 a110, v125
    v_perm_b32 v124, v71, v70, s37
    v_accvgpr_write_b32 a103, v124
    v_perm_b32 v125, v71, v70, s38
    v_accvgpr_write_b32 a111, v125
    v_perm_b32 v124, v73, v72, s37
    v_accvgpr_write_b32 a112, v124
    v_perm_b32 v125, v73, v72, s38
    v_accvgpr_write_b32 a120, v125
    v_perm_b32 v124, v75, v74, s37
    v_accvgpr_write_b32 a113, v124
    v_perm_b32 v125, v75, v74, s38
    v_accvgpr_write_b32 a121, v125
    v_perm_b32 v124, v77, v76, s37
    v_accvgpr_write_b32 a114, v124
    v_perm_b32 v125, v77, v76, s38
    v_accvgpr_write_b32 a122, v125
    v_perm_b32 v124, v79, v78, s37
    v_accvgpr_write_b32 a115, v124
    v_perm_b32 v125, v79, v78, s38
    v_accvgpr_write_b32 a123, v125
    v_perm_b32 v124, v81, v80, s37
    v_accvgpr_write_b32 a116, v124
    v_perm_b32 v125, v81, v80, s38
    v_accvgpr_write_b32 a124, v125
    v_perm_b32 v124, v83, v82, s37
    v_accvgpr_write_b32 a117, v124
    v_perm_b32 v125, v83, v82, s38
    v_accvgpr_write_b32 a125, v125
    v_perm_b32 v124, v85, v84, s37
    v_accvgpr_write_b32 a118, v124
    v_perm_b32 v125, v85, v84, s38
    v_accvgpr_write_b32 a126, v125
    v_perm_b32 v124, v87, v86, s37
    v_accvgpr_write_b32 a119, v124
    v_perm_b32 v125, v87, v86, s38
    v_accvgpr_write_b32 a127, v125
    s_waitcnt vmcnt(17)
    s_barrier
    ds_read2st64_b32 v[24:25], v107 offset0:0 offset1:2
    ds_read2st64_b32 v[26:27], v107 offset0:4 offset1:6
    ds_read2st64_b32 v[28:29], v107 offset0:8 offset1:10
    ds_read2st64_b32 v[30:31], v107 offset0:12 offset1:14
    ds_read2st64_b32 v[32:33], v107 offset0:16 offset1:18
    ds_read2st64_b32 v[34:35], v107 offset0:20 offset1:22
    ds_read2st64_b32 v[36:37], v107 offset0:24 offset1:26
    ds_read2st64_b32 v[38:39], v107 offset0:28 offset1:30
    ds_read2st64_b32 v[40:41], v107 offset0:32 offset1:34
    ds_read2st64_b32 v[42:43], v107 offset0:36 offset1:38
    ds_read2st64_b32 v[44:45], v107 offset0:40 offset1:42
    ds_read2st64_b32 v[46:47], v107 offset0:44 offset1:46
    ds_read2st64_b32 v[48:49], v107 offset0:48 offset1:50
    ds_read2st64_b32 v[50:51], v107 offset0:52 offset1:54
    ds_read2st64_b32 v[52:53], v107 offset0:56 offset1:58
    ds_read2st64_b32 v[54:55], v107 offset0:60 offset1:62
    ds_read2st64_b32 v[56:57], v109 offset0:0 offset1:2
    ds_read2st64_b32 v[58:59], v109 offset0:4 offset1:6
    ds_read2st64_b32 v[60:61], v109 offset0:8 offset1:10
    ds_read2st64_b32 v[62:63], v109 offset0:12 offset1:14
    ds_read2st64_b32 v[64:65], v109 offset0:16 offset1:18
    ds_read2st64_b32 v[66:67], v109 offset0:20 offset1:22
    ds_read2st64_b32 v[68:69], v109 offset0:24 offset1:26
    ds_read2st64_b32 v[70:71], v109 offset0:28 offset1:30
    ds_read2st64_b32 v[72:73], v109 offset0:32 offset1:34
    ds_read2st64_b32 v[74:75], v109 offset0:36 offset1:38
    ds_read2st64_b32 v[76:77], v109 offset0:40 offset1:42
    ds_read2st64_b32 v[78:79], v109 offset0:44 offset1:46
    ds_read2st64_b32 v[80:81], v109 offset0:48 offset1:50
    ds_read2st64_b32 v[82:83], v109 offset0:52 offset1:54
    ds_read2st64_b32 v[84:85], v109 offset0:56 offset1:58
    ds_read2st64_b32 v[86:87], v109 offset0:60 offset1:62
    s_waitcnt lgkmcnt(0)
    s_barrier
    s_add_u32 m0, s54, 0
    s_xor_b32 s51, s58, 0x0
    buffer_load_dwordx4 v105, s[24:27], s51 offen  lds
    s_add_u32 m0, s54, 1024
    s_xor_b32 s51, s58, 0x10000
    buffer_load_dwordx4 v105, s[24:27], s51 offen  lds
    s_add_u32 m0, s54, 2048
    s_xor_b32 s51, s58, 0x4000
    buffer_load_dwordx4 v105, s[24:27], s51 offen  lds
    s_add_u32 m0, s54, 3072
    s_xor_b32 s51, s58, 0x14000
    buffer_load_dwordx4 v105, s[24:27], s51 offen  lds
    s_add_u32 m0, s54, 4096
    s_xor_b32 s51, s58, 0x40000
    buffer_load_dwordx4 v105, s[24:27], s51 offen  lds
    s_add_u32 m0, s54, 5120
    s_xor_b32 s51, s58, 0x50000
    buffer_load_dwordx4 v105, s[24:27], s51 offen  lds
    s_add_u32 m0, s54, 6144
    s_xor_b32 s51, s58, 0x44000
    buffer_load_dwordx4 v105, s[24:27], s51 offen  lds
    s_add_u32 m0, s54, 7168
    s_xor_b32 s51, s58, 0x54000
    buffer_load_dwordx4 v105, s[24:27], s51 offen  lds
    s_add_u32 m0, s54, 8192
    s_xor_b32 s51, s58, 0x80000
    buffer_load_dwordx4 v105, s[24:27], s51 offen  lds
    s_add_u32 m0, s54, 9216
    s_xor_b32 s51, s58, 0x90000
    buffer_load_dwordx4 v105, s[24:27], s51 offen  lds
    s_add_u32 m0, s54, 10240
    s_xor_b32 s51, s58, 0x84000
    buffer_load_dwordx4 v105, s[24:27], s51 offen  lds
    s_add_u32 m0, s54, 11264
    s_xor_b32 s51, s58, 0x94000
    buffer_load_dwordx4 v105, s[24:27], s51 offen  lds
    s_add_u32 m0, s54, 12288
    s_xor_b32 s51, s58, 0xc0000
    buffer_load_dwordx4 v105, s[24:27], s51 offen  lds
    s_add_u32 m0, s54, 13312
    s_xor_b32 s51, s58, 0xd0000
    buffer_load_dwordx4 v105, s[24:27], s51 offen  lds
    s_add_u32 m0, s54, 14336
    s_xor_b32 s51, s58, 0xc4000
    buffer_load_dwordx4 v105, s[24:27], s51 offen  lds
    s_add_u32 m0, s54, 15360
    s_xor_b32 s51, s58, 0xd4000
    buffer_load_dwordx4 v105, s[24:27], s51 offen  lds
    v_perm_b32 v124, v25, v24, s37
    v_accvgpr_write_b32 a128, v124
    v_perm_b32 v125, v25, v24, s38
    v_accvgpr_write_b32 a136, v125
    v_perm_b32 v124, v27, v26, s37
    v_accvgpr_write_b32 a129, v124
    v_perm_b32 v125, v27, v26, s38
    v_accvgpr_write_b32 a137, v125
    v_perm_b32 v124, v29, v28, s37
    v_accvgpr_write_b32 a130, v124
    v_perm_b32 v125, v29, v28, s38
    v_accvgpr_write_b32 a138, v125
    v_perm_b32 v124, v31, v30, s37
    v_accvgpr_write_b32 a131, v124
    v_perm_b32 v125, v31, v30, s38
    v_accvgpr_write_b32 a139, v125
    v_perm_b32 v124, v33, v32, s37
    v_accvgpr_write_b32 a132, v124
    v_perm_b32 v125, v33, v32, s38
    v_accvgpr_write_b32 a140, v125
    v_perm_b32 v124, v35, v34, s37
    v_accvgpr_write_b32 a133, v124
    v_perm_b32 v125, v35, v34, s38
    v_accvgpr_write_b32 a141, v125
    v_perm_b32 v124, v37, v36, s37
    v_accvgpr_write_b32 a134, v124
    v_perm_b32 v125, v37, v36, s38
    v_accvgpr_write_b32 a142, v125
    v_perm_b32 v124, v39, v38, s37
    v_accvgpr_write_b32 a135, v124
    v_perm_b32 v125, v39, v38, s38
    v_accvgpr_write_b32 a143, v125
    v_perm_b32 v124, v41, v40, s37
    v_accvgpr_write_b32 a144, v124
    v_perm_b32 v125, v41, v40, s38
    v_accvgpr_write_b32 a152, v125
    v_perm_b32 v124, v43, v42, s37
    v_accvgpr_write_b32 a145, v124
    v_perm_b32 v125, v43, v42, s38
    v_accvgpr_write_b32 a153, v125
    v_perm_b32 v124, v45, v44, s37
    v_accvgpr_write_b32 a146, v124
    v_perm_b32 v125, v45, v44, s38
    v_accvgpr_write_b32 a154, v125
    v_perm_b32 v124, v47, v46, s37
    v_accvgpr_write_b32 a147, v124
    v_perm_b32 v125, v47, v46, s38
    v_accvgpr_write_b32 a155, v125
    v_perm_b32 v124, v49, v48, s37
    v_accvgpr_write_b32 a148, v124
    v_perm_b32 v125, v49, v48, s38
    v_accvgpr_write_b32 a156, v125
    v_perm_b32 v124, v51, v50, s37
    v_accvgpr_write_b32 a149, v124
    v_perm_b32 v125, v51, v50, s38
    v_accvgpr_write_b32 a157, v125
    v_perm_b32 v124, v53, v52, s37
    v_accvgpr_write_b32 a150, v124
    v_perm_b32 v125, v53, v52, s38
    v_accvgpr_write_b32 a158, v125
    v_perm_b32 v124, v55, v54, s37
    v_accvgpr_write_b32 a151, v124
    v_perm_b32 v125, v55, v54, s38
    v_accvgpr_write_b32 a159, v125
    v_perm_b32 v124, v57, v56, s37
    v_accvgpr_write_b32 a160, v124
    v_perm_b32 v125, v57, v56, s38
    v_accvgpr_write_b32 a168, v125
    v_perm_b32 v124, v59, v58, s37
    v_accvgpr_write_b32 a161, v124
    v_perm_b32 v125, v59, v58, s38
    v_accvgpr_write_b32 a169, v125
    v_perm_b32 v124, v61, v60, s37
    v_accvgpr_write_b32 a162, v124
    v_perm_b32 v125, v61, v60, s38
    v_accvgpr_write_b32 a170, v125
    v_perm_b32 v124, v63, v62, s37
    v_accvgpr_write_b32 a163, v124
    v_perm_b32 v125, v63, v62, s38
    v_accvgpr_write_b32 a171, v125
    v_perm_b32 v124, v65, v64, s37
    v_accvgpr_write_b32 a164, v124
    v_perm_b32 v125, v65, v64, s38
    v_accvgpr_write_b32 a172, v125
    v_perm_b32 v124, v67, v66, s37
    v_accvgpr_write_b32 a165, v124
    v_perm_b32 v125, v67, v66, s38
    v_accvgpr_write_b32 a173, v125
    v_perm_b32 v124, v69, v68, s37
    v_accvgpr_write_b32 a166, v124
    v_perm_b32 v125, v69, v68, s38
    v_accvgpr_write_b32 a174, v125
    v_perm_b32 v124, v71, v70, s37
    v_accvgpr_write_b32 a167, v124
    v_perm_b32 v125, v71, v70, s38
    v_accvgpr_write_b32 a175, v125
    v_perm_b32 v124, v73, v72, s37
    v_accvgpr_write_b32 a176, v124
    v_perm_b32 v125, v73, v72, s38
    v_accvgpr_write_b32 a184, v125
    v_perm_b32 v124, v75, v74, s37
    v_accvgpr_write_b32 a177, v124
    v_perm_b32 v125, v75, v74, s38
    v_accvgpr_write_b32 a185, v125
    v_perm_b32 v124, v77, v76, s37
    v_accvgpr_write_b32 a178, v124
    v_perm_b32 v125, v77, v76, s38
    v_accvgpr_write_b32 a186, v125
    v_perm_b32 v124, v79, v78, s37
    v_accvgpr_write_b32 a179, v124
    v_perm_b32 v125, v79, v78, s38
    v_accvgpr_write_b32 a187, v125
    v_perm_b32 v124, v81, v80, s37
    v_accvgpr_write_b32 a180, v124
    v_perm_b32 v125, v81, v80, s38
    v_accvgpr_write_b32 a188, v125
    v_perm_b32 v124, v83, v82, s37
    v_accvgpr_write_b32 a181, v124
    v_perm_b32 v125, v83, v82, s38
    v_accvgpr_write_b32 a189, v125
    v_perm_b32 v124, v85, v84, s37
    v_accvgpr_write_b32 a182, v124
    v_perm_b32 v125, v85, v84, s38
    v_accvgpr_write_b32 a190, v125
    v_perm_b32 v124, v87, v86, s37
    v_accvgpr_write_b32 a183, v124
    v_perm_b32 v125, v87, v86, s38
    v_accvgpr_write_b32 a191, v125
    s_waitcnt vmcnt(16)
    s_barrier
    ds_read2st64_b32 v[24:25], v107 offset0:128 offset1:130
    ds_read2st64_b32 v[26:27], v107 offset0:132 offset1:134
    ds_read2st64_b32 v[28:29], v107 offset0:136 offset1:138
    ds_read2st64_b32 v[30:31], v107 offset0:140 offset1:142
    ds_read2st64_b32 v[32:33], v107 offset0:144 offset1:146
    ds_read2st64_b32 v[34:35], v107 offset0:148 offset1:150
    ds_read2st64_b32 v[36:37], v107 offset0:152 offset1:154
    ds_read2st64_b32 v[38:39], v107 offset0:156 offset1:158
    ds_read2st64_b32 v[40:41], v107 offset0:160 offset1:162
    ds_read2st64_b32 v[42:43], v107 offset0:164 offset1:166
    ds_read2st64_b32 v[44:45], v107 offset0:168 offset1:170
    ds_read2st64_b32 v[46:47], v107 offset0:172 offset1:174
    ds_read2st64_b32 v[48:49], v107 offset0:176 offset1:178
    ds_read2st64_b32 v[50:51], v107 offset0:180 offset1:182
    ds_read2st64_b32 v[52:53], v107 offset0:184 offset1:186
    ds_read2st64_b32 v[54:55], v107 offset0:188 offset1:190
    ds_read2st64_b32 v[56:57], v109 offset0:128 offset1:130
    ds_read2st64_b32 v[58:59], v109 offset0:132 offset1:134
    ds_read2st64_b32 v[60:61], v109 offset0:136 offset1:138
    ds_read2st64_b32 v[62:63], v109 offset0:140 offset1:142
    ds_read2st64_b32 v[64:65], v109 offset0:144 offset1:146
    ds_read2st64_b32 v[66:67], v109 offset0:148 offset1:150
    ds_read2st64_b32 v[68:69], v109 offset0:152 offset1:154
    ds_read2st64_b32 v[70:71], v109 offset0:156 offset1:158
    ds_read2st64_b32 v[72:73], v109 offset0:160 offset1:162
    ds_read2st64_b32 v[74:75], v109 offset0:164 offset1:166
    ds_read2st64_b32 v[76:77], v109 offset0:168 offset1:170
    ds_read2st64_b32 v[78:79], v109 offset0:172 offset1:174
    ds_read2st64_b32 v[80:81], v109 offset0:176 offset1:178
    ds_read2st64_b32 v[82:83], v109 offset0:180 offset1:182
    ds_read2st64_b32 v[84:85], v109 offset0:184 offset1:186
    ds_read2st64_b32 v[86:87], v109 offset0:188 offset1:190
    s_waitcnt lgkmcnt(0)
    s_barrier
    buffer_load_dword v88, off, s[12:15], 0 offset:128 sc1
    s_add_u32 m0, s54, 32768
    s_xor_b32 s51, s58, 0x200000
    buffer_load_dwordx4 v105, s[24:27], s51 offen  lds
    s_add_u32 m0, s54, 33792
    s_xor_b32 s51, s58, 0x210000
    buffer_load_dwordx4 v105, s[24:27], s51 offen  lds
    s_add_u32 m0, s54, 34816
    s_xor_b32 s51, s58, 0x204000
    buffer_load_dwordx4 v105, s[24:27], s51 offen  lds
    s_add_u32 m0, s54, 35840
    s_xor_b32 s51, s58, 0x214000
    buffer_load_dwordx4 v105, s[24:27], s51 offen  lds
    s_add_u32 m0, s54, 36864
    s_xor_b32 s51, s58, 0x240000
    buffer_load_dwordx4 v105, s[24:27], s51 offen  lds
    s_add_u32 m0, s54, 37888
    s_xor_b32 s51, s58, 0x250000
    buffer_load_dwordx4 v105, s[24:27], s51 offen  lds
    s_add_u32 m0, s54, 38912
    s_xor_b32 s51, s58, 0x244000
    buffer_load_dwordx4 v105, s[24:27], s51 offen  lds
    s_add_u32 m0, s54, 39936
    s_xor_b32 s51, s58, 0x254000
    buffer_load_dwordx4 v105, s[24:27], s51 offen  lds
    s_add_u32 m0, s54, 40960
    s_xor_b32 s51, s58, 0x280000
    buffer_load_dwordx4 v105, s[24:27], s51 offen  lds
    s_add_u32 m0, s54, 41984
    s_xor_b32 s51, s58, 0x290000
    buffer_load_dwordx4 v105, s[24:27], s51 offen  lds
    s_add_u32 m0, s54, 43008
    s_xor_b32 s51, s58, 0x284000
    buffer_load_dwordx4 v105, s[24:27], s51 offen  lds
    s_add_u32 m0, s54, 44032
    s_xor_b32 s51, s58, 0x294000
    buffer_load_dwordx4 v105, s[24:27], s51 offen  lds
    s_add_u32 m0, s54, 45056
    s_xor_b32 s51, s58, 0x2c0000
    buffer_load_dwordx4 v105, s[24:27], s51 offen  lds
    s_add_u32 m0, s54, 46080
    s_xor_b32 s51, s58, 0x2d0000
    buffer_load_dwordx4 v105, s[24:27], s51 offen  lds
    s_add_u32 m0, s54, 47104
    s_xor_b32 s51, s58, 0x2c4000
    buffer_load_dwordx4 v105, s[24:27], s51 offen  lds
    s_add_u32 m0, s54, 48128
    s_xor_b32 s51, s58, 0x2d4000
    buffer_load_dwordx4 v105, s[24:27], s51 offen  lds
    s_add_u32 s63, s5, 96
    s_cmp_eq_u32 s4, 0
    s_cselect_b32 s63, s63, 0x7fffff00
    v_mov_b32 v98, 1
    s_mov_b64 exec, 1
    buffer_store_byte v98, off, s[12:15], s63 sc1
    s_mov_b64 exec, -1
    v_perm_b32 v124, v25, v24, s37
    v_accvgpr_write_b32 a192, v124
    v_perm_b32 v125, v25, v24, s38
    v_accvgpr_write_b32 a200, v125
    v_perm_b32 v124, v27, v26, s37
    v_accvgpr_write_b32 a193, v124
    v_perm_b32 v125, v27, v26, s38
    v_accvgpr_write_b32 a201, v125
    v_perm_b32 v124, v29, v28, s37
    v_accvgpr_write_b32 a194, v124
    v_perm_b32 v125, v29, v28, s38
    v_accvgpr_write_b32 a202, v125
    v_perm_b32 v124, v31, v30, s37
    v_accvgpr_write_b32 a195, v124
    v_perm_b32 v125, v31, v30, s38
    v_accvgpr_write_b32 a203, v125
    v_perm_b32 v124, v33, v32, s37
    v_accvgpr_write_b32 a196, v124
    v_perm_b32 v125, v33, v32, s38
    v_accvgpr_write_b32 a204, v125
    v_perm_b32 v124, v35, v34, s37
    v_accvgpr_write_b32 a197, v124
    v_perm_b32 v125, v35, v34, s38
    v_accvgpr_write_b32 a205, v125
    v_perm_b32 v124, v37, v36, s37
    v_accvgpr_write_b32 a198, v124
    v_perm_b32 v125, v37, v36, s38
    v_accvgpr_write_b32 a206, v125
    v_perm_b32 v124, v39, v38, s37
    v_accvgpr_write_b32 a199, v124
    v_perm_b32 v125, v39, v38, s38
    v_accvgpr_write_b32 a207, v125
    v_perm_b32 v124, v41, v40, s37
    v_accvgpr_write_b32 a208, v124
    v_perm_b32 v125, v41, v40, s38
    v_accvgpr_write_b32 a216, v125
    v_perm_b32 v124, v43, v42, s37
    v_accvgpr_write_b32 a209, v124
    v_perm_b32 v125, v43, v42, s38
    v_accvgpr_write_b32 a217, v125
    v_perm_b32 v124, v45, v44, s37
    v_accvgpr_write_b32 a210, v124
    v_perm_b32 v125, v45, v44, s38
    v_accvgpr_write_b32 a218, v125
    v_perm_b32 v124, v47, v46, s37
    v_accvgpr_write_b32 a211, v124
    v_perm_b32 v125, v47, v46, s38
    v_accvgpr_write_b32 a219, v125
    v_perm_b32 v124, v49, v48, s37
    v_accvgpr_write_b32 a212, v124
    v_perm_b32 v125, v49, v48, s38
    v_accvgpr_write_b32 a220, v125
    v_perm_b32 v124, v51, v50, s37
    v_accvgpr_write_b32 a213, v124
    v_perm_b32 v125, v51, v50, s38
    v_accvgpr_write_b32 a221, v125
    v_perm_b32 v124, v53, v52, s37
    v_accvgpr_write_b32 a214, v124
    v_perm_b32 v125, v53, v52, s38
    v_accvgpr_write_b32 a222, v125
    v_perm_b32 v124, v55, v54, s37
    v_accvgpr_write_b32 a215, v124
    v_perm_b32 v125, v55, v54, s38
    v_accvgpr_write_b32 a223, v125
    v_perm_b32 v124, v57, v56, s37
    v_accvgpr_write_b32 a224, v124
    v_perm_b32 v125, v57, v56, s38
    v_accvgpr_write_b32 a232, v125
    v_perm_b32 v124, v59, v58, s37
    v_accvgpr_write_b32 a225, v124
    v_perm_b32 v125, v59, v58, s38
    v_accvgpr_write_b32 a233, v125
    v_perm_b32 v124, v61, v60, s37
    v_accvgpr_write_b32 a226, v124
    v_perm_b32 v125, v61, v60, s38
    v_accvgpr_write_b32 a234, v125
    v_perm_b32 v124, v63, v62, s37
    v_accvgpr_write_b32 a227, v124
    v_perm_b32 v125, v63, v62, s38
    v_accvgpr_write_b32 a235, v125
    v_perm_b32 v124, v65, v64, s37
    v_accvgpr_write_b32 a228, v124
    v_perm_b32 v125, v65, v64, s38
    v_accvgpr_write_b32 a236, v125
    v_perm_b32 v124, v67, v66, s37
    v_accvgpr_write_b32 a229, v124
    v_perm_b32 v125, v67, v66, s38
    v_accvgpr_write_b32 a237, v125
    v_perm_b32 v124, v69, v68, s37
    v_accvgpr_write_b32 a230, v124
    v_perm_b32 v125, v69, v68, s38
    v_accvgpr_write_b32 a238, v125
    v_perm_b32 v124, v71, v70, s37
    v_accvgpr_write_b32 a231, v124
    v_perm_b32 v125, v71, v70, s38
    v_accvgpr_write_b32 a239, v125
    v_perm_b32 v124, v73, v72, s37
    v_accvgpr_write_b32 a240, v124
    v_perm_b32 v125, v73, v72, s38
    v_accvgpr_write_b32 a248, v125
    v_perm_b32 v124, v75, v74, s37
    v_accvgpr_write_b32 a241, v124
    v_perm_b32 v125, v75, v74, s38
    v_accvgpr_write_b32 a249, v125
    v_perm_b32 v124, v77, v76, s37
    v_accvgpr_write_b32 a242, v124
    v_perm_b32 v125, v77, v76, s38
    v_accvgpr_write_b32 a250, v125
    v_perm_b32 v124, v79, v78, s37
    v_accvgpr_write_b32 a243, v124
    v_perm_b32 v125, v79, v78, s38
    v_accvgpr_write_b32 a251, v125
    v_perm_b32 v124, v81, v80, s37
    v_accvgpr_write_b32 a244, v124
    v_perm_b32 v125, v81, v80, s38
    v_accvgpr_write_b32 a252, v125
    v_perm_b32 v124, v83, v82, s37
    v_accvgpr_write_b32 a245, v124
    v_perm_b32 v125, v83, v82, s38
    v_accvgpr_write_b32 a253, v125
    v_perm_b32 v124, v85, v84, s37
    v_accvgpr_write_b32 a246, v124
    v_perm_b32 v125, v85, v84, s38
    v_accvgpr_write_b32 a254, v125
    v_perm_b32 v124, v87, v86, s37
    v_accvgpr_write_b32 a247, v124
    v_perm_b32 v125, v87, v86, s38
    v_accvgpr_write_b32 a255, v125
    s_waitcnt vmcnt(17)
    s_barrier
    ds_read2st64_b32 v[24:25], v107 offset0:0 offset1:2
    ds_read2st64_b32 v[26:27], v107 offset0:4 offset1:6
    ds_read2st64_b32 v[28:29], v107 offset0:8 offset1:10
    ds_read2st64_b32 v[30:31], v107 offset0:12 offset1:14
    ds_read2st64_b32 v[32:33], v107 offset0:16 offset1:18
    ds_read2st64_b32 v[34:35], v107 offset0:20 offset1:22
    ds_read2st64_b32 v[36:37], v107 offset0:24 offset1:26
    ds_read2st64_b32 v[38:39], v107 offset0:28 offset1:30
    ds_read2st64_b32 v[40:41], v107 offset0:32 offset1:34
    ds_read2st64_b32 v[42:43], v107 offset0:36 offset1:38
    ds_read2st64_b32 v[44:45], v107 offset0:40 offset1:42
    ds_read2st64_b32 v[46:47], v107 offset0:44 offset1:46
    ds_read2st64_b32 v[48:49], v107 offset0:48 offset1:50
    ds_read2st64_b32 v[50:51], v107 offset0:52 offset1:54
    ds_read2st64_b32 v[52:53], v107 offset0:56 offset1:58
    ds_read2st64_b32 v[54:55], v107 offset0:60 offset1:62
    ds_read2st64_b32 v[56:57], v109 offset0:0 offset1:2
    ds_read2st64_b32 v[58:59], v109 offset0:4 offset1:6
    ds_read2st64_b32 v[60:61], v109 offset0:8 offset1:10
    ds_read2st64_b32 v[62:63], v109 offset0:12 offset1:14
    ds_read2st64_b32 v[64:65], v109 offset0:16 offset1:18
    ds_read2st64_b32 v[66:67], v109 offset0:20 offset1:22
    ds_read2st64_b32 v[68:69], v109 offset0:24 offset1:26
    ds_read2st64_b32 v[70:71], v109 offset0:28 offset1:30
    ds_read2st64_b32 v[72:73], v109 offset0:32 offset1:34
    ds_read2st64_b32 v[74:75], v109 offset0:36 offset1:38
    ds_read2st64_b32 v[76:77], v109 offset0:40 offset1:42
    ds_read2st64_b32 v[78:79], v109 offset0:44 offset1:46
    ds_read2st64_b32 v[80:81], v109 offset0:48 offset1:50
    ds_read2st64_b32 v[82:83], v109 offset0:52 offset1:54
    ds_read2st64_b32 v[84:85], v109 offset0:56 offset1:58
    ds_read2st64_b32 v[86:87], v109 offset0:60 offset1:62
    s_waitcnt lgkmcnt(0)
    s_barrier
    v_readfirstlane_b32 s63, v88
    s_nop 0
    s_cmp_ge_u32 s63, 256
    s_cbranch_scc1 L_r4
    v_mov_b32 v88, 128
    s_mov_b32 s60, 0
L_r4w:
    buffer_load_dword v89, v88, s[12:15], 0 offen sc1
    s_waitcnt vmcnt(0)
    v_readfirstlane_b32 s63, v89
    s_add_u32 s60, s60, 1
    s_cmp_ge_u32 s60, 3000000
    s_cbranch_scc1 L_fail
    s_cmp_lt_u32 s63, 256
    s_cbranch_scc1 L_r4w
L_r4:
    s_add_u32 m0, s54, 0
    s_add_u32 s51, s59, 0x0
    buffer_load_dwordx4 v0, s[8:11], s51 offen sc1 lds
    s_add_u32 m0, s54, 1024
    s_add_u32 s51, s59, 0x400
    buffer_load_dwordx4 v0, s[8:11], s51 offen sc1 lds
    s_add_u32 m0, s54, 2048
    s_add_u32 s51, s59, 0x800
    buffer_load_dwordx4 v0, s[8:11], s51 offen sc1 lds
    s_add_u32 m0, s54, 3072
    s_add_u32 s51, s59, 0xc00
    buffer_load_dwordx4 v0, s[8:11], s51 offen sc1 lds
    s_add_u32 m0, s54, 4096
    s_add_u32 s51, s59, 0x1000
    buffer_load_dwordx4 v0, s[8:11], s51 offen sc1 lds
    s_add_u32 m0, s54, 5120
    s_add_u32 s51, s59, 0x1400
    buffer_load_dwordx4 v0, s[8:11], s51 offen sc1 lds
    s_add_u32 m0, s54, 6144
    s_add_u32 s51, s59, 0x1800
    buffer_load_dwordx4 v0, s[8:11], s51 offen sc1 lds
    s_add_u32 m0, s54, 7168
    s_add_u32 s51, s59, 0x1c00
    buffer_load_dwordx4 v0, s[8:11], s51 offen sc1 lds
    s_add_u32 m0, s54, 8192
    s_add_u32 s51, s59, 0x2000
    buffer_load_dwordx4 v0, s[8:11], s51 offen sc1 lds
    s_add_u32 m0, s54, 9216
    s_add_u32 s51, s59, 0x2400
    buffer_load_dwordx4 v0, s[8:11], s51 offen sc1 lds
    s_add_u32 m0, s54, 10240
    s_add_u32 s51, s59, 0x2800
    buffer_load_dwordx4 v0, s[8:11], s51 offen sc1 lds
    s_add_u32 m0, s54, 11264
    s_add_u32 s51, s59, 0x2c00
    buffer_load_dwordx4 v0, s[8:11], s51 offen sc1 lds
    s_add_u32 m0, s54, 12288
    s_add_u32 s51, s59, 0x3000
    buffer_load_dwordx4 v0, s[8:11], s51 offen sc1 lds
    s_add_u32 m0, s54, 13312
    s_add_u32 s51, s59, 0x3400
    buffer_load_dwordx4 v0, s[8:11], s51 offen sc1 lds
    s_add_u32 m0, s54, 14336
    s_add_u32 s51, s59, 0x3800
    buffer_load_dwordx4 v0, s[8:11], s51 offen sc1 lds
    s_add_u32 m0, s54, 15360
    s_add_u32 s51, s59, 0x3c00
    buffer_load_dwordx4 v0, s[8:11], s51 offen sc1 lds
    v_perm_b32 v128, v25, v24, s37
    v_perm_b32 v136, v25, v24, s38
    v_perm_b32 v129, v27, v26, s37
    v_perm_b32 v137, v27, v26, s38
    v_perm_b32 v130, v29, v28, s37
    v_perm_b32 v138, v29, v28, s38
    v_perm_b32 v131, v31, v30, s37
    v_perm_b32 v139, v31, v30, s38
    v_perm_b32 v132, v33, v32, s37
    v_perm_b32 v140, v33, v32, s38
    v_perm_b32 v133, v35, v34, s37
    v_perm_b32 v141, v35, v34, s38
    v_perm_b32 v134, v37, v36, s37
    v_perm_b32 v142, v37, v36, s38
    v_perm_b32 v135, v39, v38, s37
    v_perm_b32 v143, v39, v38, s38
    v_perm_b32 v144, v41, v40, s37
    v_perm_b32 v152, v41, v40, s38
    v_perm_b32 v145, v43, v42, s37
    v_perm_b32 v153, v43, v42, s38
    v_perm_b32 v146, v45, v44, s37
    v_perm_b32 v154, v45, v44, s38
    v_perm_b32 v147, v47, v46, s37
    v_perm_b32 v155, v47, v46, s38
    v_perm_b32 v148, v49, v48, s37
    v_perm_b32 v156, v49, v48, s38
    v_perm_b32 v149, v51, v50, s37
    v_perm_b32 v157, v51, v50, s38
    v_perm_b32 v150, v53, v52, s37
    v_perm_b32 v158, v53, v52, s38
    v_perm_b32 v151, v55, v54, s37
    v_perm_b32 v159, v55, v54, s38
    v_perm_b32 v160, v57, v56, s37
    v_perm_b32 v168, v57, v56, s38
    v_perm_b32 v161, v59, v58, s37
    v_perm_b32 v169, v59, v58, s38
    v_perm_b32 v162, v61, v60, s37
    v_perm_b32 v170, v61, v60, s38
    v_perm_b32 v163, v63, v62, s37
    v_perm_b32 v171, v63, v62, s38
    v_perm_b32 v164, v65, v64, s37
    v_perm_b32 v172, v65, v64, s38
    v_perm_b32 v165, v67, v66, s37
    v_perm_b32 v173, v67, v66, s38
    v_perm_b32 v166, v69, v68, s37
    v_perm_b32 v174, v69, v68, s38
    v_perm_b32 v167, v71, v70, s37
    v_perm_b32 v175, v71, v70, s38
    v_perm_b32 v176, v73, v72, s37
    v_perm_b32 v184, v73, v72, s38
    v_perm_b32 v177, v75, v74, s37
    v_perm_b32 v185, v75, v74, s38
    v_perm_b32 v178, v77, v76, s37
    v_perm_b32 v186, v77, v76, s38
    v_perm_b32 v179, v79, v78, s37
    v_perm_b32 v187, v79, v78, s38
    v_perm_b32 v180, v81, v80, s37
    v_perm_b32 v188, v81, v80, s38
    v_perm_b32 v181, v83, v82, s37
    v_perm_b32 v189, v83, v82, s38
    v_perm_b32 v182, v85, v84, s37
    v_perm_b32 v190, v85, v84, s38
    v_perm_b32 v183, v87, v86, s37
    v_perm_b32 v191, v87, v86, s38
    s_waitcnt vmcnt(16)
    s_barrier
    ds_read2st64_b32 v[24:25], v107 offset0:128 offset1:130
    ds_read2st64_b32 v[26:27], v107 offset0:132 offset1:134
    ds_read2st64_b32 v[28:29], v107 offset0:136 offset1:138
    ds_read2st64_b32 v[30:31], v107 offset0:140 offset1:142
    ds_read2st64_b32 v[32:33], v107 offset0:144 offset1:146
    ds_read2st64_b32 v[34:35], v107 offset0:148 offset1:150
    ds_read2st64_b32 v[36:37], v107 offset0:152 offset1:154
    ds_read2st64_b32 v[38:39], v107 offset0:156 offset1:158
    ds_read2st64_b32 v[40:41], v107 offset0:160 offset1:162
    ds_read2st64_b32 v[42:43], v107 offset0:164 offset1:166
    ds_read2st64_b32 v[44:45], v107 offset0:168 offset1:170
    ds_read2st64_b32 v[46:47], v107 offset0:172 offset1:174
    ds_read2st64_b32 v[48:49], v107 offset0:176 offset1:178
    ds_read2st64_b32 v[50:51], v107 offset0:180 offset1:182
    ds_read2st64_b32 v[52:53], v107 offset0:184 offset1:186
    ds_read2st64_b32 v[54:55], v107 offset0:188 offset1:190
    ds_read2st64_b32 v[56:57], v109 offset0:128 offset1:130
    ds_read2st64_b32 v[58:59], v109 offset0:132 offset1:134
    ds_read2st64_b32 v[60:61], v109 offset0:136 offset1:138
    ds_read2st64_b32 v[62:63], v109 offset0:140 offset1:142
    ds_read2st64_b32 v[64:65], v109 offset0:144 offset1:146
    ds_read2st64_b32 v[66:67], v109 offset0:148 offset1:150
    ds_read2st64_b32 v[68:69], v109 offset0:152 offset1:154
    ds_read2st64_b32 v[70:71], v109 offset0:156 offset1:158
    ds_read2st64_b32 v[72:73], v109 offset0:160 offset1:162
    ds_read2st64_b32 v[74:75], v109 offset0:164 offset1:166
    ds_read2st64_b32 v[76:77], v109 offset0:168 offset1:170
    ds_read2st64_b32 v[78:79], v109 offset0:172 offset1:174
    ds_read2st64_b32 v[80:81], v109 offset0:176 offset1:178
    ds_read2st64_b32 v[82:83], v109 offset0:180 offset1:182
    ds_read2st64_b32 v[84:85], v109 offset0:184 offset1:186
    ds_read2st64_b32 v[86:87], v109 offset0:188 offset1:190
    s_waitcnt lgkmcnt(0)
    s_barrier
    v_bfe_u32 v91, v0, 4, 3
    v_min_u32 v91, 5, v91
    v_bfe_u32 v89, v0, 7, 1
    v_lshl_add_u32 v89, v89, 3, v91
    v_lshlrev_b32 v89, 2, v89
    v_lshrrev_b32 v93, 2, v0
    v_add_u32 v93, 96, v93
    v_cmp_ge_u32 vcc, 128, v93
    s_nop 1
    v_cndmask_b32 v93, 0, v93, vcc
    buffer_load_dword v90, v89, s[8:11], s6 offen sc1
    buffer_load_dword v92, v93, s[12:15], 0 offen sc1
    s_add_u32 m0, s54, 32768
    s_add_u32 s51, s59, 0x4000
    buffer_load_dwordx4 v0, s[8:11], s51 offen sc1 lds
    s_add_u32 m0, s54, 33792
    s_add_u32 s51, s59, 0x4400
    buffer_load_dwordx4 v0, s[8:11], s51 offen sc1 lds
    s_add_u32 m0, s54, 34816
    s_add_u32 s51, s59, 0x4800
    buffer_load_dwordx4 v0, s[8:11], s51 offen sc1 lds
    s_add_u32 m0, s54, 35840
    s_add_u32 s51, s59, 0x4c00
    buffer_load_dwordx4 v0, s[8:11], s51 offen sc1 lds
    s_add_u32 m0, s54, 36864
    s_add_u32 s51, s59, 0x5000
    buffer_load_dwordx4 v0, s[8:11], s51 offen sc1 lds
    s_add_u32 m0, s54, 37888
    s_add_u32 s51, s59, 0x5400
    buffer_load_dwordx4 v0, s[8:11], s51 offen sc1 lds
    s_add_u32 m0, s54, 38912
    s_add_u32 s51, s59, 0x5800
    buffer_load_dwordx4 v0, s[8:11], s51 offen sc1 lds
    s_add_u32 m0, s54, 39936
    s_add_u32 s51, s59, 0x5c00
    buffer_load_dwordx4 v0, s[8:11], s51 offen sc1 lds
    s_add_u32 m0, s54, 40960
    s_add_u32 s51, s59, 0x6000
    buffer_load_dwordx4 v0, s[8:11], s51 offen sc1 lds
    s_add_u32 m0, s54, 41984
    s_add_u32 s51, s59, 0x6400
    buffer_load_dwordx4 v0, s[8:11], s51 offen sc1 lds
    s_add_u32 m0, s54, 43008
    s_add_u32 s51, s59, 0x6800
    buffer_load_dwordx4 v0, s[8:11], s51 offen sc1 lds
    s_add_u32 m0, s54, 44032
    s_add_u32 s51, s59, 0x6c00
    buffer_load_dwordx4 v0, s[8:11], s51 offen sc1 lds
    s_add_u32 m0, s54, 45056
    s_add_u32 s51, s59, 0x7000
    buffer_load_dwordx4 v0, s[8:11], s51 offen sc1 lds
    s_add_u32 m0, s54, 46080
    s_add_u32 s51, s59, 0x7400
    buffer_load_dwordx4 v0, s[8:11], s51 offen sc1 lds
    s_add_u32 m0, s54, 47104
    s_add_u32 s51, s59, 0x7800
    buffer_load_dwordx4 v0, s[8:11], s51 offen sc1 lds
    s_add_u32 m0, s54, 48128
    s_add_u32 s51, s59, 0x7c00
    buffer_load_dwordx4 v0, s[8:11], s51 offen sc1 lds
    s_and_b32 s52, s5, 3
    s_lshl_b32 s52, s52, 11
    s_mul_i32 s50, s4, 0x10000
    s_add_u32 s52, s52, s50
    s_add_u32 s52, s52, 0x100000
    s_xor_b32 s50, s56, 0x40000
    buffer_load_dwordx4 v[112:115], v0, s[8:11], s52 offen offset:0 sc1
    buffer_load_dwordx4 v[112:115], v0, s[8:11], s52 offen offset:1024 sc1
    buffer_load_dwordx4 v[112:115], v0, s[8:11], s56 offen offset:0 sc1
    buffer_load_dwordx4 v[112:115], v0, s[8:11], s56 offen offset:1024 sc1
    buffer_load_dwordx4 v[112:115], v0, s[8:11], s50 offen offset:0 sc1
    buffer_load_dwordx4 v[112:115], v0, s[8:11], s50 offen offset:1024 sc1
    s_getpc_b64 s[64:65]
    s_and_b32 s64, s64, 0xffffff80
    v_lshlrev_b32 v96, 3, v0
    s_lshl_b32 s63, s4, 13
    v_add_u32 v96, s63, v96
    global_load_dword v97, v96, s[64:65]
    v_perm_b32 v192, v25, v24, s37
    v_perm_b32 v200, v25, v24, s38
    v_perm_b32 v193, v27, v26, s37
    v_perm_b32 v201, v27, v26, s38
    v_perm_b32 v194, v29, v28, s37
    v_perm_b32 v202, v29, v28, s38
    v_perm_b32 v195, v31, v30, s37
    v_perm_b32 v203, v31, v30, s38
    v_perm_b32 v196, v33, v32, s37
    v_perm_b32 v204, v33, v32, s38
    v_perm_b32 v197, v35, v34, s37
    v_perm_b32 v205, v35, v34, s38
    v_perm_b32 v198, v37, v36, s37
    v_perm_b32 v206, v37, v36, s38
    v_perm_b32 v199, v39, v38, s37
    v_perm_b32 v207, v39, v38, s38
    v_perm_b32 v208, v41, v40, s37
    v_perm_b32 v216, v41, v40, s38
    v_perm_b32 v209, v43, v42, s37
    v_perm_b32 v217, v43, v42, s38
    v_perm_b32 v210, v45, v44, s37
    v_perm_b32 v218, v45, v44, s38
    v_perm_b32 v211, v47, v46, s37
    v_perm_b32 v219, v47, v46, s38
    v_perm_b32 v212, v49, v48, s37
    v_perm_b32 v220, v49, v48, s38
    v_perm_b32 v213, v51, v50, s37
    v_perm_b32 v221, v51, v50, s38
    v_perm_b32 v214, v53, v52, s37
    v_perm_b32 v222, v53, v52, s38
    v_perm_b32 v215, v55, v54, s37
    v_perm_b32 v223, v55, v54, s38
    v_perm_b32 v224, v57, v56, s37
    v_perm_b32 v232, v57, v56, s38
    v_perm_b32 v225, v59, v58, s37
    v_perm_b32 v233, v59, v58, s38
    v_perm_b32 v226, v61, v60, s37
    v_perm_b32 v234, v61, v60, s38
    v_perm_b32 v227, v63, v62, s37
    v_perm_b32 v235, v63, v62, s38
    v_perm_b32 v228, v65, v64, s37
    v_perm_b32 v236, v65, v64, s38
    v_perm_b32 v229, v67, v66, s37
    v_perm_b32 v237, v67, v66, s38
    v_perm_b32 v230, v69, v68, s37
    v_perm_b32 v238, v69, v68, s38
    v_perm_b32 v231, v71, v70, s37
    v_perm_b32 v239, v71, v70, s38
    v_perm_b32 v240, v73, v72, s37
    v_perm_b32 v248, v73, v72, s38
    v_perm_b32 v241, v75, v74, s37
    v_perm_b32 v249, v75, v74, s38
    v_perm_b32 v242, v77, v76, s37
    v_perm_b32 v250, v77, v76, s38
    v_perm_b32 v243, v79, v78, s37
    v_perm_b32 v251, v79, v78, s38
    v_perm_b32 v244, v81, v80, s37
    v_perm_b32 v252, v81, v80, s38
    v_perm_b32 v245, v83, v82, s37
    v_perm_b32 v253, v83, v82, s38
    v_perm_b32 v246, v85, v84, s37
    v_perm_b32 v254, v85, v84, s38
    v_perm_b32 v247, v87, v86, s37
    v_perm_b32 v255, v87, v86, s38
    s_waitcnt vmcnt(23)
    v_mad_u32_u24 v90, v90, 6, v91
    s_nop 1
    v_min_u32_dpp v90, v90, v90 row_ror:8 row_mask:0xf bank_mask:0xf
    s_nop 1
    v_min_u32_dpp v90, v90, v90 row_ror:4 row_mask:0xf bank_mask:0xf
    s_nop 1
    v_min_u32_dpp v90, v90, v90 row_ror:2 row_mask:0xf bank_mask:0xf
    s_nop 1
    v_min_u32_dpp v90, v90, v90 row_ror:1 row_mask:0xf bank_mask:0xf
    s_nop 0
    v_readfirstlane_b32 s7, v90
    v_readlane_b32 s61, v92, 9
    v_readlane_b32 s63, v92, 8
    v_cmp_ne_u32 vcc, 0x01010101, v92
    s_cmp_ge_u32 s63, 256
    s_cselect_b32 s60, 1, 0
    s_and_b32 s63, vcc_lo, 0xff
    s_cselect_b32 s60, 0, s60
    s_cmp_ge_u32 s7, 3
    s_cselect_b32 s62, s60, 0
    s_cmp_eq_u32 s62, 0
    s_cbranch_scc1 L_h6n
    s_mov_b32 s54, 131072
    s_mov_b32 s59, 131072
    s_add_u32 m0, s48, s59
    s_add_u32 s46, s46, 0x0
    buffer_load_dwordx4 v0, s[8:11], s46 offen sc1 lds
    buffer_load_dwordx4 v0, s[8:11], s46 offen offset:1024 sc1 lds
    s_mov_b32 m0, s57
    s_add_u32 s52, s46, 0x1000000
    buffer_load_dwordx4 v0, s[8:11], s52 offen sc1 lds
    buffer_load_dwordx4 v0, s[8:11], s52 offen offset:1024 sc1 lds
    s_mov_b32 s59, 139328
    s_add_u32 m0, s48, s59
    s_add_u32 s46, s46, 0x40000
    buffer_load_dwordx4 v0, s[8:11], s46 offen sc1 lds
    buffer_load_dwordx4 v0, s[8:11], s46 offen offset:1024 sc1 lds
    s_branch L_h6e
L_h6n:
    buffer_load_dword v90, v89, s[8:11], s6 offen sc1
    buffer_load_dword v92, v93, s[12:15], 0 offen sc1
L_h6e:
    s_waitcnt vmcnt(0)
    s_cmp_eq_u32 s62, 1
    s_cbranch_scc1 L_pre
    s_mov_b32 s49, 0
    s_branch L_st1
L_st0:
    buffer_load_dword v90, v89, s[8:11], s6 offen sc1
    buffer_load_dword v92, v93, s[12:15], 0 offen sc1
    s_add_u32 s49, s49, 1
    s_cmp_ge_u32 s49, 3000000
    s_cbranch_scc1 L_fail
L_st1:
    s_waitcnt vmcnt(0)
    v_mad_u32_u24 v90, v90, 6, v91
    s_nop 1
    v_min_u32_dpp v90, v90, v90 row_ror:8 row_mask:0xf bank_mask:0xf
    s_nop 1
    v_min_u32_dpp v90, v90, v90 row_ror:4 row_mask:0xf bank_mask:0xf
    s_nop 1
    v_min_u32_dpp v90, v90, v90 row_ror:2 row_mask:0xf bank_mask:0xf
    s_nop 1
    v_min_u32_dpp v90, v90, v90 row_ror:1 row_mask:0xf bank_mask:0xf
    s_nop 0
    v_readfirstlane_b32 s7, v90
    v_readlane_b32 s61, v92, 9
    v_readlane_b32 s63, v92, 8
    v_cmp_ne_u32 vcc, 0x01010101, v92
    s_cmp_ge_u32 s63, 256
    s_cselect_b32 s60, 1, 0
    s_and_b32 s63, vcc_lo, 0xff
    s_cselect_b32 s60, 0, s60
    s_cmp_ge_u32 s7, 3
    s_cselect_b32 s62, s60, 0
    s_cmp_eq_u32 s62, 0
    s_cbranch_scc1 L_st0
    s_mov_b32 s54, 131072
    s_mov_b32 s59, 131072
    s_add_u32 m0, s48, s59
    s_add_u32 s46, s46, 0x0
    buffer_load_dwordx4 v0, s[8:11], s46 offen sc1 lds
    buffer_load_dwordx4 v0, s[8:11], s46 offen offset:1024 sc1 lds
    s_mov_b32 m0, s57
    s_add_u32 s52, s46, 0x1000000
    buffer_load_dwordx4 v0, s[8:11], s52 offen sc1 lds
    buffer_load_dwordx4 v0, s[8:11], s52 offen offset:1024 sc1 lds
    s_mov_b32 s59, 139328
    s_add_u32 m0, s48, s59
    s_add_u32 s46, s46, 0x40000
    buffer_load_dwordx4 v0, s[8:11], s46 offen sc1 lds
    buffer_load_dwordx4 v0, s[8:11], s46 offen offset:1024 sc1 lds
L_pre:
    s_lshl_b32 s53, s5, 2
    s_add_u32 s53, s53, 2048
    v_and_b32 v61, 0x310, v0
    v_and_b32 v62, 0x60, v0
    v_lshl_add_u32 v61, v62, 1, v61
    v_bfe_u32 v62, v0, 7, 1
    v_mul_u32_u24 v62, 4128, v62
    v_add3_u32 v61, v61, v62, s54
    v_mov_b64 v[104:105], 0
    v_mov_b64 v[106:107], 0
    v_mov_b64 v[108:109], 0
    v_mov_b64 v[110:111], 0
    v_mov_b64 v[112:113], 0
    v_mov_b64 v[114:115], 0
    v_mov_b64 v[116:117], 0
    v_mov_b64 v[118:119], 0
    v_mov_b64 v[120:121], 0
    v_mov_b64 v[122:123], 0
    v_mov_b64 v[124:125], 0
    v_mov_b64 v[126:127], 0
    s_waitcnt vmcnt(0)
    s_barrier
    v_add_u32 v63, s57, v0
    v_mov_b32 v27, 0
    v_mov_b32 v31, 0
    v_mov_b32 v35, 0
    v_mov_b32 v39, 0
    ds_read_b128 v[72:75], v61 offset:0
    ds_read_b128 v[76:79], v61 offset:1024
    ds_read_b128 v[80:83], v61 offset:2048
    ds_read_b128 v[84:87], v61 offset:3072
    ds_read_b128 v[88:91], v61 offset:32
    ds_read_b128 v[92:95], v61 offset:1056
    ds_read_b128 v[96:99], v61 offset:2080
    ds_read_b128 v[100:103], v61 offset:3104
    ds_read_b64 v[24:25], v63 offset:0
    ds_read_b64 v[28:29], v63 offset:8
    ds_read_b64 v[32:33], v63 offset:1024
    ds_read_b64 v[36:37], v63 offset:1032
    s_mov_b32 s54, 139328
    s_mov_b32 s59, 131072
    s_waitcnt lgkmcnt(0)
    s_cmp_lt_u32 s61, 32
    s_cbranch_scc1 L_tslow
    s_cmp_eq_u32 s4, 0
    s_cbranch_scc1 T_full0
    s_cmp_eq_u32 s4, 1
    s_cbranch_scc1 T_full1
    s_cmp_eq_u32 s4, 2
    s_cbranch_scc1 T_full2
    s_mov_b32 s49, 0
    buffer_load_dwordx4 v[40:43], v0, s[8:11], s41 offen sc1
    buffer_load_dwordx4 v[44:47], v0, s[8:11], s41 offen offset:1024 sc1
    s_add_u32 s58, s41, 0x1000
    s_waitcnt vmcnt(0)
.p2align 6
    s_nop 0
    s_nop 0
T3_p2ok:
    buffer_load_dwordx4 v[48:51], v0, s[8:11], s41 offen offset:2048 sc1
    buffer_load_dwordx4 v[52:55], v0, s[8:11], s41 offen offset:3072 sc1
T3_p2go:
    buffer_load_dwordx4 v[56:59], v0, s[8:11], s58 offen offset:0 sc1
    s_waitcnt lgkmcnt(1)
    v_smfmac_f32_16x16x64_bf16 v[104:107], v[40:43], a[0:7], v1
    s_xor_b32 s45, s56, 0x40000
    v_smfmac_f32_16x16x64_bf16 v[108:111], v[40:43], a[8:15], v1
    s_waitcnt lgkmcnt(0)
    v_smfmac_f32_16x16x64_bf16 v[104:107], v[44:47], a[16:23], v1
    buffer_load_dwordx4 v[60:63], v0, s[8:11], s58 offen offset:1024 sc1
    v_smfmac_f32_16x16x64_bf16 v[108:111], v[44:47], a[24:31], v1
    s_add_u32 s37, s44, 0x1000
    v_mov_b32 v26, v9
    v_smfmac_f32_16x16x64_bf16 v[112:115], v[40:43], a[128:135], v1
    v_smfmac_f32_16x16x64_bf16 v[116:119], v[40:43], a[136:143], v1
    buffer_load_dwordx4 v[64:67], v0, s[8:11], s58 offen offset:2048 sc1
    v_mov_b32_dpp v26, v9 row_shl:4 row_mask:0xf bank_mask:0x2
    v_smfmac_f32_16x16x64_bf16 v[112:115], v[44:47], a[144:151], v1
    v_smfmac_f32_16x16x64_bf16 v[116:119], v[44:47], a[152:159], v1
    v_mov_b32_dpp v26, v9 row_shr:4 row_mask:0xf bank_mask:0x4
    v_smfmac_f32_16x16x64_bf16 v[120:123], v[40:43], v[128:135], v1
    buffer_load_dwordx4 v[68:71], v0, s[8:11], s58 offen offset:3072 sc1
    v_smfmac_f32_16x16x64_bf16 v[124:127], v[40:43], v[136:143], v1
    v_smfmac_f32_16x16x64_bf16 v[120:123], v[44:47], v[144:151], v1
    v_subrev_u32 v38, 4608, v8
    v_smfmac_f32_16x16x64_bf16 v[124:127], v[44:47], v[152:159], v1
    s_waitcnt vmcnt(5)
    v_smfmac_f32_16x16x64_bf16 v[104:107], v[48:51], a[32:39], v1
    v_max_u32 v34, v48, v49
    v_smfmac_f32_16x16x64_bf16 v[108:111], v[48:51], a[40:47], v1
    s_mov_b32 m0, s57
    s_add_u32 s52, s46, 0x1000000
    v_max3_u32 v34, v34, v50, v51
    v_smfmac_f32_16x16x64_bf16 v[112:115], v[48:51], a[160:167], v1
    buffer_load_dwordx4 v0, s[8:11], s52 offen sc1 lds
    v_smfmac_f32_16x16x64_bf16 v[116:119], v[48:51], a[168:175], v1
    s_waitcnt vmcnt(5)
    v_smfmac_f32_16x16x64_bf16 v[104:107], v[52:55], a[48:55], v1
    v_max3_u32 v34, v34, v52, v53
    v_smfmac_f32_16x16x64_bf16 v[108:111], v[52:55], a[56:63], v1
    v_max3_u32 v34, v34, v54, v55
    v_smfmac_f32_16x16x64_bf16 v[112:115], v[52:55], a[176:183], v1
    buffer_load_dwordx4 v0, s[8:11], s52 offen offset:1024 sc1 lds
    v_smfmac_f32_16x16x64_bf16 v[116:119], v[52:55], a[184:191], v1
    s_waitcnt vmcnt(5)
    v_smfmac_f32_16x16x64_bf16 v[104:107], v[56:59], a[64:71], v1
    v_max3_u32 v34, v34, v56, v57
    v_smfmac_f32_16x16x64_bf16 v[108:111], v[56:59], a[72:79], v1
    s_add_u32 m0, s48, s59
    s_add_u32 s38, s46, 0x40000
    v_max3_u32 v34, v34, v58, v59
    v_smfmac_f32_16x16x64_bf16 v[112:115], v[56:59], a[192:199], v1
    buffer_load_dwordx4 v0, s[8:11], s38 offen sc1 lds
    v_smfmac_f32_16x16x64_bf16 v[116:119], v[56:59], a[200:207], v1
    s_waitcnt vmcnt(5)
    v_smfmac_f32_16x16x64_bf16 v[104:107], v[60:63], a[80:87], v1
    buffer_store_dwordx4 v[2:5], v0, s[8:11], s45 offen offset:0
    v_max3_u32 v34, v34, v60, v61
    v_smfmac_f32_16x16x64_bf16 v[108:111], v[60:63], a[88:95], v1
    v_max3_u32 v34, v34, v62, v63
    v_smfmac_f32_16x16x64_bf16 v[112:115], v[60:63], a[208:215], v1
    buffer_load_dwordx4 v0, s[8:11], s38 offen offset:1024 sc1 lds
    v_smfmac_f32_16x16x64_bf16 v[116:119], v[60:63], a[216:223], v1
    s_waitcnt vmcnt(6)
    v_smfmac_f32_16x16x64_bf16 v[104:107], v[64:67], a[96:103], v1
    v_max3_u32 v34, v34, v64, v65
    v_smfmac_f32_16x16x64_bf16 v[108:111], v[64:67], a[104:111], v1
    v_max3_u32 v34, v34, v66, v67
    v_smfmac_f32_16x16x64_bf16 v[112:115], v[64:67], a[224:231], v1
    buffer_store_dwordx4 v[2:5], v0, s[8:11], s45 offen offset:1024
    v_smfmac_f32_16x16x64_bf16 v[116:119], v[64:67], a[232:239], v1
    s_waitcnt vmcnt(6)
    v_subrev_u32 v30, 2304, v8
    v_smfmac_f32_16x16x64_bf16 v[104:107], v[68:71], a[112:119], v1
    v_max3_u32 v34, v34, v68, v69
    v_smfmac_f32_16x16x64_bf16 v[108:111], v[68:71], a[120:127], v1
    s_nop 1
    v_max3_u32 v34, v34, v70, v71
    v_smfmac_f32_16x16x64_bf16 v[112:115], v[68:71], a[240:247], v1
    v_cmp_eq_u32 vcc, s36, v34
    v_smfmac_f32_16x16x64_bf16 v[116:119], v[68:71], a[248:255], v1
    v_add_f32 v104, v104, v106
    v_add_f32 v105, v105, v107
    v_add_f32 v108, v108, v110
    v_add_f32 v109, v109, v111
    v_smfmac_f32_16x16x64_bf16 v[120:123], v[48:51], v[160:167], v1
    s_cbranch_vccnz T3_redo
    buffer_store_dwordx4 v[12:15], v0, s[8:11], s47 offen sc1
    v_cvt_pk_bf16_f32 v106, v104, v108
    v_cvt_pk_bf16_f32 v107, v105, v109
    v_smfmac_f32_16x16x64_bf16 v[124:127], v[48:51], v[168:175], v1
    ds_write2_b32 v38, v106, v107 offset0:0 offset1:72
    v_add_f32 v112, v112, v114
    v_add_f32 v113, v113, v115
    v_add_f32 v116, v116, v118
    v_add_f32 v117, v117, v119
    v_smfmac_f32_16x16x64_bf16 v[120:123], v[52:55], v[176:183], v1
    v_cvt_pk_bf16_f32 v12, v112, v116
    v_cvt_pk_bf16_f32 v13, v113, v117
    v_smfmac_f32_16x16x64_bf16 v[124:127], v[52:55], v[184:191], v1
    ds_write2_b32 v30, v12, v13 offset0:0 offset1:72
    v_smfmac_f32_16x16x64_bf16 v[120:123], v[56:59], v[192:199], v1
    v_smfmac_f32_16x16x64_bf16 v[124:127], v[56:59], v[200:207], v1
    buffer_store_dword v2, v7, s[8:11], s43 offen
    v_smfmac_f32_16x16x64_bf16 v[120:123], v[60:63], v[208:215], v1
    s_mov_b32 s46, s38
    v_smfmac_f32_16x16x64_bf16 v[124:127], v[60:63], v[216:223], v1
    s_waitcnt lgkmcnt(0)
    s_barrier
    ds_read_b128 v[40:43], v9 offset:0
    v_smfmac_f32_16x16x64_bf16 v[120:123], v[64:67], v[224:231], v1
    ds_read_b128 v[44:47], v9 offset:64
    ds_read_b128 v[48:51], v9 offset:128
    v_smfmac_f32_16x16x64_bf16 v[124:127], v[64:67], v[232:239], v1
    ds_read_b128 v[52:55], v9 offset:192
    v_smfmac_f32_16x16x64_bf16 v[120:123], v[68:71], v[240:247], v1
    s_cmp_eq_u32 s40, 63
    v_smfmac_f32_16x16x64_bf16 v[124:127], v[68:71], v[248:255], v1
    ds_read_b128 v[56:59], v26 offset:2304
    s_waitcnt lgkmcnt(4)
    v_mfma_f32_16x16x32_bf16 v[104:107], v[72:75], v[40:43], 0
    ds_read_b128 v[60:63], v26 offset:2368
    ds_read_b128 v[64:67], v26 offset:2432
    v_mfma_f32_16x16x32_bf16 v[108:111], v[88:91], v[40:43], 0
    ds_read_b128 v[68:71], v26 offset:2496
    s_waitcnt lgkmcnt(4)
    v_mfma_f32_16x16x32_bf16 v[104:107], v[76:79], v[44:47], v[104:107]
    v_add_f32 v120, v120, v122
    v_add_f32 v121, v121, v123
    v_mfma_f32_16x16x32_bf16 v[108:111], v[92:95], v[44:47], v[108:111]
    v_add_f32 v124, v124, v126
    v_add_f32 v125, v125, v127
    v_mfma_f32_16x16x32_bf16 v[104:107], v[80:83], v[48:51], v[104:107]
    ds_read_b128 v[72:75], v11 offset:8192
    v_cvt_pk_bf16_f32 v14, v120, v121
    v_cvt_pk_bf16_f32 v15, v124, v125
    v_mfma_f32_16x16x32_bf16 v[108:111], v[96:99], v[48:51], v[108:111]
    ds_read_b128 v[88:91], v11 offset:2048
    s_cbranch_scc1 T3_fin
    v_cndmask_b32 v26, 0, v14, s[34:35]
    v_mfma_f32_16x16x32_bf16 v[104:107], v[84:87], v[52:55], v[104:107]
    ds_read_b128 v[76:79], v11 offset:12288
    v_cndmask_b32 v30, v14, 0, s[34:35]
    v_mfma_f32_16x16x32_bf16 v[108:111], v[100:103], v[52:55], v[108:111]
    ds_read_b128 v[92:95], v11 offset:6144
    s_waitcnt lgkmcnt(3)
    v_cndmask_b32 v34, 0, v15, s[34:35]
    v_cndmask_b32 v38, v15, 0, s[34:35]
    v_mfma_f32_16x16x32_bf16 v[112:115], v[56:59], v[40:43], 0
    ds_read_b128 v[80:83], v11 offset:9216
    v_mov_b64 v[120:121], 0
    v_mov_b64 v[122:123], 0
    v_mfma_f32_16x16x32_bf16 v[112:115], v[60:63], v[44:47], v[112:115]
    ds_read_b128 v[96:99], v11 offset:3072
    v_mov_b64 v[124:125], 0
    v_mov_b64 v[126:127], 0
    v_mfma_f32_16x16x32_bf16 v[112:115], v[64:67], v[48:51], v[112:115]
    ds_read_b128 v[84:87], v11 offset:13312
    v_max3_f32 v116, v104, v105, v106
    v_max3_f32 v117, v108, v109, v110
    v_mfma_f32_16x16x32_bf16 v[112:115], v[68:71], v[52:55], v[112:115]
    ds_read_b128 v[100:103], v11 offset:7168
    v_max3_f32 v116, v116, v107, v111
    v_max_f32 v116, v116, v117
    v_cndmask_b32 v104, v104, v108, s[32:33]
    v_cndmask_b32 v105, v105, v109, s[32:33]
    v_cndmask_b32 v106, v106, v110, s[32:33]
    v_cndmask_b32 v107, v107, v111, s[32:33]
    s_nop 0
    v_max3_f32 v114, v116, v112, v113
    v_max3_f32 v115, v116, v112, v113
    ds_read_b128 v[48:51], v11 offset:0
    s_nop 0
    v_permlane32_swap_b32 v114, v115
    v_max_f32 v116, v114, v115
    v_max_f32 v117, v114, v115
    ds_read_b128 v[52:55], v11 offset:4096
    s_nop 0
    v_permlane16_swap_b32 v116, v117
    v_max_f32 v114, v116, v117
    v_pk_add_f32 v[104:105], v[104:105], v[114:115] op_sel_hi:[1,0] neg_lo:[0,1] neg_hi:[0,1]
    v_pk_add_f32 v[106:107], v[106:107], v[114:115] op_sel_hi:[1,0] neg_lo:[0,1] neg_hi:[0,1]
    v_pk_add_f32 v[112:113], v[112:113], v[114:115] op_sel_hi:[1,0] neg_lo:[0,1] neg_hi:[0,1]
    v_pk_mul_f32 v[104:105], v[104:105], s[38:39] op_sel:[0,1] op_sel_hi:[1,1]
    v_pk_mul_f32 v[106:107], v[106:107], s[38:39] op_sel:[0,1] op_sel_hi:[1,1]
    v_pk_mul_f32 v[112:113], v[112:113], s[38:39] op_sel:[0,1] op_sel_hi:[1,1]
    v_exp_f32 v104, v104
    v_exp_f32 v105, v105
    v_exp_f32 v106, v106
    v_exp_f32 v107, v107
    v_exp_f32 v112, v112
    v_exp_f32 v113, v113
    v_cvt_pk_bf16_f32 v116, v104, v105
    v_cvt_pk_bf16_f32 v118, v106, v107
    v_cvt_pk_bf16_f32 v117, v112, v113
    v_cvt_pk_bf16_f32 v119, v112, v113
    ds_read_b128 v[40:43], v11 offset:1024
    v_mov_b64 v[104:105], 0
    v_mfma_f32_16x16x32_bf16 v[112:115], v[116:119], v[20:23], 0
    ds_read_b128 v[44:47], v11 offset:5120
    v_mov_b64 v[106:107], 0
    v_mov_b64 v[108:109], 0
    v_smfmac_f32_16x16x64_bf16 v[120:123], v[116:119], v[24:31], v1
    ds_read_b128 v[56:59], v11 offset:10240
    ds_read_b128 v[60:63], v11 offset:14336
    v_mov_b64 v[110:111], 0
    v_smfmac_f32_16x16x64_bf16 v[124:127], v[116:119], v[32:39], v1
    ds_read_b128 v[64:67], v11 offset:11264
    ds_read_b128 v[68:71], v11 offset:15360
    v_add_f32 v112, v112, v114
    v_add_f32 v113, v113, v115
    v_rcp_f32 v112, v112
    v_rcp_f32 v113, v113
    v_pk_add_f32 v[120:121], v[120:121], v[122:123]
    s_nop 0
    v_pk_add_f32 v[124:125], v[124:125], v[126:127]
    v_pk_mul_f32 v[120:121], v[120:121], v[112:113]
    v_pk_mul_f32 v[124:125], v[124:125], v[112:113]
    v_cvt_pk_bf16_f32 v122, v120, v124
    v_cvt_pk_bf16_f32 v123, v121, v125
    ds_write_b32 v8, v122
    ds_write_b32 v8, v123 offset:288
    v_mov_b64 v[24:25], 0
    v_mov_b64 v[26:27], 0
    v_mov_b64 v[28:29], 0
    v_mov_b64 v[30:31], 0
    v_mov_b64 v[32:33], 0
    s_waitcnt lgkmcnt(0)
    s_barrier
    ds_read_b128 v[120:123], v10 offset:4608
    ds_read_b128 v[124:127], v10 offset:4736
    v_mov_b64 v[34:35], 0
    v_mov_b64 v[36:37], 0
    v_mov_b64 v[38:39], 0
    s_waitcnt lgkmcnt(1)
    v_smfmac_f32_16x16x64_bf16 v[24:27], v[120:123], v[48:55], v1
    ds_read_b128 v[48:51], v11 offset:32768
    ds_read_b128 v[52:55], v11 offset:36864
    s_waitcnt lgkmcnt(2)
    v_smfmac_f32_16x16x64_bf16 v[28:31], v[120:123], v[40:47], v1
    ds_read_b128 v[40:43], v11 offset:33792
    ds_read_b128 v[44:47], v11 offset:37888
    v_smfmac_f32_16x16x64_bf16 v[24:27], v[124:127], v[72:79], v1
    ds_read_b128 v[72:75], v11 offset:40960
    v_smfmac_f32_16x16x64_bf16 v[28:31], v[124:127], v[80:87], v1
    ds_read_b128 v[76:79], v11 offset:45056
    ds_read_b128 v[80:83], v11 offset:41984
    v_smfmac_f32_16x16x64_bf16 v[32:35], v[120:123], v[88:95], v1
    ds_read_b128 v[84:87], v11 offset:46080
    s_nop 1
    v_add_f32 v24, v24, v26
    v_add_f32 v25, v25, v27
    v_add_f32 v28, v28, v30
    v_add_f32 v29, v29, v31
    v_smfmac_f32_16x16x64_bf16 v[36:39], v[120:123], v[96:103], v1
    ds_read_b128 v[88:91], v11 offset:34816
    ds_read_b128 v[92:95], v11 offset:38912
    v_cvt_pk_bf16_f32 v26, v24, v28
    v_cvt_pk_bf16_f32 v27, v25, v29
    v_smfmac_f32_16x16x64_bf16 v[32:35], v[124:127], v[56:63], v1
    ds_read_b128 v[96:99], v11 offset:35840
    buffer_store_dwordx2 v[26:27], v6, s[8:11], s44 offen offset:0
    v_mov_b64 v[112:113], 0
    v_mov_b64 v[114:115], 0
    v_smfmac_f32_16x16x64_bf16 v[36:39], v[124:127], v[64:71], v1
    ds_read_b128 v[100:103], v11 offset:39936
    s_waitcnt lgkmcnt(8)
    v_mov_b64 v[116:117], 0
    v_mov_b64 v[118:119], 0
    v_smfmac_f32_16x16x64_bf16 v[104:107], v[120:123], v[48:55], v1
    ds_read_b128 v[56:59], v11 offset:43008
    ds_read_b128 v[60:63], v11 offset:47104
    v_add_f32 v32, v32, v34
    v_smfmac_f32_16x16x64_bf16 v[108:111], v[120:123], v[40:47], v1
    ds_read_b128 v[64:67], v11 offset:44032
    s_waitcnt lgkmcnt(7)
    v_add_f32 v33, v33, v35
    v_smfmac_f32_16x16x64_bf16 v[104:107], v[124:127], v[72:79], v1
    ds_read_b128 v[68:71], v11 offset:48128
    v_add_f32 v36, v36, v38
    v_add_f32 v37, v37, v39
    v_smfmac_f32_16x16x64_bf16 v[108:111], v[124:127], v[80:87], v1
    s_waitcnt lgkmcnt(4)
    v_cvt_pk_bf16_f32 v34, v32, v36
    v_cvt_pk_bf16_f32 v35, v33, v37
    v_smfmac_f32_16x16x64_bf16 v[112:115], v[120:123], v[88:95], v1
    buffer_store_dwordx2 v[34:35], v6, s[8:11], s44 offen offset:2048
    v_add_f32 v104, v104, v106
    v_smfmac_f32_16x16x64_bf16 v[116:119], v[120:123], v[96:103], v1
    s_waitcnt lgkmcnt(0)
    v_add_f32 v105, v105, v107
    v_smfmac_f32_16x16x64_bf16 v[112:115], v[124:127], v[56:63], v1
    v_add_f32 v108, v108, v110
    v_add_f32 v109, v109, v111
    v_smfmac_f32_16x16x64_bf16 v[116:119], v[124:127], v[64:71], v1
    v_cvt_pk_bf16_f32 v106, v104, v108
    v_cvt_pk_bf16_f32 v107, v105, v109
    buffer_store_dwordx2 v[106:107], v6, s[8:11], s37 offen offset:0
    s_nop 1
    v_pk_add_f32 v[112:113], v[112:113], v[114:115]
    s_nop 1
    v_pk_add_f32 v[116:117], v[116:117], v[118:119]
    v_cvt_pk_bf16_f32 v114, v112, v116
    v_cvt_pk_bf16_f32 v115, v113, v117
    buffer_store_dwordx2 v[114:115], v6, s[8:11], s37 offen offset:2048
    s_mov_b32 s41, s42
    v_and_b32 v61, 0x310, v0
    v_and_b32 v62, 0x60, v0
    v_lshl_add_u32 v61, v62, 1, v61
    v_bfe_u32 v62, v0, 7, 1
    v_mul_u32_u24 v62, 4128, v62
    v_add3_u32 v61, v61, v62, s54
    ds_read_b128 v[72:75], v61 offset:0
    v_mov_b64 v[104:105], 0
    ds_read_b128 v[76:79], v61 offset:1024
    v_mov_b64 v[106:107], 0
    ds_read_b128 v[80:83], v61 offset:2048
    v_mov_b64 v[108:109], 0
    ds_read_b128 v[84:87], v61 offset:3072
    v_mov_b64 v[110:111], 0
    ds_read_b128 v[88:91], v61 offset:32
    v_mov_b64 v[112:113], 0
    ds_read_b128 v[92:95], v61 offset:1056
    v_mov_b64 v[114:115], 0
    ds_read_b128 v[96:99], v61 offset:2080
    v_mov_b64 v[116:117], 0
    ds_read_b128 v[100:103], v61 offset:3104
    v_mov_b64 v[118:119], 0
    v_mov_b64 v[120:121], 0
    v_mov_b64 v[122:123], 0
    v_mov_b64 v[124:125], 0
    v_mov_b64 v[126:127], 0
    s_waitcnt vmcnt(1)
    buffer_load_dwordx4 v[48:51], v0, s[8:11], s56 offen sc1
    buffer_load_dwordx4 v[52:55], v0, s[8:11], s56 offen offset:1024 sc1
    v_add_u32 v63, s57, v0
    v_mov_b32 v27, 0
    v_mov_b32 v31, 0
    v_mov_b32 v35, 0
    v_mov_b32 v39, 0
    s_waitcnt vmcnt(12)
    ds_read_b64 v[24:25], v63 offset:0
    ds_read_b64 v[28:29], v63 offset:8
    ds_read_b64 v[32:33], v63 offset:1024
    ds_read_b64 v[36:37], v63 offset:1032
    v_add_u32 v38, 152192, v0
    s_add_u32 s40, s40, 1
    s_xor_b32 s50, s42, 0x20000
    s_mov_b32 s42, s43
    s_mov_b32 s43, s50
    s_xor_b32 s44, s44, 0x40000
    s_add_u32 s47, s47, 0x20000
    s_mov_b32 s49, 0
    s_mov_b32 s59, s54
    s_sub_u32 s54, 270400, s54
    s_add_u32 s58, s41, 0x1000
    s_add_u32 s51, s40, 2
T3_s1w3:
    buffer_load_dwordx4 v[48:51], v0, s[8:11], s56 offen sc1
    buffer_load_dwordx4 v[52:55], v0, s[8:11], s56 offen offset:1024 sc1
    s_add_u32 s49, s49, 1
    s_cmp_ge_u32 s49, 3000000
    s_cbranch_scc1 L_fail
    s_waitcnt vmcnt(2)
    v_max3_u32 v60, v48, v49, v50
    v_max3_u32 v60, v60, v51, v52
    v_mfma_f32_16x16x32_bf16 v[56:59], v[16:19], v[48:51], 0
    v_max3_u32 v60, v60, v53, v54
    v_max_u32 v60, v60, v55
    v_mfma_f32_16x16x32_bf16 v[56:59], v[16:19], v[52:55], v[56:59]
    v_cmp_eq_u32 vcc, s36, v60
    s_nop 6
    v_add_f32_dpp v56, v56, v56 row_ror:4 row_mask:0xf bank_mask:0xf
    v_add_f32_dpp v57, v57, v57 row_ror:4 row_mask:0xf bank_mask:0xf
    s_nop 0
    v_add_f32_dpp v56, v56, v56 row_ror:8 row_mask:0xf bank_mask:0xf
    v_add_f32_dpp v57, v57, v57 row_ror:8 row_mask:0xf bank_mask:0xf
    v_cvt_pk_bf16_f32 v64, v56, v57
    s_cbranch_vccnz T3_s1w3
T3_s1w3ok:
    buffer_store_dword v64, v7, s[8:11], s41 offen
    s_xor_b32 s56, s56, 0x40000
    s_waitcnt lgkmcnt(0)
    s_barrier
    buffer_load_dwordx4 v[48:51], v0, s[8:11], s41 offen offset:2048 sc1
    buffer_load_dwordx4 v[52:55], v0, s[8:11], s41 offen offset:3072 sc1
    s_barrier
    ds_read_b128 v[40:43], v38
    ds_read_b128 v[44:47], v38 offset:1024
    s_branch T3_p2go
    s_waitcnt lgkmcnt(0)
    s_waitcnt lgkmcnt(0)
T3_redo:
    s_add_u32 s49, s49, 1
    s_cmp_ge_u32 s49, 3000000
    s_cbranch_scc1 L_fail
    s_nop 7
    v_mov_b64 v[104:105], 0
    v_mov_b64 v[106:107], 0
    v_mov_b64 v[108:109], 0
    v_mov_b64 v[110:111], 0
    v_mov_b64 v[112:113], 0
    v_mov_b64 v[114:115], 0
    v_mov_b64 v[116:117], 0
    v_mov_b64 v[118:119], 0
    v_mov_b64 v[120:121], 0
    v_mov_b64 v[122:123], 0
    v_mov_b64 v[124:125], 0
    v_mov_b64 v[126:127], 0
    s_branch T3_p2ok
T3_fin:
    s_waitcnt lgkmcnt(0)
    s_add_u32 s47, s47, 0x20000
    buffer_store_dwordx4 v[12:15], v0, s[8:11], s47 offen sc1
    s_waitcnt vmcnt(0)
    s_endpgm
T_full0:
    s_mov_b32 s49, 0
    buffer_load_dwordx4 v[40:43], v0, s[8:11], s41 offen sc1
    buffer_load_dwordx4 v[44:47], v0, s[8:11], s41 offen offset:1024 sc1
    s_add_u32 s58, s41, 0x1000
    s_waitcnt vmcnt(0)
.p2align 6
    s_nop 0
    s_nop 0
T0_p2ok:
    buffer_load_dwordx4 v[48:51], v0, s[8:11], s41 offen offset:2048 sc1
    buffer_load_dwordx4 v[52:55], v0, s[8:11], s41 offen offset:3072 sc1
T0_p2go:
    buffer_load_dwordx4 v[56:59], v0, s[8:11], s58 offen offset:0 sc1
    s_waitcnt lgkmcnt(1)
    v_smfmac_f32_16x16x64_bf16 v[104:107], v[40:43], a[0:7], v1
    s_xor_b32 s45, s56, 0x40000
    v_smfmac_f32_16x16x64_bf16 v[108:111], v[40:43], a[8:15], v1
    s_waitcnt lgkmcnt(0)
    v_smfmac_f32_16x16x64_bf16 v[104:107], v[44:47], a[16:23], v1
    buffer_load_dwordx4 v[60:63], v0, s[8:11], s58 offen offset:1024 sc1
    v_smfmac_f32_16x16x64_bf16 v[108:111], v[44:47], a[24:31], v1
    s_add_u32 s37, s44, 0x1000
    v_mov_b32 v26, v9
    v_smfmac_f32_16x16x64_bf16 v[112:115], v[40:43], a[128:135], v1
    v_smfmac_f32_16x16x64_bf16 v[116:119], v[40:43], a[136:143], v1
    buffer_load_dwordx4 v[64:67], v0, s[8:11], s58 offen offset:2048 sc1
    v_mov_b32_dpp v26, v9 row_shl:4 row_mask:0xf bank_mask:0x2
    v_smfmac_f32_16x16x64_bf16 v[112:115], v[44:47], a[144:151], v1
    v_smfmac_f32_16x16x64_bf16 v[116:119], v[44:47], a[152:159], v1
    v_mov_b32_dpp v26, v9 row_shr:4 row_mask:0xf bank_mask:0x4
    v_smfmac_f32_16x16x64_bf16 v[120:123], v[40:43], v[128:135], v1
    buffer_load_dwordx4 v[68:71], v0, s[8:11], s58 offen offset:3072 sc1
    v_smfmac_f32_16x16x64_bf16 v[124:127], v[40:43], v[136:143], v1
    v_smfmac_f32_16x16x64_bf16 v[120:123], v[44:47], v[144:151], v1
    v_subrev_u32 v38, 4608, v8
    v_smfmac_f32_16x16x64_bf16 v[124:127], v[44:47], v[152:159], v1
    s_waitcnt vmcnt(5)
    v_smfmac_f32_16x16x64_bf16 v[104:107], v[48:51], a[32:39], v1
    v_max_u32 v34, v48, v49
    v_smfmac_f32_16x16x64_bf16 v[108:111], v[48:51], a[40:47], v1
    s_mov_b32 m0, s57
    s_add_u32 s52, s46, 0x1000000
    v_max3_u32 v34, v34, v50, v51
    v_smfmac_f32_16x16x64_bf16 v[112:115], v[48:51], a[160:167], v1
    buffer_load_dwordx4 v0, s[8:11], s52 offen sc1 lds
    v_smfmac_f32_16x16x64_bf16 v[116:119], v[48:51], a[168:175], v1
    s_waitcnt vmcnt(5)
    v_smfmac_f32_16x16x64_bf16 v[104:107], v[52:55], a[48:55], v1
    v_max3_u32 v34, v34, v52, v53
    v_smfmac_f32_16x16x64_bf16 v[108:111], v[52:55], a[56:63], v1
    v_max3_u32 v34, v34, v54, v55
    v_smfmac_f32_16x16x64_bf16 v[112:115], v[52:55], a[176:183], v1
    buffer_load_dwordx4 v0, s[8:11], s52 offen offset:1024 sc1 lds
    v_smfmac_f32_16x16x64_bf16 v[116:119], v[52:55], a[184:191], v1
    s_waitcnt vmcnt(5)
    v_smfmac_f32_16x16x64_bf16 v[104:107], v[56:59], a[64:71], v1
    v_max3_u32 v34, v34, v56, v57
    v_smfmac_f32_16x16x64_bf16 v[108:111], v[56:59], a[72:79], v1
    s_add_u32 m0, s48, s59
    s_add_u32 s38, s46, 0x40000
    v_max3_u32 v34, v34, v58, v59
    v_smfmac_f32_16x16x64_bf16 v[112:115], v[56:59], a[192:199], v1
    buffer_load_dwordx4 v0, s[8:11], s38 offen sc1 lds
    v_smfmac_f32_16x16x64_bf16 v[116:119], v[56:59], a[200:207], v1
    s_waitcnt vmcnt(5)
    v_smfmac_f32_16x16x64_bf16 v[104:107], v[60:63], a[80:87], v1
    buffer_store_dwordx4 v[2:5], v0, s[8:11], s45 offen offset:0
    v_max3_u32 v34, v34, v60, v61
    v_smfmac_f32_16x16x64_bf16 v[108:111], v[60:63], a[88:95], v1
    v_max3_u32 v34, v34, v62, v63
    v_smfmac_f32_16x16x64_bf16 v[112:115], v[60:63], a[208:215], v1
    buffer_load_dwordx4 v0, s[8:11], s38 offen offset:1024 sc1 lds
    v_smfmac_f32_16x16x64_bf16 v[116:119], v[60:63], a[216:223], v1
    s_waitcnt vmcnt(6)
    v_smfmac_f32_16x16x64_bf16 v[104:107], v[64:67], a[96:103], v1
    v_max3_u32 v34, v34, v64, v65
    v_smfmac_f32_16x16x64_bf16 v[108:111], v[64:67], a[104:111], v1
    v_max3_u32 v34, v34, v66, v67
    v_smfmac_f32_16x16x64_bf16 v[112:115], v[64:67], a[224:231], v1
    buffer_store_dwordx4 v[2:5], v0, s[8:11], s45 offen offset:1024
    v_smfmac_f32_16x16x64_bf16 v[116:119], v[64:67], a[232:239], v1
    s_waitcnt vmcnt(6)
    v_subrev_u32 v30, 2304, v8
    v_smfmac_f32_16x16x64_bf16 v[104:107], v[68:71], a[112:119], v1
    v_max3_u32 v34, v34, v68, v69
    v_smfmac_f32_16x16x64_bf16 v[108:111], v[68:71], a[120:127], v1
    s_nop 1
    v_max3_u32 v34, v34, v70, v71
    v_smfmac_f32_16x16x64_bf16 v[112:115], v[68:71], a[240:247], v1
    v_cmp_eq_u32 vcc, s36, v34
    v_smfmac_f32_16x16x64_bf16 v[116:119], v[68:71], a[248:255], v1
    v_add_f32 v104, v104, v106
    v_add_f32 v105, v105, v107
    v_add_f32 v108, v108, v110
    v_add_f32 v109, v109, v111
    v_smfmac_f32_16x16x64_bf16 v[120:123], v[48:51], v[160:167], v1
    s_cbranch_vccnz T0_redo
    buffer_store_dwordx4 v[12:15], v0, s[8:11], s47 offen sc1
    v_cvt_pk_bf16_f32 v106, v104, v108
    v_cvt_pk_bf16_f32 v107, v105, v109
    v_smfmac_f32_16x16x64_bf16 v[124:127], v[48:51], v[168:175], v1
    ds_write2_b32 v38, v106, v107 offset0:0 offset1:72
    v_add_f32 v112, v112, v114
    v_add_f32 v113, v113, v115
    v_add_f32 v116, v116, v118
    v_add_f32 v117, v117, v119
    v_smfmac_f32_16x16x64_bf16 v[120:123], v[52:55], v[176:183], v1
    v_cvt_pk_bf16_f32 v12, v112, v116
    v_cvt_pk_bf16_f32 v13, v113, v117
    v_smfmac_f32_16x16x64_bf16 v[124:127], v[52:55], v[184:191], v1
    ds_write2_b32 v30, v12, v13 offset0:0 offset1:72
    v_smfmac_f32_16x16x64_bf16 v[120:123], v[56:59], v[192:199], v1
    v_smfmac_f32_16x16x64_bf16 v[124:127], v[56:59], v[200:207], v1
    buffer_store_dword v2, v7, s[8:11], s43 offen
    v_smfmac_f32_16x16x64_bf16 v[120:123], v[60:63], v[208:215], v1
    s_mov_b32 s46, s38
    v_smfmac_f32_16x16x64_bf16 v[124:127], v[60:63], v[216:223], v1
    s_waitcnt lgkmcnt(0)
    s_barrier
    ds_read_b128 v[40:43], v9 offset:0
    v_smfmac_f32_16x16x64_bf16 v[120:123], v[64:67], v[224:231], v1
    ds_read_b128 v[44:47], v9 offset:64
    ds_read_b128 v[48:51], v9 offset:128
    v_smfmac_f32_16x16x64_bf16 v[124:127], v[64:67], v[232:239], v1
    ds_read_b128 v[52:55], v9 offset:192
    v_smfmac_f32_16x16x64_bf16 v[120:123], v[68:71], v[240:247], v1
    s_cmp_eq_u32 s40, 63
    v_smfmac_f32_16x16x64_bf16 v[124:127], v[68:71], v[248:255], v1
    ds_read_b128 v[56:59], v26 offset:2304
    s_waitcnt lgkmcnt(4)
    v_mfma_f32_16x16x32_bf16 v[104:107], v[72:75], v[40:43], 0
    ds_read_b128 v[60:63], v26 offset:2368
    ds_read_b128 v[64:67], v26 offset:2432
    v_mfma_f32_16x16x32_bf16 v[108:111], v[88:91], v[40:43], 0
    ds_read_b128 v[68:71], v26 offset:2496
    s_waitcnt lgkmcnt(4)
    v_mfma_f32_16x16x32_bf16 v[104:107], v[76:79], v[44:47], v[104:107]
    v_add_f32 v120, v120, v122
    v_add_f32 v121, v121, v123
    v_mfma_f32_16x16x32_bf16 v[108:111], v[92:95], v[44:47], v[108:111]
    v_add_f32 v124, v124, v126
    v_add_f32 v125, v125, v127
    v_mfma_f32_16x16x32_bf16 v[104:107], v[80:83], v[48:51], v[104:107]
    ds_read_b128 v[72:75], v11 offset:8192
    v_cvt_pk_bf16_f32 v14, v120, v121
    v_cvt_pk_bf16_f32 v15, v124, v125
    v_mfma_f32_16x16x32_bf16 v[108:111], v[96:99], v[48:51], v[108:111]
    ds_read_b128 v[88:91], v11 offset:2048
    s_cbranch_scc1 T0_fin
    v_cndmask_b32 v26, 0, v14, s[34:35]
    v_mfma_f32_16x16x32_bf16 v[104:107], v[84:87], v[52:55], v[104:107]
    ds_read_b128 v[76:79], v11 offset:12288
    v_cndmask_b32 v30, v14, 0, s[34:35]
    v_mfma_f32_16x16x32_bf16 v[108:111], v[100:103], v[52:55], v[108:111]
    ds_read_b128 v[92:95], v11 offset:6144
    s_waitcnt lgkmcnt(3)
    v_cndmask_b32 v34, 0, v15, s[34:35]
    v_cndmask_b32 v38, v15, 0, s[34:35]
    v_mfma_f32_16x16x32_bf16 v[112:115], v[56:59], v[40:43], 0
    ds_read_b128 v[80:83], v11 offset:9216
    v_mov_b64 v[120:121], 0
    v_mov_b64 v[122:123], 0
    v_mfma_f32_16x16x32_bf16 v[112:115], v[60:63], v[44:47], v[112:115]
    ds_read_b128 v[96:99], v11 offset:3072
    v_mov_b64 v[124:125], 0
    v_mov_b64 v[126:127], 0
    v_mfma_f32_16x16x32_bf16 v[112:115], v[64:67], v[48:51], v[112:115]
    ds_read_b128 v[84:87], v11 offset:13312
    v_max3_f32 v116, v104, v105, v106
    v_max3_f32 v117, v108, v109, v110
    v_mfma_f32_16x16x32_bf16 v[112:115], v[68:71], v[52:55], v[112:115]
    ds_read_b128 v[100:103], v11 offset:7168
    v_max3_f32 v116, v116, v107, v111
    v_max_f32 v116, v116, v117
    v_cndmask_b32 v104, v104, v108, s[32:33]
    v_cndmask_b32 v105, v105, v109, s[32:33]
    v_cndmask_b32 v106, v106, v110, s[32:33]
    v_cndmask_b32 v107, v107, v111, s[32:33]
    s_nop 0
    v_max3_f32 v114, v116, v112, v113
    v_max3_f32 v115, v116, v112, v113
    ds_read_b128 v[48:51], v11 offset:0
    s_nop 0
    v_permlane32_swap_b32 v114, v115
    v_max_f32 v116, v114, v115
    v_max_f32 v117, v114, v115
    ds_read_b128 v[52:55], v11 offset:4096
    s_nop 0
    v_permlane16_swap_b32 v116, v117
    v_max_f32 v114, v116, v117
    v_pk_add_f32 v[104:105], v[104:105], v[114:115] op_sel_hi:[1,0] neg_lo:[0,1] neg_hi:[0,1]
    v_pk_add_f32 v[106:107], v[106:107], v[114:115] op_sel_hi:[1,0] neg_lo:[0,1] neg_hi:[0,1]
    v_pk_add_f32 v[112:113], v[112:113], v[114:115] op_sel_hi:[1,0] neg_lo:[0,1] neg_hi:[0,1]
    v_pk_mul_f32 v[104:105], v[104:105], s[38:39] op_sel:[0,1] op_sel_hi:[1,1]
    v_pk_mul_f32 v[106:107], v[106:107], s[38:39] op_sel:[0,1] op_sel_hi:[1,1]
    v_pk_mul_f32 v[112:113], v[112:113], s[38:39] op_sel:[0,1] op_sel_hi:[1,1]
    v_exp_f32 v104, v104
    v_exp_f32 v105, v105
    v_exp_f32 v106, v106
    v_exp_f32 v107, v107
    v_exp_f32 v112, v112
    v_exp_f32 v113, v113
    v_cvt_pk_bf16_f32 v116, v104, v105
    v_cvt_pk_bf16_f32 v118, v106, v107
    v_cvt_pk_bf16_f32 v117, v112, v113
    v_cvt_pk_bf16_f32 v119, v112, v113
    ds_read_b128 v[40:43], v11 offset:1024
    v_mov_b64 v[104:105], 0
    v_mfma_f32_16x16x32_bf16 v[112:115], v[116:119], v[20:23], 0
    ds_read_b128 v[44:47], v11 offset:5120
    v_mov_b64 v[106:107], 0
    v_mov_b64 v[108:109], 0
    v_smfmac_f32_16x16x64_bf16 v[120:123], v[116:119], v[24:31], v1
    ds_read_b128 v[56:59], v11 offset:10240
    ds_read_b128 v[60:63], v11 offset:14336
    v_mov_b64 v[110:111], 0
    v_smfmac_f32_16x16x64_bf16 v[124:127], v[116:119], v[32:39], v1
    ds_read_b128 v[64:67], v11 offset:11264
    ds_read_b128 v[68:71], v11 offset:15360
    v_add_f32 v112, v112, v114
    v_add_f32 v113, v113, v115
    v_rcp_f32 v112, v112
    v_rcp_f32 v113, v113
    v_pk_add_f32 v[120:121], v[120:121], v[122:123]
    s_nop 0
    v_pk_add_f32 v[124:125], v[124:125], v[126:127]
    v_pk_mul_f32 v[120:121], v[120:121], v[112:113]
    v_pk_mul_f32 v[124:125], v[124:125], v[112:113]
    v_cvt_pk_bf16_f32 v122, v120, v124
    v_cvt_pk_bf16_f32 v123, v121, v125
    ds_write_b32 v8, v122
    ds_write_b32 v8, v123 offset:288
    v_mov_b64 v[24:25], 0
    v_mov_b64 v[26:27], 0
    v_mov_b64 v[28:29], 0
    v_mov_b64 v[30:31], 0
    v_mov_b64 v[32:33], 0
    s_waitcnt lgkmcnt(0)
    s_barrier
    ds_read_b128 v[120:123], v10 offset:4608
    ds_read_b128 v[124:127], v10 offset:4736
    v_mov_b64 v[34:35], 0
    v_mov_b64 v[36:37], 0
    v_mov_b64 v[38:39], 0
    s_waitcnt lgkmcnt(1)
    v_smfmac_f32_16x16x64_bf16 v[24:27], v[120:123], v[48:55], v1
    ds_read_b128 v[48:51], v11 offset:32768
    ds_read_b128 v[52:55], v11 offset:36864
    s_waitcnt lgkmcnt(2)
    v_smfmac_f32_16x16x64_bf16 v[28:31], v[120:123], v[40:47], v1
    ds_read_b128 v[40:43], v11 offset:33792
    ds_read_b128 v[44:47], v11 offset:37888
    v_smfmac_f32_16x16x64_bf16 v[24:27], v[124:127], v[72:79], v1
    ds_read_b128 v[72:75], v11 offset:40960
    v_smfmac_f32_16x16x64_bf16 v[28:31], v[124:127], v[80:87], v1
    ds_read_b128 v[76:79], v11 offset:45056
    ds_read_b128 v[80:83], v11 offset:41984
    v_smfmac_f32_16x16x64_bf16 v[32:35], v[120:123], v[88:95], v1
    ds_read_b128 v[84:87], v11 offset:46080
    s_nop 1
    v_add_f32 v24, v24, v26
    v_add_f32 v25, v25, v27
    v_add_f32 v28, v28, v30
    v_add_f32 v29, v29, v31
    v_smfmac_f32_16x16x64_bf16 v[36:39], v[120:123], v[96:103], v1
    ds_read_b128 v[88:91], v11 offset:34816
    ds_read_b128 v[92:95], v11 offset:38912
    v_cvt_pk_bf16_f32 v26, v24, v28
    v_cvt_pk_bf16_f32 v27, v25, v29
    v_smfmac_f32_16x16x64_bf16 v[32:35], v[124:127], v[56:63], v1
    ds_read_b128 v[96:99], v11 offset:35840
    buffer_store_dwordx2 v[26:27], v6, s[8:11], s44 offen offset:0
    v_mov_b64 v[112:113], 0
    v_mov_b64 v[114:115], 0
    v_smfmac_f32_16x16x64_bf16 v[36:39], v[124:127], v[64:71], v1
    ds_read_b128 v[100:103], v11 offset:39936
    s_waitcnt lgkmcnt(8)
    v_mov_b64 v[116:117], 0
    v_mov_b64 v[118:119], 0
    v_smfmac_f32_16x16x64_bf16 v[104:107], v[120:123], v[48:55], v1
    ds_read_b128 v[56:59], v11 offset:43008
    ds_read_b128 v[60:63], v11 offset:47104
    v_add_f32 v32, v32, v34
    v_smfmac_f32_16x16x64_bf16 v[108:111], v[120:123], v[40:47], v1
    ds_read_b128 v[64:67], v11 offset:44032
    s_waitcnt lgkmcnt(7)
    v_add_f32 v33, v33, v35
    v_smfmac_f32_16x16x64_bf16 v[104:107], v[124:127], v[72:79], v1
    ds_read_b128 v[68:71], v11 offset:48128
    v_add_f32 v36, v36, v38
    v_add_f32 v37, v37, v39
    v_smfmac_f32_16x16x64_bf16 v[108:111], v[124:127], v[80:87], v1
    s_waitcnt lgkmcnt(4)
    v_cvt_pk_bf16_f32 v34, v32, v36
    v_cvt_pk_bf16_f32 v35, v33, v37
    v_smfmac_f32_16x16x64_bf16 v[112:115], v[120:123], v[88:95], v1
    buffer_store_dwordx2 v[34:35], v6, s[8:11], s44 offen offset:2048
    v_add_f32 v104, v104, v106
    v_smfmac_f32_16x16x64_bf16 v[116:119], v[120:123], v[96:103], v1
    s_waitcnt lgkmcnt(0)
    v_add_f32 v105, v105, v107
    v_smfmac_f32_16x16x64_bf16 v[112:115], v[124:127], v[56:63], v1
    buffer_load_dwordx4 v[48:51], v0, s[8:11], s56 offen sc1
    buffer_load_dwordx4 v[52:55], v0, s[8:11], s56 offen offset:1024 sc1
    v_add_f32 v108, v108, v110
    v_add_f32 v109, v109, v111
    v_smfmac_f32_16x16x64_bf16 v[116:119], v[124:127], v[64:71], v1
    v_cvt_pk_bf16_f32 v106, v104, v108
    v_cvt_pk_bf16_f32 v107, v105, v109
    buffer_store_dwordx2 v[106:107], v6, s[8:11], s37 offen offset:0
    v_pk_add_f32 v[112:113], v[112:113], v[114:115]
    s_nop 3
    v_pk_add_f32 v[116:117], v[116:117], v[118:119]
    v_cvt_pk_bf16_f32 v114, v112, v116
    v_cvt_pk_bf16_f32 v115, v113, v117
    buffer_store_dwordx2 v[114:115], v6, s[8:11], s37 offen offset:2048
    s_mov_b32 s41, s42
    buffer_load_dwordx4 v[48:51], v0, s[8:11], s56 offen sc1
    buffer_load_dwordx4 v[52:55], v0, s[8:11], s56 offen offset:1024 sc1
    v_and_b32 v61, 0x310, v0
    v_and_b32 v62, 0x60, v0
    v_lshl_add_u32 v61, v62, 1, v61
    v_bfe_u32 v62, v0, 7, 1
    v_mul_u32_u24 v62, 4128, v62
    v_add3_u32 v61, v61, v62, s54
    ds_read_b128 v[72:75], v61 offset:0
    v_mov_b64 v[104:105], 0
    ds_read_b128 v[76:79], v61 offset:1024
    v_mov_b64 v[106:107], 0
    ds_read_b128 v[80:83], v61 offset:2048
    v_mov_b64 v[108:109], 0
    s_waitcnt vmcnt(4)
    v_max3_u32 v60, v48, v49, v50
    v_max3_u32 v60, v60, v51, v52
    v_mfma_f32_16x16x32_bf16 v[56:59], v[16:19], v[48:51], 0
    v_max3_u32 v60, v60, v53, v54
    v_max_u32 v60, v60, v55
    v_mfma_f32_16x16x32_bf16 v[56:59], v[16:19], v[52:55], v[56:59]
    v_cmp_eq_u32 vcc, s36, v60
    s_nop 6
    v_add_f32_dpp v56, v56, v56 row_ror:4 row_mask:0xf bank_mask:0xf
    v_add_f32_dpp v57, v57, v57 row_ror:4 row_mask:0xf bank_mask:0xf
    s_nop 0
    v_add_f32_dpp v56, v56, v56 row_ror:8 row_mask:0xf bank_mask:0xf
    v_add_f32_dpp v57, v57, v57 row_ror:8 row_mask:0xf bank_mask:0xf
    v_cvt_pk_bf16_f32 v64, v56, v57
    s_cbranch_vccz T0_s1w0ok
T0_s1w0:
    buffer_load_dwordx4 v[48:51], v0, s[8:11], s56 offen sc1
    buffer_load_dwordx4 v[52:55], v0, s[8:11], s56 offen offset:1024 sc1
    s_add_u32 s49, s49, 1
    s_cmp_ge_u32 s49, 3000000
    s_cbranch_scc1 L_fail
    s_waitcnt vmcnt(2)
    v_max3_u32 v60, v48, v49, v50
    v_max3_u32 v60, v60, v51, v52
    v_mfma_f32_16x16x32_bf16 v[56:59], v[16:19], v[48:51], 0
    v_max3_u32 v60, v60, v53, v54
    v_max_u32 v60, v60, v55
    v_mfma_f32_16x16x32_bf16 v[56:59], v[16:19], v[52:55], v[56:59]
    v_cmp_eq_u32 vcc, s36, v60
    s_nop 6
    v_add_f32_dpp v56, v56, v56 row_ror:4 row_mask:0xf bank_mask:0xf
    v_add_f32_dpp v57, v57, v57 row_ror:4 row_mask:0xf bank_mask:0xf
    s_nop 0
    v_add_f32_dpp v56, v56, v56 row_ror:8 row_mask:0xf bank_mask:0xf
    v_add_f32_dpp v57, v57, v57 row_ror:8 row_mask:0xf bank_mask:0xf
    v_cvt_pk_bf16_f32 v64, v56, v57
    s_cbranch_vccnz T0_s1w0
T0_s1w0ok:
    buffer_store_dword v64, v7, s[8:11], s41 offen
    s_xor_b32 s56, s56, 0x40000
    ds_read_b128 v[84:87], v61 offset:3072
    v_mov_b64 v[110:111], 0
    ds_read_b128 v[88:91], v61 offset:32
    v_mov_b64 v[112:113], 0
    ds_read_b128 v[92:95], v61 offset:1056
    v_mov_b64 v[114:115], 0
    ds_read_b128 v[96:99], v61 offset:2080
    v_mov_b64 v[116:117], 0
    buffer_load_dwordx4 v[40:43], v0, s[8:11], s41 offen sc1
    buffer_load_dwordx4 v[44:47], v0, s[8:11], s41 offen offset:1024 sc1
    ds_read_b128 v[100:103], v61 offset:3104
    v_mov_b64 v[118:119], 0
    v_mov_b64 v[120:121], 0
    v_mov_b64 v[122:123], 0
    v_mov_b64 v[124:125], 0
    v_mov_b64 v[126:127], 0
    v_add_u32 v63, s57, v0
    v_mov_b32 v27, 0
    v_mov_b32 v31, 0
    v_mov_b32 v35, 0
    v_mov_b32 v39, 0
    s_waitcnt vmcnt(19)
    ds_read_b64 v[24:25], v63 offset:0
    ds_read_b64 v[28:29], v63 offset:8
    ds_read_b64 v[32:33], v63 offset:1024
    ds_read_b64 v[36:37], v63 offset:1032
    buffer_load_dwordx4 v[40:43], v0, s[8:11], s41 offen sc1
    buffer_load_dwordx4 v[44:47], v0, s[8:11], s41 offen offset:1024 sc1
    v_add_u32 v38, 152192, v0
    s_add_u32 s40, s40, 1
    s_xor_b32 s50, s42, 0x20000
    s_mov_b32 s42, s43
    s_mov_b32 s43, s50
    s_xor_b32 s44, s44, 0x40000
    s_add_u32 s47, s47, 0x20000
    s_mov_b32 s49, 0
    s_mov_b32 s59, s54
    s_sub_u32 s54, 270400, s54
    s_add_u32 s58, s41, 0x1000
    s_add_u32 s51, s40, 2
T0_s2:
    buffer_load_dwordx4 v[40:43], v0, s[8:11], s41 offen sc1
    buffer_load_dwordx4 v[44:47], v0, s[8:11], s41 offen offset:1024 sc1
    s_add_u32 s49, s49, 1
    s_cmp_ge_u32 s49, 3000000
    s_cbranch_scc1 L_fail
    s_waitcnt vmcnt(4)
    v_max3_u32 v34, v40, v41, v42
    v_max3_u32 v34, v34, v43, v44
    v_max3_u32 v34, v34, v45, v46
    v_max_u32 v34, v34, v47
    v_cmp_eq_u32 vcc, s36, v34
    s_cbranch_vccnz T0_s2
T0_s2ok:
    s_barrier
    ds_write_b128 v38, v[40:43]
    ds_write_b128 v38, v[44:47] offset:1024
    buffer_load_dwordx4 v[48:51], v0, s[8:11], s41 offen offset:2048 sc1
    buffer_load_dwordx4 v[52:55], v0, s[8:11], s41 offen offset:3072 sc1
    s_waitcnt lgkmcnt(0)
    s_barrier
    s_branch T0_p2go
    s_waitcnt lgkmcnt(0)
    s_waitcnt lgkmcnt(0)
T0_redo:
    s_add_u32 s49, s49, 1
    s_cmp_ge_u32 s49, 3000000
    s_cbranch_scc1 L_fail
    s_nop 7
    v_mov_b64 v[104:105], 0
    v_mov_b64 v[106:107], 0
    v_mov_b64 v[108:109], 0
    v_mov_b64 v[110:111], 0
    v_mov_b64 v[112:113], 0
    v_mov_b64 v[114:115], 0
    v_mov_b64 v[116:117], 0
    v_mov_b64 v[118:119], 0
    v_mov_b64 v[120:121], 0
    v_mov_b64 v[122:123], 0
    v_mov_b64 v[124:125], 0
    v_mov_b64 v[126:127], 0
    s_branch T0_p2ok
T0_fin:
    s_waitcnt lgkmcnt(0)
    s_add_u32 s47, s47, 0x20000
    buffer_store_dwordx4 v[12:15], v0, s[8:11], s47 offen sc1
    s_waitcnt vmcnt(0)
    s_endpgm
T_full1:
    s_mov_b32 s49, 0
    buffer_load_dwordx4 v[40:43], v0, s[8:11], s41 offen sc1
    buffer_load_dwordx4 v[44:47], v0, s[8:11], s41 offen offset:1024 sc1
    s_add_u32 s58, s41, 0x1000
    s_waitcnt vmcnt(0)
.p2align 6
    s_nop 0
    s_nop 0
T1_p2ok:
    buffer_load_dwordx4 v[48:51], v0, s[8:11], s41 offen offset:2048 sc1
    buffer_load_dwordx4 v[52:55], v0, s[8:11], s41 offen offset:3072 sc1
T1_p2go:
    buffer_load_dwordx4 v[56:59], v0, s[8:11], s58 offen offset:0 sc1
    s_waitcnt lgkmcnt(1)
    v_smfmac_f32_16x16x64_bf16 v[104:107], v[40:43], a[0:7], v1
    s_xor_b32 s45, s56, 0x40000
    v_smfmac_f32_16x16x64_bf16 v[108:111], v[40:43], a[8:15], v1
    s_waitcnt lgkmcnt(0)
    v_smfmac_f32_16x16x64_bf16 v[104:107], v[44:47], a[16:23], v1
    buffer_load_dwordx4 v[60:63], v0, s[8:11], s58 offen offset:1024 sc1
    v_smfmac_f32_16x16x64_bf16 v[108:111], v[44:47], a[24:31], v1
    s_add_u32 s37, s44, 0x1000
    v_mov_b32 v26, v9
    v_smfmac_f32_16x16x64_bf16 v[112:115], v[40:43], a[128:135], v1
    v_smfmac_f32_16x16x64_bf16 v[116:119], v[40:43], a[136:143], v1
    buffer_load_dwordx4 v[64:67], v0, s[8:11], s58 offen offset:2048 sc1
    v_mov_b32_dpp v26, v9 row_shl:4 row_mask:0xf bank_mask:0x2
    v_smfmac_f32_16x16x64_bf16 v[112:115], v[44:47], a[144:151], v1
    v_smfmac_f32_16x16x64_bf16 v[116:119], v[44:47], a[152:159], v1
    v_mov_b32_dpp v26, v9 row_shr:4 row_mask:0xf bank_mask:0x4
    v_smfmac_f32_16x16x64_bf16 v[120:123], v[40:43], v[128:135], v1
    buffer_load_dwordx4 v[68:71], v0, s[8:11], s58 offen offset:3072 sc1
    v_smfmac_f32_16x16x64_bf16 v[124:127], v[40:43], v[136:143], v1
    v_smfmac_f32_16x16x64_bf16 v[120:123], v[44:47], v[144:151], v1
    v_subrev_u32 v38, 4608, v8
    v_smfmac_f32_16x16x64_bf16 v[124:127], v[44:47], v[152:159], v1
    s_waitcnt vmcnt(5)
    v_smfmac_f32_16x16x64_bf16 v[104:107], v[48:51], a[32:39], v1
    v_max_u32 v34, v48, v49
    v_smfmac_f32_16x16x64_bf16 v[108:111], v[48:51], a[40:47], v1
    s_mov_b32 m0, s57
    s_add_u32 s52, s46, 0x1000000
    v_max3_u32 v34, v34, v50, v51
    v_smfmac_f32_16x16x64_bf16 v[112:115], v[48:51], a[160:167], v1
    buffer_load_dwordx4 v0, s[8:11], s52 offen sc1 lds
    v_smfmac_f32_16x16x64_bf16 v[116:119], v[48:51], a[168:175], v1
    s_waitcnt vmcnt(5)
    v_smfmac_f32_16x16x64_bf16 v[104:107], v[52:55], a[48:55], v1
    v_max3_u32 v34, v34, v52, v53
    v_smfmac_f32_16x16x64_bf16 v[108:111], v[52:55], a[56:63], v1
    v_max3_u32 v34, v34, v54, v55
    v_smfmac_f32_16x16x64_bf16 v[112:115], v[52:55], a[176:183], v1
    buffer_load_dwordx4 v0, s[8:11], s52 offen offset:1024 sc1 lds
    v_smfmac_f32_16x16x64_bf16 v[116:119], v[52:55], a[184:191], v1
    s_waitcnt vmcnt(5)
    v_smfmac_f32_16x16x64_bf16 v[104:107], v[56:59], a[64:71], v1
    v_max3_u32 v34, v34, v56, v57
    v_smfmac_f32_16x16x64_bf16 v[108:111], v[56:59], a[72:79], v1
    s_add_u32 m0, s48, s59
    s_add_u32 s38, s46, 0x40000
    v_max3_u32 v34, v34, v58, v59
    v_smfmac_f32_16x16x64_bf16 v[112:115], v[56:59], a[192:199], v1
    buffer_load_dwordx4 v0, s[8:11], s38 offen sc1 lds
    v_smfmac_f32_16x16x64_bf16 v[116:119], v[56:59], a[200:207], v1
    s_waitcnt vmcnt(5)
    v_smfmac_f32_16x16x64_bf16 v[104:107], v[60:63], a[80:87], v1
    buffer_store_dwordx4 v[2:5], v0, s[8:11], s45 offen offset:0
    v_max3_u32 v34, v34, v60, v61
    v_smfmac_f32_16x16x64_bf16 v[108:111], v[60:63], a[88:95], v1
    v_max3_u32 v34, v34, v62, v63
    v_smfmac_f32_16x16x64_bf16 v[112:115], v[60:63], a[208:215], v1
    buffer_load_dwordx4 v0, s[8:11], s38 offen offset:1024 sc1 lds
    v_smfmac_f32_16x16x64_bf16 v[116:119], v[60:63], a[216:223], v1
    s_waitcnt vmcnt(6)
    s_mov_b32 m0, 162688
    v_lshrrev_b32 v30, 2, v0
    v_smfmac_f32_16x16x64_bf16 v[104:107], v[64:67], a[96:103], v1
    buffer_load_dword v30, s[8:11], s6 offen sc1 lds
    v_max3_u32 v34, v34, v64, v65
    v_smfmac_f32_16x16x64_bf16 v[108:111], v[64:67], a[104:111], v1
    v_max3_u32 v34, v34, v66, v67
    v_smfmac_f32_16x16x64_bf16 v[112:115], v[64:67], a[224:231], v1
    buffer_store_dwordx4 v[2:5], v0, s[8:11], s45 offen offset:1024
    v_smfmac_f32_16x16x64_bf16 v[116:119], v[64:67], a[232:239], v1
    s_waitcnt vmcnt(7)
    v_subrev_u32 v30, 2304, v8
    v_smfmac_f32_16x16x64_bf16 v[104:107], v[68:71], a[112:119], v1
    v_max3_u32 v34, v34, v68, v69
    v_smfmac_f32_16x16x64_bf16 v[108:111], v[68:71], a[120:127], v1
    s_nop 1
    v_max3_u32 v34, v34, v70, v71
    v_smfmac_f32_16x16x64_bf16 v[112:115], v[68:71], a[240:247], v1
    v_cmp_eq_u32 vcc, s36, v34
    v_smfmac_f32_16x16x64_bf16 v[116:119], v[68:71], a[248:255], v1
    v_add_f32 v104, v104, v106
    v_add_f32 v105, v105, v107
    v_add_f32 v108, v108, v110
    v_add_f32 v109, v109, v111
    v_smfmac_f32_16x16x64_bf16 v[120:123], v[48:51], v[160:167], v1
    s_cbranch_vccnz T1_redo
    buffer_store_dwordx4 v[12:15], v0, s[8:11], s47 offen sc1
    v_cvt_pk_bf16_f32 v106, v104, v108
    v_cvt_pk_bf16_f32 v107, v105, v109
    v_smfmac_f32_16x16x64_bf16 v[124:127], v[48:51], v[168:175], v1
    ds_write2_b32 v38, v106, v107 offset0:0 offset1:72
    v_add_f32 v112, v112, v114
    v_add_f32 v113, v113, v115
    v_add_f32 v116, v116, v118
    v_add_f32 v117, v117, v119
    v_smfmac_f32_16x16x64_bf16 v[120:123], v[52:55], v[176:183], v1
    v_cvt_pk_bf16_f32 v12, v112, v116
    v_cvt_pk_bf16_f32 v13, v113, v117
    v_smfmac_f32_16x16x64_bf16 v[124:127], v[52:55], v[184:191], v1
    ds_write2_b32 v30, v12, v13 offset0:0 offset1:72
    v_smfmac_f32_16x16x64_bf16 v[120:123], v[56:59], v[192:199], v1
    v_smfmac_f32_16x16x64_bf16 v[124:127], v[56:59], v[200:207], v1
    buffer_store_dword v2, v7, s[8:11], s43 offen
    v_smfmac_f32_16x16x64_bf16 v[120:123], v[60:63], v[208:215], v1
    s_mov_b32 s46, s38
    v_smfmac_f32_16x16x64_bf16 v[124:127], v[60:63], v[216:223], v1
    s_waitcnt lgkmcnt(0)
    s_barrier
    ds_read_b128 v[40:43], v9 offset:0
    v_smfmac_f32_16x16x64_bf16 v[120:123], v[64:67], v[224:231], v1
    ds_read_b128 v[44:47], v9 offset:64
    ds_read_b128 v[48:51], v9 offset:128
    v_smfmac_f32_16x16x64_bf16 v[124:127], v[64:67], v[232:239], v1
    ds_read_b128 v[52:55], v9 offset:192
    v_smfmac_f32_16x16x64_bf16 v[120:123], v[68:71], v[240:247], v1
    s_cmp_eq_u32 s40, 63
    v_smfmac_f32_16x16x64_bf16 v[124:127], v[68:71], v[248:255], v1
    ds_read_b128 v[56:59], v26 offset:2304
    s_waitcnt lgkmcnt(4)
    v_mfma_f32_16x16x32_bf16 v[104:107], v[72:75], v[40:43], 0
    ds_read_b128 v[60:63], v26 offset:2368
    ds_read_b128 v[64:67], v26 offset:2432
    v_mfma_f32_16x16x32_bf16 v[108:111], v[88:91], v[40:43], 0
    ds_read_b128 v[68:71], v26 offset:2496
    s_waitcnt lgkmcnt(4)
    v_mfma_f32_16x16x32_bf16 v[104:107], v[76:79], v[44:47], v[104:107]
    v_add_f32 v120, v120, v122
    v_add_f32 v121, v121, v123
    v_mfma_f32_16x16x32_bf16 v[108:111], v[92:95], v[44:47], v[108:111]
    v_add_f32 v124, v124, v126
    v_add_f32 v125, v125, v127
    v_mfma_f32_16x16x32_bf16 v[104:107], v[80:83], v[48:51], v[104:107]
    ds_read_b128 v[72:75], v11 offset:8192
    v_cvt_pk_bf16_f32 v14, v120, v121
    v_cvt_pk_bf16_f32 v15, v124, v125
    v_mfma_f32_16x16x32_bf16 v[108:111], v[96:99], v[48:51], v[108:111]
    ds_read_b128 v[88:91], v11 offset:2048
    s_cbranch_scc1 T1_fin
    v_cndmask_b32 v26, 0, v14, s[34:35]
    v_mfma_f32_16x16x32_bf16 v[104:107], v[84:87], v[52:55], v[104:107]
    ds_read_b128 v[76:79], v11 offset:12288
    v_cndmask_b32 v30, v14, 0, s[34:35]
    v_mfma_f32_16x16x32_bf16 v[108:111], v[100:103], v[52:55], v[108:111]
    ds_read_b128 v[92:95], v11 offset:6144
    s_waitcnt lgkmcnt(3)
    v_cndmask_b32 v34, 0, v15, s[34:35]
    v_cndmask_b32 v38, v15, 0, s[34:35]
    v_mfma_f32_16x16x32_bf16 v[112:115], v[56:59], v[40:43], 0
    ds_read_b128 v[80:83], v11 offset:9216
    v_mov_b64 v[120:121], 0
    v_mov_b64 v[122:123], 0
    v_mfma_f32_16x16x32_bf16 v[112:115], v[60:63], v[44:47], v[112:115]
    ds_read_b128 v[96:99], v11 offset:3072
    v_mov_b64 v[124:125], 0
    v_mov_b64 v[126:127], 0
    v_mfma_f32_16x16x32_bf16 v[112:115], v[64:67], v[48:51], v[112:115]
    ds_read_b128 v[84:87], v11 offset:13312
    v_max3_f32 v116, v104, v105, v106
    v_max3_f32 v117, v108, v109, v110
    v_mfma_f32_16x16x32_bf16 v[112:115], v[68:71], v[52:55], v[112:115]
    ds_read_b128 v[100:103], v11 offset:7168
    v_max3_f32 v116, v116, v107, v111
    v_max_f32 v116, v116, v117
    v_cndmask_b32 v104, v104, v108, s[32:33]
    v_cndmask_b32 v105, v105, v109, s[32:33]
    v_cndmask_b32 v106, v106, v110, s[32:33]
    v_cndmask_b32 v107, v107, v111, s[32:33]
    s_nop 0
    v_max3_f32 v114, v116, v112, v113
    v_max3_f32 v115, v116, v112, v113
    ds_read_b128 v[48:51], v11 offset:0
    s_nop 0
    v_permlane32_swap_b32 v114, v115
    v_max_f32 v116, v114, v115
    v_max_f32 v117, v114, v115
    ds_read_b128 v[52:55], v11 offset:4096
    s_nop 0
    v_permlane16_swap_b32 v116, v117
    v_max_f32 v114, v116, v117
    v_pk_add_f32 v[104:105], v[104:105], v[114:115] op_sel_hi:[1,0] neg_lo:[0,1] neg_hi:[0,1]
    v_pk_add_f32 v[106:107], v[106:107], v[114:115] op_sel_hi:[1,0] neg_lo:[0,1] neg_hi:[0,1]
    v_pk_add_f32 v[112:113], v[112:113], v[114:115] op_sel_hi:[1,0] neg_lo:[0,1] neg_hi:[0,1]
    v_pk_mul_f32 v[104:105], v[104:105], s[38:39] op_sel:[0,1] op_sel_hi:[1,1]
    v_pk_mul_f32 v[106:107], v[106:107], s[38:39] op_sel:[0,1] op_sel_hi:[1,1]
    v_pk_mul_f32 v[112:113], v[112:113], s[38:39] op_sel:[0,1] op_sel_hi:[1,1]
    v_exp_f32 v104, v104
    v_exp_f32 v105, v105
    v_exp_f32 v106, v106
    v_exp_f32 v107, v107
    v_exp_f32 v112, v112
    v_exp_f32 v113, v113
    v_cvt_pk_bf16_f32 v116, v104, v105
    v_cvt_pk_bf16_f32 v118, v106, v107
    v_cvt_pk_bf16_f32 v117, v112, v113
    v_cvt_pk_bf16_f32 v119, v112, v113
    ds_read_b128 v[40:43], v11 offset:1024
    v_mov_b64 v[104:105], 0
    v_mfma_f32_16x16x32_bf16 v[112:115], v[116:119], v[20:23], 0
    ds_read_b128 v[44:47], v11 offset:5120
    v_mov_b64 v[106:107], 0
    v_mov_b64 v[108:109], 0
    v_smfmac_f32_16x16x64_bf16 v[120:123], v[116:119], v[24:31], v1
    ds_read_b128 v[56:59], v11 offset:10240
    ds_read_b128 v[60:63], v11 offset:14336
    v_mov_b64 v[110:111], 0
    v_smfmac_f32_16x16x64_bf16 v[124:127], v[116:119], v[32:39], v1
    ds_read_b128 v[64:67], v11 offset:11264
    ds_read_b128 v[68:71], v11 offset:15360
    v_add_f32 v112, v112, v114
    v_add_f32 v113, v113, v115
    v_rcp_f32 v112, v112
    v_rcp_f32 v113, v113
    v_pk_add_f32 v[120:121], v[120:121], v[122:123]
    s_nop 0
    v_pk_add_f32 v[124:125], v[124:125], v[126:127]
    v_pk_mul_f32 v[120:121], v[120:121], v[112:113]
    v_pk_mul_f32 v[124:125], v[124:125], v[112:113]
    v_cvt_pk_bf16_f32 v122, v120, v124
    v_cvt_pk_bf16_f32 v123, v121, v125
    ds_write_b32 v8, v122
    ds_write_b32 v8, v123 offset:288
    v_mov_b64 v[24:25], 0
    v_mov_b64 v[26:27], 0
    v_mov_b64 v[28:29], 0
    v_mov_b64 v[30:31], 0
    v_mov_b64 v[32:33], 0
    s_waitcnt lgkmcnt(0)
    s_barrier
    ds_read_b128 v[120:123], v10 offset:4608
    ds_read_b128 v[124:127], v10 offset:4736
    v_mov_b64 v[34:35], 0
    v_mov_b64 v[36:37], 0
    v_mov_b64 v[38:39], 0
    s_waitcnt lgkmcnt(1)
    v_smfmac_f32_16x16x64_bf16 v[24:27], v[120:123], v[48:55], v1
    ds_read_b128 v[48:51], v11 offset:32768
    ds_read_b128 v[52:55], v11 offset:36864
    s_waitcnt lgkmcnt(2)
    v_smfmac_f32_16x16x64_bf16 v[28:31], v[120:123], v[40:47], v1
    ds_read_b128 v[40:43], v11 offset:33792
    ds_read_b128 v[44:47], v11 offset:37888
    v_smfmac_f32_16x16x64_bf16 v[24:27], v[124:127], v[72:79], v1
    ds_read_b128 v[72:75], v11 offset:40960
    v_smfmac_f32_16x16x64_bf16 v[28:31], v[124:127], v[80:87], v1
    ds_read_b128 v[76:79], v11 offset:45056
    ds_read_b128 v[80:83], v11 offset:41984
    v_smfmac_f32_16x16x64_bf16 v[32:35], v[120:123], v[88:95], v1
    ds_read_b128 v[84:87], v11 offset:46080
    s_nop 1
    v_add_f32 v24, v24, v26
    v_add_f32 v25, v25, v27
    v_add_f32 v28, v28, v30
    v_add_f32 v29, v29, v31
    v_smfmac_f32_16x16x64_bf16 v[36:39], v[120:123], v[96:103], v1
    ds_read_b128 v[88:91], v11 offset:34816
    ds_read_b128 v[92:95], v11 offset:38912
    v_cvt_pk_bf16_f32 v26, v24, v28
    v_cvt_pk_bf16_f32 v27, v25, v29
    v_smfmac_f32_16x16x64_bf16 v[32:35], v[124:127], v[56:63], v1
    ds_read_b128 v[96:99], v11 offset:35840
    buffer_store_dwordx2 v[26:27], v6, s[8:11], s44 offen offset:0
    v_mov_b64 v[112:113], 0
    v_mov_b64 v[114:115], 0
    v_smfmac_f32_16x16x64_bf16 v[36:39], v[124:127], v[64:71], v1
    ds_read_b128 v[100:103], v11 offset:39936
    s_waitcnt lgkmcnt(8)
    v_mov_b64 v[116:117], 0
    v_mov_b64 v[118:119], 0
    v_smfmac_f32_16x16x64_bf16 v[104:107], v[120:123], v[48:55], v1
    ds_read_b128 v[56:59], v11 offset:43008
    ds_read_b128 v[60:63], v11 offset:47104
    v_add_f32 v32, v32, v34
    v_smfmac_f32_16x16x64_bf16 v[108:111], v[120:123], v[40:47], v1
    ds_read_b128 v[64:67], v11 offset:44032
    s_waitcnt lgkmcnt(7)
    v_add_f32 v33, v33, v35
    v_smfmac_f32_16x16x64_bf16 v[104:107], v[124:127], v[72:79], v1
    ds_read_b128 v[68:71], v11 offset:48128
    v_add_f32 v36, v36, v38
    v_add_f32 v37, v37, v39
    v_smfmac_f32_16x16x64_bf16 v[108:111], v[124:127], v[80:87], v1
    s_waitcnt lgkmcnt(4)
    v_cvt_pk_bf16_f32 v34, v32, v36
    v_cvt_pk_bf16_f32 v35, v33, v37
    v_smfmac_f32_16x16x64_bf16 v[112:115], v[120:123], v[88:95], v1
    buffer_store_dwordx2 v[34:35], v6, s[8:11], s44 offen offset:2048
    v_add_f32 v104, v104, v106
    v_smfmac_f32_16x16x64_bf16 v[116:119], v[120:123], v[96:103], v1
    s_waitcnt lgkmcnt(0)
    v_add_f32 v105, v105, v107
    v_smfmac_f32_16x16x64_bf16 v[112:115], v[124:127], v[56:63], v1
    v_add_f32 v108, v108, v110
    v_add_f32 v109, v109, v111
    v_smfmac_f32_16x16x64_bf16 v[116:119], v[124:127], v[64:71], v1
    v_cvt_pk_bf16_f32 v106, v104, v108
    v_cvt_pk_bf16_f32 v107, v105, v109
    buffer_store_dwordx2 v[106:107], v6, s[8:11], s37 offen offset:0
    s_nop 1
    v_pk_add_f32 v[112:113], v[112:113], v[114:115]
    s_nop 1
    v_pk_add_f32 v[116:117], v[116:117], v[118:119]
    v_cvt_pk_bf16_f32 v114, v112, v116
    v_cvt_pk_bf16_f32 v115, v113, v117
    buffer_store_dwordx2 v[114:115], v6, s[8:11], s37 offen offset:2048
    s_mov_b32 s41, s42
    v_and_b32 v61, 0x310, v0
    v_and_b32 v62, 0x60, v0
    v_lshl_add_u32 v61, v62, 1, v61
    v_bfe_u32 v62, v0, 7, 1
    v_mul_u32_u24 v62, 4128, v62
    v_add3_u32 v61, v61, v62, s54
    ds_read_b128 v[72:75], v61 offset:0
    v_mov_b64 v[104:105], 0
    ds_read_b128 v[76:79], v61 offset:1024
    v_mov_b64 v[106:107], 0
    ds_read_b128 v[80:83], v61 offset:2048
    v_mov_b64 v[108:109], 0
    ds_read_b128 v[84:87], v61 offset:3072
    v_mov_b64 v[110:111], 0
    ds_read_b128 v[88:91], v61 offset:32
    v_mov_b64 v[112:113], 0
    ds_read_b128 v[92:95], v61 offset:1056
    v_mov_b64 v[114:115], 0
    ds_read_b128 v[96:99], v61 offset:2080
    v_mov_b64 v[116:117], 0
    buffer_load_dwordx4 v[48:51], v0, s[8:11], s56 offen sc1
    buffer_load_dwordx4 v[52:55], v0, s[8:11], s56 offen offset:1024 sc1
    ds_read_b128 v[100:103], v61 offset:3104
    v_mov_b64 v[118:119], 0
    v_mov_b64 v[120:121], 0
    v_mov_b64 v[122:123], 0
    v_mov_b64 v[124:125], 0
    v_mov_b64 v[126:127], 0
    v_add_u32 v63, s57, v0
    v_mov_b32 v27, 0
    v_mov_b32 v31, 0
    v_mov_b32 v35, 0
    v_mov_b32 v39, 0
    s_waitcnt vmcnt(13)
    ds_read_b64 v[24:25], v63 offset:0
    ds_read_b64 v[28:29], v63 offset:8
    ds_read_b64 v[32:33], v63 offset:1024
    ds_read_b64 v[36:37], v63 offset:1032
    v_add_u32 v38, 152192, v0
    s_add_u32 s40, s40, 1
    s_xor_b32 s50, s42, 0x20000
    s_mov_b32 s42, s43
    s_mov_b32 s43, s50
    s_xor_b32 s44, s44, 0x40000
    s_add_u32 s47, s47, 0x20000
    s_mov_b32 s49, 0
    s_mov_b32 s59, s54
    s_sub_u32 s54, 270400, s54
    s_add_u32 s58, s41, 0x1000
    s_add_u32 s51, s40, 2
T1_s1w1:
    buffer_load_dwordx4 v[48:51], v0, s[8:11], s56 offen sc1
    buffer_load_dwordx4 v[52:55], v0, s[8:11], s56 offen offset:1024 sc1
    s_add_u32 s49, s49, 1
    s_cmp_ge_u32 s49, 3000000
    s_cbranch_scc1 L_fail
    s_waitcnt vmcnt(2)
    v_max3_u32 v60, v48, v49, v50
    v_max3_u32 v60, v60, v51, v52
    v_mfma_f32_16x16x32_bf16 v[56:59], v[16:19], v[48:51], 0
    v_max3_u32 v60, v60, v53, v54
    v_max_u32 v60, v60, v55
    v_mfma_f32_16x16x32_bf16 v[56:59], v[16:19], v[52:55], v[56:59]
    v_cmp_eq_u32 vcc, s36, v60
    s_nop 6
    v_add_f32_dpp v56, v56, v56 row_ror:4 row_mask:0xf bank_mask:0xf
    v_add_f32_dpp v57, v57, v57 row_ror:4 row_mask:0xf bank_mask:0xf
    s_nop 0
    v_add_f32_dpp v56, v56, v56 row_ror:8 row_mask:0xf bank_mask:0xf
    v_add_f32_dpp v57, v57, v57 row_ror:8 row_mask:0xf bank_mask:0xf
    v_cvt_pk_bf16_f32 v64, v56, v57
    s_cbranch_vccnz T1_s1w1
T1_s1w1ok:
    buffer_store_dword v64, v7, s[8:11], s41 offen
    s_xor_b32 s56, s56, 0x40000
    v_bfe_u32 v68, v0, 4, 3
    v_min_u32 v68, 5, v68
    v_bfe_u32 v66, v0, 7, 1
    v_lshl_add_u32 v66, v66, 3, v68
    v_lshlrev_b32 v66, 2, v66
    v_add_u32 v66, 162688, v66
    ds_read_b32 v67, v66
    s_waitcnt lgkmcnt(0)
    v_mad_u32_u24 v67, v67, 6, v68
    s_nop 1
    v_min_u32_dpp v67, v67, v67 row_ror:8 row_mask:0xf bank_mask:0xf
    s_nop 1
    v_min_u32_dpp v67, v67, v67 row_ror:4 row_mask:0xf bank_mask:0xf
    s_nop 1
    v_min_u32_dpp v67, v67, v67 row_ror:2 row_mask:0xf bank_mask:0xf
    s_nop 1
    v_min_u32_dpp v67, v67, v67 row_ror:1 row_mask:0xf bank_mask:0xf
    s_nop 0
    v_readfirstlane_b32 s7, v67
    s_nop 0
    s_cmp_ge_u32 s51, s7
    s_cbranch_scc1 T1_kvw1
T1_kvo1:
    s_waitcnt lgkmcnt(0)
    s_barrier
    buffer_load_dwordx4 v[48:51], v0, s[8:11], s41 offen offset:2048 sc1
    buffer_load_dwordx4 v[52:55], v0, s[8:11], s41 offen offset:3072 sc1
    s_barrier
    ds_read_b128 v[40:43], v38
    ds_read_b128 v[44:47], v38 offset:1024
    s_branch T1_p2go
    s_waitcnt lgkmcnt(0)
T1_kvw1:
    v_bfe_u32 v68, v0, 4, 3
    v_min_u32 v68, 5, v68
    v_bfe_u32 v66, v0, 7, 1
    v_lshl_add_u32 v66, v66, 3, v68
    v_lshlrev_b32 v66, 2, v66
    s_mov_b32 s49, 0
T1_kvl1:
    buffer_load_dword v67, v66, s[8:11], s6 offen sc1
    s_waitcnt vmcnt(0)
    v_mad_u32_u24 v67, v67, 6, v68
    s_nop 1
    v_min_u32_dpp v67, v67, v67 row_ror:8 row_mask:0xf bank_mask:0xf
    s_nop 1
    v_min_u32_dpp v67, v67, v67 row_ror:4 row_mask:0xf bank_mask:0xf
    s_nop 1
    v_min_u32_dpp v67, v67, v67 row_ror:2 row_mask:0xf bank_mask:0xf
    s_nop 1
    v_min_u32_dpp v67, v67, v67 row_ror:1 row_mask:0xf bank_mask:0xf
    s_nop 0
    v_readfirstlane_b32 s7, v67
    s_add_u32 s49, s49, 1
    s_cmp_ge_u32 s49, 3000000
    s_cbranch_scc1 L_fail
    s_cmp_ge_u32 s51, s7
    s_cbranch_scc1 T1_kvl1
    s_mov_b32 s49, 0
    s_branch T1_kvo1
    s_waitcnt lgkmcnt(0)
T1_redo:
    s_add_u32 s49, s49, 1
    s_cmp_ge_u32 s49, 3000000
    s_cbranch_scc1 L_fail
    s_nop 7
    v_mov_b64 v[104:105], 0
    v_mov_b64 v[106:107], 0
    v_mov_b64 v[108:109], 0
    v_mov_b64 v[110:111], 0
    v_mov_b64 v[112:113], 0
    v_mov_b64 v[114:115], 0
    v_mov_b64 v[116:117], 0
    v_mov_b64 v[118:119], 0
    v_mov_b64 v[120:121], 0
    v_mov_b64 v[122:123], 0
    v_mov_b64 v[124:125], 0
    v_mov_b64 v[126:127], 0
    s_branch T1_p2ok
T1_fin:
    s_waitcnt lgkmcnt(0)
    s_add_u32 s47, s47, 0x20000
    buffer_store_dwordx4 v[12:15], v0, s[8:11], s47 offen sc1
    s_waitcnt vmcnt(0)
    s_endpgm
T_full2:
    s_mov_b32 s49, 0
    buffer_load_dwordx4 v[40:43], v0, s[8:11], s41 offen sc1
    buffer_load_dwordx4 v[44:47], v0, s[8:11], s41 offen offset:1024 sc1
    s_add_u32 s58, s41, 0x1000
    s_waitcnt vmcnt(0)
.p2align 6
    s_nop 0
    s_nop 0
T2_p2ok:
    buffer_load_dwordx4 v[48:51], v0, s[8:11], s41 offen offset:2048 sc1
    buffer_load_dwordx4 v[52:55], v0, s[8:11], s41 offen offset:3072 sc1
T2_p2go:
    buffer_load_dwordx4 v[56:59], v0, s[8:11], s58 offen offset:0 sc1
    s_waitcnt lgkmcnt(1)
    v_smfmac_f32_16x16x64_bf16 v[104:107], v[40:43], a[0:7], v1
    s_xor_b32 s45, s56, 0x40000
    v_smfmac_f32_16x16x64_bf16 v[108:111], v[40:43], a[8:15], v1
    s_waitcnt lgkmcnt(0)
    v_smfmac_f32_16x16x64_bf16 v[104:107], v[44:47], a[16:23], v1
    buffer_load_dwordx4 v[60:63], v0, s[8:11], s58 offen offset:1024 sc1
    v_smfmac_f32_16x16x64_bf16 v[108:111], v[44:47], a[24:31], v1
    s_add_u32 s37, s44, 0x1000
    v_mov_b32 v26, v9
    v_smfmac_f32_16x16x64_bf16 v[112:115], v[40:43], a[128:135], v1
    v_smfmac_f32_16x16x64_bf16 v[116:119], v[40:43], a[136:143], v1
    buffer_load_dwordx4 v[64:67], v0, s[8:11], s58 offen offset:2048 sc1
    v_mov_b32_dpp v26, v9 row_shl:4 row_mask:0xf bank_mask:0x2
    v_smfmac_f32_16x16x64_bf16 v[112:115], v[44:47], a[144:151], v1
    v_smfmac_f32_16x16x64_bf16 v[116:119], v[44:47], a[152:159], v1
    v_mov_b32_dpp v26, v9 row_shr:4 row_mask:0xf bank_mask:0x4
    v_smfmac_f32_16x16x64_bf16 v[120:123], v[40:43], v[128:135], v1
    buffer_load_dwordx4 v[68:71], v0, s[8:11], s58 offen offset:3072 sc1
    v_smfmac_f32_16x16x64_bf16 v[124:127], v[40:43], v[136:143], v1
    v_smfmac_f32_16x16x64_bf16 v[120:123], v[44:47], v[144:151], v1
    v_subrev_u32 v38, 4608, v8
    v_smfmac_f32_16x16x64_bf16 v[124:127], v[44:47], v[152:159], v1
    s_waitcnt vmcnt(5)
    v_smfmac_f32_16x16x64_bf16 v[104:107], v[48:51], a[32:39], v1
    v_max_u32 v34, v48, v49
    v_smfmac_f32_16x16x64_bf16 v[108:111], v[48:51], a[40:47], v1
    s_mov_b32 m0, s57
    s_add_u32 s52, s46, 0x1000000
    v_max3_u32 v34, v34, v50, v51
    v_smfmac_f32_16x16x64_bf16 v[112:115], v[48:51], a[160:167], v1
    buffer_load_dwordx4 v0, s[8:11], s52 offen sc1 lds
    v_smfmac_f32_16x16x64_bf16 v[116:119], v[48:51], a[168:175], v1
    s_waitcnt vmcnt(5)
    v_smfmac_f32_16x16x64_bf16 v[104:107], v[52:55], a[48:55], v1
    v_max3_u32 v34, v34, v52, v53
    v_smfmac_f32_16x16x64_bf16 v[108:111], v[52:55], a[56:63], v1
    v_max3_u32 v34, v34, v54, v55
    v_smfmac_f32_16x16x64_bf16 v[112:115], v[52:55], a[176:183], v1
    buffer_load_dwordx4 v0, s[8:11], s52 offen offset:1024 sc1 lds
    v_smfmac_f32_16x16x64_bf16 v[116:119], v[52:55], a[184:191], v1
    s_waitcnt vmcnt(5)
    v_smfmac_f32_16x16x64_bf16 v[104:107], v[56:59], a[64:71], v1
    v_max3_u32 v34, v34, v56, v57
    v_smfmac_f32_16x16x64_bf16 v[108:111], v[56:59], a[72:79], v1
    s_add_u32 m0, s48, s59
    s_add_u32 s38, s46, 0x40000
    v_max3_u32 v34, v34, v58, v59
    v_smfmac_f32_16x16x64_bf16 v[112:115], v[56:59], a[192:199], v1
    buffer_load_dwordx4 v0, s[8:11], s38 offen sc1 lds
    v_smfmac_f32_16x16x64_bf16 v[116:119], v[56:59], a[200:207], v1
    s_waitcnt vmcnt(5)
    v_smfmac_f32_16x16x64_bf16 v[104:107], v[60:63], a[80:87], v1
    buffer_store_dwordx4 v[2:5], v0, s[8:11], s45 offen offset:0
    v_max3_u32 v34, v34, v60, v61
    v_smfmac_f32_16x16x64_bf16 v[108:111], v[60:63], a[88:95], v1
    v_max3_u32 v34, v34, v62, v63
    v_smfmac_f32_16x16x64_bf16 v[112:115], v[60:63], a[208:215], v1
    buffer_load_dwordx4 v0, s[8:11], s38 offen offset:1024 sc1 lds
    v_smfmac_f32_16x16x64_bf16 v[116:119], v[60:63], a[216:223], v1
    s_waitcnt vmcnt(6)
    v_smfmac_f32_16x16x64_bf16 v[104:107], v[64:67], a[96:103], v1
    buffer_store_dword v1, off, s[8:11], s53 sc1
    s_mov_b32 s53, 0x7fffff00
    v_max3_u32 v34, v34, v64, v65
    v_smfmac_f32_16x16x64_bf16 v[108:111], v[64:67], a[104:111], v1
    v_max3_u32 v34, v34, v66, v67
    v_smfmac_f32_16x16x64_bf16 v[112:115], v[64:67], a[224:231], v1
    buffer_store_dwordx4 v[2:5], v0, s[8:11], s45 offen offset:1024
    v_smfmac_f32_16x16x64_bf16 v[116:119], v[64:67], a[232:239], v1
    s_waitcnt vmcnt(7)
    v_subrev_u32 v30, 2304, v8
    v_smfmac_f32_16x16x64_bf16 v[104:107], v[68:71], a[112:119], v1
    v_max3_u32 v34, v34, v68, v69
    v_smfmac_f32_16x16x64_bf16 v[108:111], v[68:71], a[120:127], v1
    s_nop 1
    v_max3_u32 v34, v34, v70, v71
    v_smfmac_f32_16x16x64_bf16 v[112:115], v[68:71], a[240:247], v1
    v_cmp_eq_u32 vcc, s36, v34
    v_smfmac_f32_16x16x64_bf16 v[116:119], v[68:71], a[248:255], v1
    v_add_f32 v104, v104, v106
    v_add_f32 v105, v105, v107
    v_add_f32 v108, v108, v110
    v_add_f32 v109, v109, v111
    v_smfmac_f32_16x16x64_bf16 v[120:123], v[48:51], v[160:167], v1
    s_cbranch_vccnz T2_redo
    buffer_store_dwordx4 v[12:15], v0, s[8:11], s47 offen sc1
    v_cvt_pk_bf16_f32 v106, v104, v108
    v_cvt_pk_bf16_f32 v107, v105, v109
    v_smfmac_f32_16x16x64_bf16 v[124:127], v[48:51], v[168:175], v1
    ds_write2_b32 v38, v106, v107 offset0:0 offset1:72
    v_add_f32 v112, v112, v114
    v_add_f32 v113, v113, v115
    v_add_f32 v116, v116, v118
    v_add_f32 v117, v117, v119
    v_smfmac_f32_16x16x64_bf16 v[120:123], v[52:55], v[176:183], v1
    v_cvt_pk_bf16_f32 v12, v112, v116
    v_cvt_pk_bf16_f32 v13, v113, v117
    v_smfmac_f32_16x16x64_bf16 v[124:127], v[52:55], v[184:191], v1
    ds_write2_b32 v30, v12, v13 offset0:0 offset1:72
    v_smfmac_f32_16x16x64_bf16 v[120:123], v[56:59], v[192:199], v1
    v_smfmac_f32_16x16x64_bf16 v[124:127], v[56:59], v[200:207], v1
    buffer_store_dword v2, v7, s[8:11], s43 offen
    v_smfmac_f32_16x16x64_bf16 v[120:123], v[60:63], v[208:215], v1
    s_mov_b32 s46, s38
    v_smfmac_f32_16x16x64_bf16 v[124:127], v[60:63], v[216:223], v1
    s_waitcnt lgkmcnt(0)
    s_barrier
    ds_read_b128 v[40:43], v9 offset:0
    v_smfmac_f32_16x16x64_bf16 v[120:123], v[64:67], v[224:231], v1
    ds_read_b128 v[44:47], v9 offset:64
    ds_read_b128 v[48:51], v9 offset:128
    v_smfmac_f32_16x16x64_bf16 v[124:127], v[64:67], v[232:239], v1
    ds_read_b128 v[52:55], v9 offset:192
    v_smfmac_f32_16x16x64_bf16 v[120:123], v[68:71], v[240:247], v1
    s_cmp_eq_u32 s40, 63
    v_smfmac_f32_16x16x64_bf16 v[124:127], v[68:71], v[248:255], v1
    ds_read_b128 v[56:59], v26 offset:2304
    s_waitcnt lgkmcnt(4)
    v_mfma_f32_16x16x32_bf16 v[104:107], v[72:75], v[40:43], 0
    ds_read_b128 v[60:63], v26 offset:2368
    ds_read_b128 v[64:67], v26 offset:2432
    v_mfma_f32_16x16x32_bf16 v[108:111], v[88:91], v[40:43], 0
    ds_read_b128 v[68:71], v26 offset:2496
    s_waitcnt lgkmcnt(4)
    v_mfma_f32_16x16x32_bf16 v[104:107], v[76:79], v[44:47], v[104:107]
    v_add_f32 v120, v120, v122
    v_add_f32 v121, v121, v123
    v_mfma_f32_16x16x32_bf16 v[108:111], v[92:95], v[44:47], v[108:111]
    v_add_f32 v124, v124, v126
    v_add_f32 v125, v125, v127
    v_mfma_f32_16x16x32_bf16 v[104:107], v[80:83], v[48:51], v[104:107]
    ds_read_b128 v[72:75], v11 offset:8192
    v_cvt_pk_bf16_f32 v14, v120, v121
    v_cvt_pk_bf16_f32 v15, v124, v125
    v_mfma_f32_16x16x32_bf16 v[108:111], v[96:99], v[48:51], v[108:111]
    ds_read_b128 v[88:91], v11 offset:2048
    s_cbranch_scc1 T2_fin
    v_cndmask_b32 v26, 0, v14, s[34:35]
    v_mfma_f32_16x16x32_bf16 v[104:107], v[84:87], v[52:55], v[104:107]
    ds_read_b128 v[76:79], v11 offset:12288
    v_cndmask_b32 v30, v14, 0, s[34:35]
    v_mfma_f32_16x16x32_bf16 v[108:111], v[100:103], v[52:55], v[108:111]
    ds_read_b128 v[92:95], v11 offset:6144
    s_waitcnt lgkmcnt(3)
    v_cndmask_b32 v34, 0, v15, s[34:35]
    v_cndmask_b32 v38, v15, 0, s[34:35]
    v_mfma_f32_16x16x32_bf16 v[112:115], v[56:59], v[40:43], 0
    ds_read_b128 v[80:83], v11 offset:9216
    v_mov_b64 v[120:121], 0
    v_mov_b64 v[122:123], 0
    v_mfma_f32_16x16x32_bf16 v[112:115], v[60:63], v[44:47], v[112:115]
    ds_read_b128 v[96:99], v11 offset:3072
    v_mov_b64 v[124:125], 0
    v_mov_b64 v[126:127], 0
    v_mfma_f32_16x16x32_bf16 v[112:115], v[64:67], v[48:51], v[112:115]
    ds_read_b128 v[84:87], v11 offset:13312
    v_max3_f32 v116, v104, v105, v106
    v_max3_f32 v117, v108, v109, v110
    v_mfma_f32_16x16x32_bf16 v[112:115], v[68:71], v[52:55], v[112:115]
    ds_read_b128 v[100:103], v11 offset:7168
    v_max3_f32 v116, v116, v107, v111
    v_max_f32 v116, v116, v117
    v_cndmask_b32 v104, v104, v108, s[32:33]
    v_cndmask_b32 v105, v105, v109, s[32:33]
    v_cndmask_b32 v106, v106, v110, s[32:33]
    v_cndmask_b32 v107, v107, v111, s[32:33]
    s_nop 0
    v_max3_f32 v114, v116, v112, v113
    v_max3_f32 v115, v116, v112, v113
    ds_read_b128 v[48:51], v11 offset:0
    s_nop 0
    v_permlane32_swap_b32 v114, v115
    v_max_f32 v116, v114, v115
    v_max_f32 v117, v114, v115
    ds_read_b128 v[52:55], v11 offset:4096
    s_nop 0
    v_permlane16_swap_b32 v116, v117
    v_max_f32 v114, v116, v117
    v_pk_add_f32 v[104:105], v[104:105], v[114:115] op_sel_hi:[1,0] neg_lo:[0,1] neg_hi:[0,1]
    v_pk_add_f32 v[106:107], v[106:107], v[114:115] op_sel_hi:[1,0] neg_lo:[0,1] neg_hi:[0,1]
    v_pk_add_f32 v[112:113], v[112:113], v[114:115] op_sel_hi:[1,0] neg_lo:[0,1] neg_hi:[0,1]
    v_pk_mul_f32 v[104:105], v[104:105], s[38:39] op_sel:[0,1] op_sel_hi:[1,1]
    v_pk_mul_f32 v[106:107], v[106:107], s[38:39] op_sel:[0,1] op_sel_hi:[1,1]
    v_pk_mul_f32 v[112:113], v[112:113], s[38:39] op_sel:[0,1] op_sel_hi:[1,1]
    v_exp_f32 v104, v104
    v_exp_f32 v105, v105
    v_exp_f32 v106, v106
    v_exp_f32 v107, v107
    v_exp_f32 v112, v112
    v_exp_f32 v113, v113
    v_cvt_pk_bf16_f32 v116, v104, v105
    v_cvt_pk_bf16_f32 v118, v106, v107
    v_cvt_pk_bf16_f32 v117, v112, v113
    v_cvt_pk_bf16_f32 v119, v112, v113
    ds_read_b128 v[40:43], v11 offset:1024
    v_mov_b64 v[104:105], 0
    v_mfma_f32_16x16x32_bf16 v[112:115], v[116:119], v[20:23], 0
    ds_read_b128 v[44:47], v11 offset:5120
    v_mov_b64 v[106:107], 0
    v_mov_b64 v[108:109], 0
    v_smfmac_f32_16x16x64_bf16 v[120:123], v[116:119], v[24:31], v1
    ds_read_b128 v[56:59], v11 offset:10240
    ds_read_b128 v[60:63], v11 offset:14336
    v_mov_b64 v[110:111], 0
    v_smfmac_f32_16x16x64_bf16 v[124:127], v[116:119], v[32:39], v1
    ds_read_b128 v[64:67], v11 offset:11264
    ds_read_b128 v[68:71], v11 offset:15360
    v_add_f32 v112, v112, v114
    v_add_f32 v113, v113, v115
    v_rcp_f32 v112, v112
    v_rcp_f32 v113, v113
    v_pk_add_f32 v[120:121], v[120:121], v[122:123]
    s_nop 0
    v_pk_add_f32 v[124:125], v[124:125], v[126:127]
    v_pk_mul_f32 v[120:121], v[120:121], v[112:113]
    v_pk_mul_f32 v[124:125], v[124:125], v[112:113]
    v_cvt_pk_bf16_f32 v122, v120, v124
    v_cvt_pk_bf16_f32 v123, v121, v125
    ds_write_b32 v8, v122
    ds_write_b32 v8, v123 offset:288
    v_mov_b64 v[24:25], 0
    v_mov_b64 v[26:27], 0
    v_mov_b64 v[28:29], 0
    v_mov_b64 v[30:31], 0
    v_mov_b64 v[32:33], 0
    s_waitcnt lgkmcnt(0)
    s_barrier
    ds_read_b128 v[120:123], v10 offset:4608
    ds_read_b128 v[124:127], v10 offset:4736
    v_mov_b64 v[34:35], 0
    v_mov_b64 v[36:37], 0
    v_mov_b64 v[38:39], 0
    s_waitcnt lgkmcnt(1)
    v_smfmac_f32_16x16x64_bf16 v[24:27], v[120:123], v[48:55], v1
    ds_read_b128 v[48:51], v11 offset:32768
    ds_read_b128 v[52:55], v11 offset:36864
    s_waitcnt lgkmcnt(2)
    v_smfmac_f32_16x16x64_bf16 v[28:31], v[120:123], v[40:47], v1
    ds_read_b128 v[40:43], v11 offset:33792
    ds_read_b128 v[44:47], v11 offset:37888
    v_smfmac_f32_16x16x64_bf16 v[24:27], v[124:127], v[72:79], v1
    ds_read_b128 v[72:75], v11 offset:40960
    v_smfmac_f32_16x16x64_bf16 v[28:31], v[124:127], v[80:87], v1
    ds_read_b128 v[76:79], v11 offset:45056
    ds_read_b128 v[80:83], v11 offset:41984
    v_smfmac_f32_16x16x64_bf16 v[32:35], v[120:123], v[88:95], v1
    ds_read_b128 v[84:87], v11 offset:46080
    s_nop 1
    v_add_f32 v24, v24, v26
    v_add_f32 v25, v25, v27
    v_add_f32 v28, v28, v30
    v_add_f32 v29, v29, v31
    v_smfmac_f32_16x16x64_bf16 v[36:39], v[120:123], v[96:103], v1
    ds_read_b128 v[88:91], v11 offset:34816
    ds_read_b128 v[92:95], v11 offset:38912
    v_cvt_pk_bf16_f32 v26, v24, v28
    v_cvt_pk_bf16_f32 v27, v25, v29
    v_smfmac_f32_16x16x64_bf16 v[32:35], v[124:127], v[56:63], v1
    ds_read_b128 v[96:99], v11 offset:35840
    buffer_store_dwordx2 v[26:27], v6, s[8:11], s44 offen offset:0
    v_mov_b64 v[112:113], 0
    v_mov_b64 v[114:115], 0
    v_smfmac_f32_16x16x64_bf16 v[36:39], v[124:127], v[64:71], v1
    ds_read_b128 v[100:103], v11 offset:39936
    s_waitcnt lgkmcnt(8)
    v_mov_b64 v[116:117], 0
    v_mov_b64 v[118:119], 0
    v_smfmac_f32_16x16x64_bf16 v[104:107], v[120:123], v[48:55], v1
    ds_read_b128 v[56:59], v11 offset:43008
    ds_read_b128 v[60:63], v11 offset:47104
    v_add_f32 v32, v32, v34
    v_smfmac_f32_16x16x64_bf16 v[108:111], v[120:123], v[40:47], v1
    ds_read_b128 v[64:67], v11 offset:44032
    s_waitcnt lgkmcnt(7)
    v_add_f32 v33, v33, v35
    v_smfmac_f32_16x16x64_bf16 v[104:107], v[124:127], v[72:79], v1
    ds_read_b128 v[68:71], v11 offset:48128
    v_add_f32 v36, v36, v38
    v_add_f32 v37, v37, v39
    v_smfmac_f32_16x16x64_bf16 v[108:111], v[124:127], v[80:87], v1
    s_waitcnt lgkmcnt(4)
    v_cvt_pk_bf16_f32 v34, v32, v36
    v_cvt_pk_bf16_f32 v35, v33, v37
    v_smfmac_f32_16x16x64_bf16 v[112:115], v[120:123], v[88:95], v1
    buffer_store_dwordx2 v[34:35], v6, s[8:11], s44 offen offset:2048
    v_add_f32 v104, v104, v106
    v_smfmac_f32_16x16x64_bf16 v[116:119], v[120:123], v[96:103], v1
    s_waitcnt lgkmcnt(0)
    v_add_f32 v105, v105, v107
    v_smfmac_f32_16x16x64_bf16 v[112:115], v[124:127], v[56:63], v1
    v_add_f32 v108, v108, v110
    v_add_f32 v109, v109, v111
    v_smfmac_f32_16x16x64_bf16 v[116:119], v[124:127], v[64:71], v1
    v_cvt_pk_bf16_f32 v106, v104, v108
    v_cvt_pk_bf16_f32 v107, v105, v109
    buffer_store_dwordx2 v[106:107], v6, s[8:11], s37 offen offset:0
    s_nop 1
    v_pk_add_f32 v[112:113], v[112:113], v[114:115]
    s_nop 1
    v_pk_add_f32 v[116:117], v[116:117], v[118:119]
    v_cvt_pk_bf16_f32 v114, v112, v116
    v_cvt_pk_bf16_f32 v115, v113, v117
    buffer_store_dwordx2 v[114:115], v6, s[8:11], s37 offen offset:2048
    s_mov_b32 s41, s42
    v_and_b32 v61, 0x310, v0
    v_and_b32 v62, 0x60, v0
    v_lshl_add_u32 v61, v62, 1, v61
    v_bfe_u32 v62, v0, 7, 1
    v_mul_u32_u24 v62, 4128, v62
    v_add3_u32 v61, v61, v62, s54
    ds_read_b128 v[72:75], v61 offset:0
    v_mov_b64 v[104:105], 0
    ds_read_b128 v[76:79], v61 offset:1024
    v_mov_b64 v[106:107], 0
    ds_read_b128 v[80:83], v61 offset:2048
    v_mov_b64 v[108:109], 0
    ds_read_b128 v[84:87], v61 offset:3072
    v_mov_b64 v[110:111], 0
    ds_read_b128 v[88:91], v61 offset:32
    v_mov_b64 v[112:113], 0
    ds_read_b128 v[92:95], v61 offset:1056
    v_mov_b64 v[114:115], 0
    ds_read_b128 v[96:99], v61 offset:2080
    v_mov_b64 v[116:117], 0
    ds_read_b128 v[100:103], v61 offset:3104
    v_mov_b64 v[118:119], 0
    v_mov_b64 v[120:121], 0
    v_mov_b64 v[122:123], 0
    v_mov_b64 v[124:125], 0
    v_mov_b64 v[126:127], 0
    s_waitcnt vmcnt(2)
    buffer_load_dwordx4 v[48:51], v0, s[8:11], s56 offen sc1
    buffer_load_dwordx4 v[52:55], v0, s[8:11], s56 offen offset:1024 sc1
    v_add_u32 v63, s57, v0
    v_mov_b32 v27, 0
    v_mov_b32 v31, 0
    v_mov_b32 v35, 0
    v_mov_b32 v39, 0
    s_waitcnt vmcnt(13)
    ds_read_b64 v[24:25], v63 offset:0
    ds_read_b64 v[28:29], v63 offset:8
    ds_read_b64 v[32:33], v63 offset:1024
    ds_read_b64 v[36:37], v63 offset:1032
    v_add_u32 v38, 152192, v0
    s_add_u32 s40, s40, 1
    s_xor_b32 s50, s42, 0x20000
    s_mov_b32 s42, s43
    s_mov_b32 s43, s50
    s_xor_b32 s44, s44, 0x40000
    s_add_u32 s47, s47, 0x20000
    s_mov_b32 s49, 0
    s_mov_b32 s59, s54
    s_sub_u32 s54, 270400, s54
    s_add_u32 s58, s41, 0x1000
    s_add_u32 s51, s40, 2
T2_s1w2:
    buffer_load_dwordx4 v[48:51], v0, s[8:11], s56 offen sc1
    buffer_load_dwordx4 v[52:55], v0, s[8:11], s56 offen offset:1024 sc1
    s_add_u32 s49, s49, 1
    s_cmp_ge_u32 s49, 3000000
    s_cbranch_scc1 L_fail
    s_waitcnt vmcnt(2)
    v_max3_u32 v60, v48, v49, v50
    v_max3_u32 v60, v60, v51, v52
    v_mfma_f32_16x16x32_bf16 v[56:59], v[16:19], v[48:51], 0
    v_max3_u32 v60, v60, v53, v54
    v_max_u32 v60, v60, v55
    v_mfma_f32_16x16x32_bf16 v[56:59], v[16:19], v[52:55], v[56:59]
    v_cmp_eq_u32 vcc, s36, v60
    s_nop 6
    v_add_f32_dpp v56, v56, v56 row_ror:4 row_mask:0xf bank_mask:0xf
    v_add_f32_dpp v57, v57, v57 row_ror:4 row_mask:0xf bank_mask:0xf
    s_nop 0
    v_add_f32_dpp v56, v56, v56 row_ror:8 row_mask:0xf bank_mask:0xf
    v_add_f32_dpp v57, v57, v57 row_ror:8 row_mask:0xf bank_mask:0xf
    v_cvt_pk_bf16_f32 v64, v56, v57
    s_cbranch_vccnz T2_s1w2
T2_s1w2ok:
    buffer_store_dword v64, v7, s[8:11], s41 offen
    s_xor_b32 s56, s56, 0x40000
    s_waitcnt lgkmcnt(0)
    s_barrier
    buffer_load_dwordx4 v[48:51], v0, s[8:11], s41 offen offset:2048 sc1
    buffer_load_dwordx4 v[52:55], v0, s[8:11], s41 offen offset:3072 sc1
    s_barrier
    ds_read_b128 v[40:43], v38
    ds_read_b128 v[44:47], v38 offset:1024
    s_branch T2_p2go
    s_waitcnt lgkmcnt(0)
    s_waitcnt lgkmcnt(0)
T2_redo:
    s_add_u32 s49, s49, 1
    s_cmp_ge_u32 s49, 3000000
    s_cbranch_scc1 L_fail
    s_nop 7
    v_mov_b64 v[104:105], 0
    v_mov_b64 v[106:107], 0
    v_mov_b64 v[108:109], 0
    v_mov_b64 v[110:111], 0
    v_mov_b64 v[112:113], 0
    v_mov_b64 v[114:115], 0
    v_mov_b64 v[116:117], 0
    v_mov_b64 v[118:119], 0
    v_mov_b64 v[120:121], 0
    v_mov_b64 v[122:123], 0
    v_mov_b64 v[124:125], 0
    v_mov_b64 v[126:127], 0
    s_branch T2_p2ok
T2_fin:
    s_waitcnt lgkmcnt(0)
    s_add_u32 s47, s47, 0x20000
    buffer_store_dwordx4 v[12:15], v0, s[8:11], s47 offen sc1
    s_waitcnt vmcnt(0)
    s_endpgm
L_tslow:
    s_mov_b32 s49, 0
    buffer_load_dwordx4 v[40:43], v0, s[8:11], s41 offen sc1
    buffer_load_dwordx4 v[44:47], v0, s[8:11], s41 offen offset:1024 sc1
    s_add_u32 s58, s41, 0x1000
    s_waitcnt vmcnt(0)
.p2align 6
    s_nop 0
    s_nop 0
S_p2ok:
    buffer_load_dwordx4 v[48:51], v0, s[8:11], s41 offen offset:2048 sc1
    buffer_load_dwordx4 v[52:55], v0, s[8:11], s41 offen offset:3072 sc1
S_p2go:
    buffer_load_dwordx4 v[56:59], v0, s[8:11], s58 offen offset:0 sc1
    s_waitcnt lgkmcnt(1)
    v_smfmac_f32_16x16x64_bf16 v[104:107], v[40:43], a[0:7], v1
    s_xor_b32 s45, s56, 0x40000
    v_smfmac_f32_16x16x64_bf16 v[108:111], v[40:43], a[8:15], v1
    s_waitcnt lgkmcnt(0)
    v_smfmac_f32_16x16x64_bf16 v[104:107], v[44:47], a[16:23], v1
    buffer_load_dwordx4 v[60:63], v0, s[8:11], s58 offen offset:1024 sc1
    v_smfmac_f32_16x16x64_bf16 v[108:111], v[44:47], a[24:31], v1
    s_add_u32 s37, s44, 0x1000
    v_mov_b32 v26, v9
    v_smfmac_f32_16x16x64_bf16 v[112:115], v[40:43], a[128:135], v1
    v_smfmac_f32_16x16x64_bf16 v[116:119], v[40:43], a[136:143], v1
    buffer_load_dwordx4 v[64:67], v0, s[8:11], s58 offen offset:2048 sc1
    v_mov_b32_dpp v26, v9 row_shl:4 row_mask:0xf bank_mask:0x2
    v_smfmac_f32_16x16x64_bf16 v[112:115], v[44:47], a[144:151], v1
    v_smfmac_f32_16x16x64_bf16 v[116:119], v[44:47], a[152:159], v1
    v_mov_b32_dpp v26, v9 row_shr:4 row_mask:0xf bank_mask:0x4
    v_smfmac_f32_16x16x64_bf16 v[120:123], v[40:43], v[128:135], v1
    buffer_load_dwordx4 v[68:71], v0, s[8:11], s58 offen offset:3072 sc1
    v_smfmac_f32_16x16x64_bf16 v[124:127], v[40:43], v[136:143], v1
    v_smfmac_f32_16x16x64_bf16 v[120:123], v[44:47], v[144:151], v1
    v_subrev_u32 v38, 4608, v8
    v_smfmac_f32_16x16x64_bf16 v[124:127], v[44:47], v[152:159], v1
    s_waitcnt vmcnt(5)
    v_smfmac_f32_16x16x64_bf16 v[104:107], v[48:51], a[32:39], v1
    v_max_u32 v34, v48, v49
    v_smfmac_f32_16x16x64_bf16 v[108:111], v[48:51], a[40:47], v1
    s_mov_b32 m0, s57
    s_add_u32 s52, s46, 0x1000000
    v_max3_u32 v34, v34, v50, v51
    v_smfmac_f32_16x16x64_bf16 v[112:115], v[48:51], a[160:167], v1
    buffer_load_dwordx4 v0, s[8:11], s52 offen sc1 lds
    v_smfmac_f32_16x16x64_bf16 v[116:119], v[48:51], a[168:175], v1
    s_waitcnt vmcnt(5)
    v_smfmac_f32_16x16x64_bf16 v[104:107], v[52:55], a[48:55], v1
    v_max3_u32 v34, v34, v52, v53
    v_smfmac_f32_16x16x64_bf16 v[108:111], v[52:55], a[56:63], v1
    v_max3_u32 v34, v34, v54, v55
    v_smfmac_f32_16x16x64_bf16 v[112:115], v[52:55], a[176:183], v1
    buffer_load_dwordx4 v0, s[8:11], s52 offen offset:1024 sc1 lds
    v_smfmac_f32_16x16x64_bf16 v[116:119], v[52:55], a[184:191], v1
    s_waitcnt vmcnt(5)
    v_smfmac_f32_16x16x64_bf16 v[104:107], v[56:59], a[64:71], v1
    v_max3_u32 v34, v34, v56, v57
    v_smfmac_f32_16x16x64_bf16 v[108:111], v[56:59], a[72:79], v1
    s_add_u32 m0, s48, s59
    s_add_u32 s38, s46, 0x40000
    v_max3_u32 v34, v34, v58, v59
    v_smfmac_f32_16x16x64_bf16 v[112:115], v[56:59], a[192:199], v1
    buffer_load_dwordx4 v0, s[8:11], s38 offen sc1 lds
    v_smfmac_f32_16x16x64_bf16 v[116:119], v[56:59], a[200:207], v1
    s_waitcnt vmcnt(5)
    v_smfmac_f32_16x16x64_bf16 v[104:107], v[60:63], a[80:87], v1
    buffer_store_dwordx4 v[2:5], v0, s[8:11], s45 offen offset:0 sc1
    v_max3_u32 v34, v34, v60, v61
    v_smfmac_f32_16x16x64_bf16 v[108:111], v[60:63], a[88:95], v1
    v_max3_u32 v34, v34, v62, v63
    v_smfmac_f32_16x16x64_bf16 v[112:115], v[60:63], a[208:215], v1
    buffer_load_dwordx4 v0, s[8:11], s38 offen offset:1024 sc1 lds
    v_smfmac_f32_16x16x64_bf16 v[116:119], v[60:63], a[216:223], v1
    s_waitcnt vmcnt(6)
    v_smfmac_f32_16x16x64_bf16 v[104:107], v[64:67], a[96:103], v1
    buffer_store_dword v1, off, s[8:11], s53 sc1
    s_mov_b32 s53, 0x7fffff00
    v_max3_u32 v34, v34, v64, v65
    v_smfmac_f32_16x16x64_bf16 v[108:111], v[64:67], a[104:111], v1
    v_max3_u32 v34, v34, v66, v67
    v_smfmac_f32_16x16x64_bf16 v[112:115], v[64:67], a[224:231], v1
    buffer_store_dwordx4 v[2:5], v0, s[8:11], s45 offen offset:1024 sc1
    v_smfmac_f32_16x16x64_bf16 v[116:119], v[64:67], a[232:239], v1
    s_waitcnt vmcnt(7)
    v_subrev_u32 v30, 2304, v8
    v_smfmac_f32_16x16x64_bf16 v[104:107], v[68:71], a[112:119], v1
    v_max3_u32 v34, v34, v68, v69
    v_smfmac_f32_16x16x64_bf16 v[108:111], v[68:71], a[120:127], v1
    s_nop 1
    v_max3_u32 v34, v34, v70, v71
    v_smfmac_f32_16x16x64_bf16 v[112:115], v[68:71], a[240:247], v1
    v_cmp_eq_u32 vcc, s36, v34
    v_smfmac_f32_16x16x64_bf16 v[116:119], v[68:71], a[248:255], v1
    v_add_f32 v104, v104, v106
    v_add_f32 v105, v105, v107
    v_add_f32 v108, v108, v110
    v_add_f32 v109, v109, v111
    v_smfmac_f32_16x16x64_bf16 v[120:123], v[48:51], v[160:167], v1
    s_cbranch_vccnz S_redo
    buffer_store_dwordx4 v[12:15], v0, s[8:11], s47 offen sc1
    v_cvt_pk_bf16_f32 v106, v104, v108
    v_cvt_pk_bf16_f32 v107, v105, v109
    v_smfmac_f32_16x16x64_bf16 v[124:127], v[48:51], v[168:175], v1
    ds_write2_b32 v38, v106, v107 offset0:0 offset1:72
    v_add_f32 v112, v112, v114
    v_add_f32 v113, v113, v115
    v_add_f32 v116, v116, v118
    v_add_f32 v117, v117, v119
    v_smfmac_f32_16x16x64_bf16 v[120:123], v[52:55], v[176:183], v1
    v_cvt_pk_bf16_f32 v12, v112, v116
    v_cvt_pk_bf16_f32 v13, v113, v117
    v_smfmac_f32_16x16x64_bf16 v[124:127], v[52:55], v[184:191], v1
    ds_write2_b32 v30, v12, v13 offset0:0 offset1:72
    v_smfmac_f32_16x16x64_bf16 v[120:123], v[56:59], v[192:199], v1
    v_smfmac_f32_16x16x64_bf16 v[124:127], v[56:59], v[200:207], v1
    buffer_store_dword v2, v7, s[8:11], s43 offen sc1
    v_smfmac_f32_16x16x64_bf16 v[120:123], v[60:63], v[208:215], v1
    s_mov_b32 s46, s38
    v_smfmac_f32_16x16x64_bf16 v[124:127], v[60:63], v[216:223], v1
    s_waitcnt lgkmcnt(0)
    s_barrier
    ds_read_b128 v[40:43], v9 offset:0
    v_smfmac_f32_16x16x64_bf16 v[120:123], v[64:67], v[224:231], v1
    ds_read_b128 v[44:47], v9 offset:64
    ds_read_b128 v[48:51], v9 offset:128
    v_smfmac_f32_16x16x64_bf16 v[124:127], v[64:67], v[232:239], v1
    ds_read_b128 v[52:55], v9 offset:192
    v_smfmac_f32_16x16x64_bf16 v[120:123], v[68:71], v[240:247], v1
    s_cmp_eq_u32 s40, 63
    v_smfmac_f32_16x16x64_bf16 v[124:127], v[68:71], v[248:255], v1
    ds_read_b128 v[56:59], v26 offset:2304
    s_waitcnt lgkmcnt(4)
    v_mfma_f32_16x16x32_bf16 v[104:107], v[72:75], v[40:43], 0
    ds_read_b128 v[60:63], v26 offset:2368
    ds_read_b128 v[64:67], v26 offset:2432
    v_mfma_f32_16x16x32_bf16 v[108:111], v[88:91], v[40:43], 0
    ds_read_b128 v[68:71], v26 offset:2496
    s_waitcnt lgkmcnt(4)
    v_mfma_f32_16x16x32_bf16 v[104:107], v[76:79], v[44:47], v[104:107]
    v_add_f32 v120, v120, v122
    v_add_f32 v121, v121, v123
    v_mfma_f32_16x16x32_bf16 v[108:111], v[92:95], v[44:47], v[108:111]
    v_add_f32 v124, v124, v126
    v_add_f32 v125, v125, v127
    v_mfma_f32_16x16x32_bf16 v[104:107], v[80:83], v[48:51], v[104:107]
    ds_read_b128 v[72:75], v11 offset:8192
    v_cvt_pk_bf16_f32 v14, v120, v121
    v_cvt_pk_bf16_f32 v15, v124, v125
    v_mfma_f32_16x16x32_bf16 v[108:111], v[96:99], v[48:51], v[108:111]
    ds_read_b128 v[88:91], v11 offset:2048
    s_cbranch_scc1 S_fin
    v_cndmask_b32 v26, 0, v14, s[34:35]
    v_mfma_f32_16x16x32_bf16 v[104:107], v[84:87], v[52:55], v[104:107]
    ds_read_b128 v[76:79], v11 offset:12288
    v_cndmask_b32 v30, v14, 0, s[34:35]
    v_mfma_f32_16x16x32_bf16 v[108:111], v[100:103], v[52:55], v[108:111]
    ds_read_b128 v[92:95], v11 offset:6144
    s_waitcnt lgkmcnt(3)
    v_cndmask_b32 v34, 0, v15, s[34:35]
    v_cndmask_b32 v38, v15, 0, s[34:35]
    v_mfma_f32_16x16x32_bf16 v[112:115], v[56:59], v[40:43], 0
    ds_read_b128 v[80:83], v11 offset:9216
    v_mov_b64 v[120:121], 0
    v_mov_b64 v[122:123], 0
    v_mfma_f32_16x16x32_bf16 v[112:115], v[60:63], v[44:47], v[112:115]
    ds_read_b128 v[96:99], v11 offset:3072
    v_mov_b64 v[124:125], 0
    v_mov_b64 v[126:127], 0
    v_mfma_f32_16x16x32_bf16 v[112:115], v[64:67], v[48:51], v[112:115]
    ds_read_b128 v[84:87], v11 offset:13312
    v_max3_f32 v116, v104, v105, v106
    v_max3_f32 v117, v108, v109, v110
    v_mfma_f32_16x16x32_bf16 v[112:115], v[68:71], v[52:55], v[112:115]
    ds_read_b128 v[100:103], v11 offset:7168
    v_max3_f32 v116, v116, v107, v111
    v_max_f32 v116, v116, v117
    v_cndmask_b32 v104, v104, v108, s[32:33]
    v_cndmask_b32 v105, v105, v109, s[32:33]
    v_cndmask_b32 v106, v106, v110, s[32:33]
    v_cndmask_b32 v107, v107, v111, s[32:33]
    s_nop 0
    v_max3_f32 v114, v116, v112, v113
    v_max3_f32 v115, v116, v112, v113
    ds_read_b128 v[48:51], v11 offset:0
    s_nop 0
    v_permlane32_swap_b32 v114, v115
    v_max_f32 v116, v114, v115
    v_max_f32 v117, v114, v115
    ds_read_b128 v[52:55], v11 offset:4096
    s_nop 0
    v_permlane16_swap_b32 v116, v117
    v_max_f32 v114, v116, v117
    v_pk_add_f32 v[104:105], v[104:105], v[114:115] op_sel_hi:[1,0] neg_lo:[0,1] neg_hi:[0,1]
    v_pk_add_f32 v[106:107], v[106:107], v[114:115] op_sel_hi:[1,0] neg_lo:[0,1] neg_hi:[0,1]
    v_pk_add_f32 v[112:113], v[112:113], v[114:115] op_sel_hi:[1,0] neg_lo:[0,1] neg_hi:[0,1]
    v_pk_mul_f32 v[104:105], v[104:105], s[38:39] op_sel:[0,1] op_sel_hi:[1,1]
    v_pk_mul_f32 v[106:107], v[106:107], s[38:39] op_sel:[0,1] op_sel_hi:[1,1]
    v_pk_mul_f32 v[112:113], v[112:113], s[38:39] op_sel:[0,1] op_sel_hi:[1,1]
    v_exp_f32 v104, v104
    v_exp_f32 v105, v105
    v_exp_f32 v106, v106
    v_exp_f32 v107, v107
    v_exp_f32 v112, v112
    v_exp_f32 v113, v113
    v_cvt_pk_bf16_f32 v116, v104, v105
    v_cvt_pk_bf16_f32 v118, v106, v107
    v_cvt_pk_bf16_f32 v117, v112, v113
    v_cvt_pk_bf16_f32 v119, v112, v113
    ds_read_b128 v[40:43], v11 offset:1024
    v_mov_b64 v[104:105], 0
    v_mfma_f32_16x16x32_bf16 v[112:115], v[116:119], v[20:23], 0
    ds_read_b128 v[44:47], v11 offset:5120
    v_mov_b64 v[106:107], 0
    v_mov_b64 v[108:109], 0
    v_smfmac_f32_16x16x64_bf16 v[120:123], v[116:119], v[24:31], v1
    ds_read_b128 v[56:59], v11 offset:10240
    ds_read_b128 v[60:63], v11 offset:14336
    v_mov_b64 v[110:111], 0
    v_smfmac_f32_16x16x64_bf16 v[124:127], v[116:119], v[32:39], v1
    ds_read_b128 v[64:67], v11 offset:11264
    ds_read_b128 v[68:71], v11 offset:15360
    v_add_f32 v112, v112, v114
    v_add_f32 v113, v113, v115
    v_rcp_f32 v112, v112
    v_rcp_f32 v113, v113
    v_pk_add_f32 v[120:121], v[120:121], v[122:123]
    s_nop 0
    v_pk_add_f32 v[124:125], v[124:125], v[126:127]
    v_pk_mul_f32 v[120:121], v[120:121], v[112:113]
    v_pk_mul_f32 v[124:125], v[124:125], v[112:113]
    v_cvt_pk_bf16_f32 v122, v120, v124
    v_cvt_pk_bf16_f32 v123, v121, v125
    s_cmp_eq_u32 s4, 0
    s_cbranch_scc1 S_w0
    s_cmp_eq_u32 s4, 1
    s_cbranch_scc1 S_w1
    s_cmp_eq_u32 s4, 2
    s_cbranch_scc1 S_w2
    ds_write_b32 v8, v122
    ds_write_b32 v8, v123 offset:288
    v_mov_b64 v[24:25], 0
    v_mov_b64 v[26:27], 0
    v_mov_b64 v[28:29], 0
    v_mov_b64 v[30:31], 0
    v_mov_b64 v[32:33], 0
    s_waitcnt lgkmcnt(0)
    s_barrier
    ds_read_b128 v[120:123], v10 offset:4608
    ds_read_b128 v[124:127], v10 offset:4736
    v_mov_b64 v[34:35], 0
    v_mov_b64 v[36:37], 0
    v_mov_b64 v[38:39], 0
    s_waitcnt lgkmcnt(1)
    v_smfmac_f32_16x16x64_bf16 v[24:27], v[120:123], v[48:55], v1
    ds_read_b128 v[48:51], v11 offset:32768
    ds_read_b128 v[52:55], v11 offset:36864
    s_waitcnt lgkmcnt(2)
    v_smfmac_f32_16x16x64_bf16 v[28:31], v[120:123], v[40:47], v1
    ds_read_b128 v[40:43], v11 offset:33792
    ds_read_b128 v[44:47], v11 offset:37888
    v_smfmac_f32_16x16x64_bf16 v[24:27], v[124:127], v[72:79], v1
    ds_read_b128 v[72:75], v11 offset:40960
    v_smfmac_f32_16x16x64_bf16 v[28:31], v[124:127], v[80:87], v1
    ds_read_b128 v[76:79], v11 offset:45056
    ds_read_b128 v[80:83], v11 offset:41984
    v_smfmac_f32_16x16x64_bf16 v[32:35], v[120:123], v[88:95], v1
    ds_read_b128 v[84:87], v11 offset:46080
    s_nop 1
    v_add_f32 v24, v24, v26
    v_add_f32 v25, v25, v27
    v_add_f32 v28, v28, v30
    v_add_f32 v29, v29, v31
    v_smfmac_f32_16x16x64_bf16 v[36:39], v[120:123], v[96:103], v1
    ds_read_b128 v[88:91], v11 offset:34816
    ds_read_b128 v[92:95], v11 offset:38912
    v_cvt_pk_bf16_f32 v26, v24, v28
    v_cvt_pk_bf16_f32 v27, v25, v29
    v_smfmac_f32_16x16x64_bf16 v[32:35], v[124:127], v[56:63], v1
    ds_read_b128 v[96:99], v11 offset:35840
    buffer_store_dwordx2 v[26:27], v6, s[8:11], s44 offen offset:0 sc1
    v_mov_b64 v[112:113], 0
    v_mov_b64 v[114:115], 0
    v_smfmac_f32_16x16x64_bf16 v[36:39], v[124:127], v[64:71], v1
    ds_read_b128 v[100:103], v11 offset:39936
    s_waitcnt lgkmcnt(8)
    v_mov_b64 v[116:117], 0
    v_mov_b64 v[118:119], 0
    v_smfmac_f32_16x16x64_bf16 v[104:107], v[120:123], v[48:55], v1
    ds_read_b128 v[56:59], v11 offset:43008
    ds_read_b128 v[60:63], v11 offset:47104
    v_add_f32 v32, v32, v34
    v_smfmac_f32_16x16x64_bf16 v[108:111], v[120:123], v[40:47], v1
    ds_read_b128 v[64:67], v11 offset:44032
    s_waitcnt lgkmcnt(7)
    v_add_f32 v33, v33, v35
    v_smfmac_f32_16x16x64_bf16 v[104:107], v[124:127], v[72:79], v1
    ds_read_b128 v[68:71], v11 offset:48128
    v_add_f32 v36, v36, v38
    v_add_f32 v37, v37, v39
    v_smfmac_f32_16x16x64_bf16 v[108:111], v[124:127], v[80:87], v1
    s_waitcnt lgkmcnt(4)
    v_cvt_pk_bf16_f32 v34, v32, v36
    v_cvt_pk_bf16_f32 v35, v33, v37
    v_smfmac_f32_16x16x64_bf16 v[112:115], v[120:123], v[88:95], v1
    buffer_store_dwordx2 v[34:35], v6, s[8:11], s44 offen offset:2048 sc1
    v_add_f32 v104, v104, v106
    v_smfmac_f32_16x16x64_bf16 v[116:119], v[120:123], v[96:103], v1
    s_waitcnt lgkmcnt(0)
    v_add_f32 v105, v105, v107
    v_smfmac_f32_16x16x64_bf16 v[112:115], v[124:127], v[56:63], v1
    v_add_f32 v108, v108, v110
    v_add_f32 v109, v109, v111
    v_smfmac_f32_16x16x64_bf16 v[116:119], v[124:127], v[64:71], v1
    v_cvt_pk_bf16_f32 v106, v104, v108
    v_cvt_pk_bf16_f32 v107, v105, v109
    buffer_store_dwordx2 v[106:107], v6, s[8:11], s37 offen offset:0 sc1
    s_nop 1
    v_pk_add_f32 v[112:113], v[112:113], v[114:115]
    s_nop 1
    v_pk_add_f32 v[116:117], v[116:117], v[118:119]
    v_cvt_pk_bf16_f32 v114, v112, v116
    v_cvt_pk_bf16_f32 v115, v113, v117
    buffer_store_dwordx2 v[114:115], v6, s[8:11], s37 offen offset:2048 sc1
    s_mov_b32 s41, s42
    v_and_b32 v61, 0x310, v0
    v_and_b32 v62, 0x60, v0
    v_lshl_add_u32 v61, v62, 1, v61
    v_bfe_u32 v62, v0, 7, 1
    v_mul_u32_u24 v62, 4128, v62
    v_add3_u32 v61, v61, v62, s54
    ds_read_b128 v[72:75], v61 offset:0
    v_mov_b64 v[104:105], 0
    ds_read_b128 v[76:79], v61 offset:1024
    v_mov_b64 v[106:107], 0
    ds_read_b128 v[80:83], v61 offset:2048
    v_mov_b64 v[108:109], 0
    ds_read_b128 v[84:87], v61 offset:3072
    v_mov_b64 v[110:111], 0
    ds_read_b128 v[88:91], v61 offset:32
    v_mov_b64 v[112:113], 0
    ds_read_b128 v[92:95], v61 offset:1056
    v_mov_b64 v[114:115], 0
    ds_read_b128 v[96:99], v61 offset:2080
    v_mov_b64 v[116:117], 0
    ds_read_b128 v[100:103], v61 offset:3104
    v_mov_b64 v[118:119], 0
    v_mov_b64 v[120:121], 0
    v_mov_b64 v[122:123], 0
    v_mov_b64 v[124:125], 0
    v_mov_b64 v[126:127], 0
    s_waitcnt vmcnt(1)
    buffer_load_dwordx4 v[48:51], v0, s[8:11], s56 offen sc1
    buffer_load_dwordx4 v[52:55], v0, s[8:11], s56 offen offset:1024 sc1
    v_add_u32 v63, s57, v0
    v_mov_b32 v27, 0
    v_mov_b32 v31, 0
    v_mov_b32 v35, 0
    v_mov_b32 v39, 0
    s_waitcnt vmcnt(4)
    ds_read_b64 v[24:25], v63 offset:0
    ds_read_b64 v[28:29], v63 offset:8
    ds_read_b64 v[32:33], v63 offset:1024
    ds_read_b64 v[36:37], v63 offset:1032
    v_add_u32 v38, 152192, v0
    s_add_u32 s40, s40, 1
    s_xor_b32 s50, s42, 0x20000
    s_mov_b32 s42, s43
    s_mov_b32 s43, s50
    s_xor_b32 s44, s44, 0x40000
    s_add_u32 s47, s47, 0x20000
    s_mov_b32 s49, 0
    s_mov_b32 s59, s54
    s_sub_u32 s54, 270400, s54
    s_add_u32 s58, s41, 0x1000
    s_add_u32 s51, s40, 2
S_s1w3:
    buffer_load_dwordx4 v[48:51], v0, s[8:11], s56 offen sc1
    buffer_load_dwordx4 v[52:55], v0, s[8:11], s56 offen offset:1024 sc1
    s_add_u32 s49, s49, 1
    s_cmp_ge_u32 s49, 3000000
    s_cbranch_scc1 L_fail
    s_waitcnt vmcnt(2)
    v_max3_u32 v60, v48, v49, v50
    v_max3_u32 v60, v60, v51, v52
    v_mfma_f32_16x16x32_bf16 v[56:59], v[16:19], v[48:51], 0
    v_max3_u32 v60, v60, v53, v54
    v_max_u32 v60, v60, v55
    v_mfma_f32_16x16x32_bf16 v[56:59], v[16:19], v[52:55], v[56:59]
    v_cmp_eq_u32 vcc, s36, v60
    s_nop 6
    v_add_f32_dpp v56, v56, v56 row_ror:4 row_mask:0xf bank_mask:0xf
    v_add_f32_dpp v57, v57, v57 row_ror:4 row_mask:0xf bank_mask:0xf
    s_nop 0
    v_add_f32_dpp v56, v56, v56 row_ror:8 row_mask:0xf bank_mask:0xf
    v_add_f32_dpp v57, v57, v57 row_ror:8 row_mask:0xf bank_mask:0xf
    v_cvt_pk_bf16_f32 v64, v56, v57
    s_cbranch_vccnz S_s1w3
S_s1w3ok:
    buffer_store_dword v64, v7, s[8:11], s41 offen sc1
    s_xor_b32 s56, s56, 0x40000
    s_waitcnt lgkmcnt(0)
    s_barrier
    buffer_load_dwordx4 v[48:51], v0, s[8:11], s41 offen offset:2048 sc1
    buffer_load_dwordx4 v[52:55], v0, s[8:11], s41 offen offset:3072 sc1
    s_barrier
    ds_read_b128 v[40:43], v38
    ds_read_b128 v[44:47], v38 offset:1024
    s_branch S_p2go
    s_waitcnt lgkmcnt(0)
    s_waitcnt lgkmcnt(0)
S_w0:
    ds_write_b32 v8, v122
    ds_write_b32 v8, v123 offset:288
    v_mov_b64 v[24:25], 0
    v_mov_b64 v[26:27], 0
    v_mov_b64 v[28:29], 0
    v_mov_b64 v[30:31], 0
    v_mov_b64 v[32:33], 0
    s_waitcnt lgkmcnt(0)
    s_barrier
    ds_read_b128 v[120:123], v10 offset:4608
    ds_read_b128 v[124:127], v10 offset:4736
    v_mov_b64 v[34:35], 0
    v_mov_b64 v[36:37], 0
    v_mov_b64 v[38:39], 0
    s_waitcnt lgkmcnt(1)
    v_smfmac_f32_16x16x64_bf16 v[24:27], v[120:123], v[48:55], v1
    ds_read_b128 v[48:51], v11 offset:32768
    ds_read_b128 v[52:55], v11 offset:36864
    s_waitcnt lgkmcnt(2)
    v_smfmac_f32_16x16x64_bf16 v[28:31], v[120:123], v[40:47], v1
    ds_read_b128 v[40:43], v11 offset:33792
    ds_read_b128 v[44:47], v11 offset:37888
    v_smfmac_f32_16x16x64_bf16 v[24:27], v[124:127], v[72:79], v1
    ds_read_b128 v[72:75], v11 offset:40960
    v_smfmac_f32_16x16x64_bf16 v[28:31], v[124:127], v[80:87], v1
    ds_read_b128 v[76:79], v11 offset:45056
    ds_read_b128 v[80:83], v11 offset:41984
    v_smfmac_f32_16x16x64_bf16 v[32:35], v[120:123], v[88:95], v1
    ds_read_b128 v[84:87], v11 offset:46080
    s_nop 1
    v_add_f32 v24, v24, v26
    v_add_f32 v25, v25, v27
    v_add_f32 v28, v28, v30
    v_add_f32 v29, v29, v31
    v_smfmac_f32_16x16x64_bf16 v[36:39], v[120:123], v[96:103], v1
    ds_read_b128 v[88:91], v11 offset:34816
    ds_read_b128 v[92:95], v11 offset:38912
    v_cvt_pk_bf16_f32 v26, v24, v28
    v_cvt_pk_bf16_f32 v27, v25, v29
    v_smfmac_f32_16x16x64_bf16 v[32:35], v[124:127], v[56:63], v1
    ds_read_b128 v[96:99], v11 offset:35840
    buffer_store_dwordx2 v[26:27], v6, s[8:11], s44 offen offset:0 sc1
    v_mov_b64 v[112:113], 0
    v_mov_b64 v[114:115], 0
    v_smfmac_f32_16x16x64_bf16 v[36:39], v[124:127], v[64:71], v1
    ds_read_b128 v[100:103], v11 offset:39936
    s_waitcnt lgkmcnt(8)
    v_mov_b64 v[116:117], 0
    v_mov_b64 v[118:119], 0
    v_smfmac_f32_16x16x64_bf16 v[104:107], v[120:123], v[48:55], v1
    ds_read_b128 v[56:59], v11 offset:43008
    ds_read_b128 v[60:63], v11 offset:47104
    v_add_f32 v32, v32, v34
    v_smfmac_f32_16x16x64_bf16 v[108:111], v[120:123], v[40:47], v1
    ds_read_b128 v[64:67], v11 offset:44032
    s_waitcnt lgkmcnt(7)
    v_add_f32 v33, v33, v35
    v_smfmac_f32_16x16x64_bf16 v[104:107], v[124:127], v[72:79], v1
    ds_read_b128 v[68:71], v11 offset:48128
    v_add_f32 v36, v36, v38
    v_add_f32 v37, v37, v39
    v_smfmac_f32_16x16x64_bf16 v[108:111], v[124:127], v[80:87], v1
    s_waitcnt lgkmcnt(4)
    v_cvt_pk_bf16_f32 v34, v32, v36
    v_cvt_pk_bf16_f32 v35, v33, v37
    v_smfmac_f32_16x16x64_bf16 v[112:115], v[120:123], v[88:95], v1
    buffer_store_dwordx2 v[34:35], v6, s[8:11], s44 offen offset:2048 sc1
    v_add_f32 v104, v104, v106
    v_smfmac_f32_16x16x64_bf16 v[116:119], v[120:123], v[96:103], v1
    s_waitcnt lgkmcnt(0)
    v_add_f32 v105, v105, v107
    v_smfmac_f32_16x16x64_bf16 v[112:115], v[124:127], v[56:63], v1
    buffer_load_dwordx4 v[48:51], v0, s[8:11], s56 offen sc1
    buffer_load_dwordx4 v[52:55], v0, s[8:11], s56 offen offset:1024 sc1
    v_add_f32 v108, v108, v110
    v_add_f32 v109, v109, v111
    v_smfmac_f32_16x16x64_bf16 v[116:119], v[124:127], v[64:71], v1
    v_cvt_pk_bf16_f32 v106, v104, v108
    v_cvt_pk_bf16_f32 v107, v105, v109
    buffer_store_dwordx2 v[106:107], v6, s[8:11], s37 offen offset:0 sc1
    v_pk_add_f32 v[112:113], v[112:113], v[114:115]
    s_nop 3
    v_pk_add_f32 v[116:117], v[116:117], v[118:119]
    v_cvt_pk_bf16_f32 v114, v112, v116
    v_cvt_pk_bf16_f32 v115, v113, v117
    buffer_store_dwordx2 v[114:115], v6, s[8:11], s37 offen offset:2048 sc1
    s_mov_b32 s41, s42
    buffer_load_dwordx4 v[48:51], v0, s[8:11], s56 offen sc1
    buffer_load_dwordx4 v[52:55], v0, s[8:11], s56 offen offset:1024 sc1
    v_and_b32 v61, 0x310, v0
    v_and_b32 v62, 0x60, v0
    v_lshl_add_u32 v61, v62, 1, v61
    v_bfe_u32 v62, v0, 7, 1
    v_mul_u32_u24 v62, 4128, v62
    v_add3_u32 v61, v61, v62, s54
    ds_read_b128 v[72:75], v61 offset:0
    v_mov_b64 v[104:105], 0
    ds_read_b128 v[76:79], v61 offset:1024
    v_mov_b64 v[106:107], 0
    ds_read_b128 v[80:83], v61 offset:2048
    v_mov_b64 v[108:109], 0
    s_waitcnt vmcnt(4)
    v_max3_u32 v60, v48, v49, v50
    v_max3_u32 v60, v60, v51, v52
    v_mfma_f32_16x16x32_bf16 v[56:59], v[16:19], v[48:51], 0
    v_max3_u32 v60, v60, v53, v54
    v_max_u32 v60, v60, v55
    v_mfma_f32_16x16x32_bf16 v[56:59], v[16:19], v[52:55], v[56:59]
    v_cmp_eq_u32 vcc, s36, v60
    s_nop 6
    v_add_f32_dpp v56, v56, v56 row_ror:4 row_mask:0xf bank_mask:0xf
    v_add_f32_dpp v57, v57, v57 row_ror:4 row_mask:0xf bank_mask:0xf
    s_nop 0
    v_add_f32_dpp v56, v56, v56 row_ror:8 row_mask:0xf bank_mask:0xf
    v_add_f32_dpp v57, v57, v57 row_ror:8 row_mask:0xf bank_mask:0xf
    v_cvt_pk_bf16_f32 v64, v56, v57
    s_cbranch_vccz S_s1w0ok
S_s1w0:
    buffer_load_dwordx4 v[48:51], v0, s[8:11], s56 offen sc1
    buffer_load_dwordx4 v[52:55], v0, s[8:11], s56 offen offset:1024 sc1
    s_add_u32 s49, s49, 1
    s_cmp_ge_u32 s49, 3000000
    s_cbranch_scc1 L_fail
    s_waitcnt vmcnt(2)
    v_max3_u32 v60, v48, v49, v50
    v_max3_u32 v60, v60, v51, v52
    v_mfma_f32_16x16x32_bf16 v[56:59], v[16:19], v[48:51], 0
    v_max3_u32 v60, v60, v53, v54
    v_max_u32 v60, v60, v55
    v_mfma_f32_16x16x32_bf16 v[56:59], v[16:19], v[52:55], v[56:59]
    v_cmp_eq_u32 vcc, s36, v60
    s_nop 6
    v_add_f32_dpp v56, v56, v56 row_ror:4 row_mask:0xf bank_mask:0xf
    v_add_f32_dpp v57, v57, v57 row_ror:4 row_mask:0xf bank_mask:0xf
    s_nop 0
    v_add_f32_dpp v56, v56, v56 row_ror:8 row_mask:0xf bank_mask:0xf
    v_add_f32_dpp v57, v57, v57 row_ror:8 row_mask:0xf bank_mask:0xf
    v_cvt_pk_bf16_f32 v64, v56, v57
    s_cbranch_vccnz S_s1w0
S_s1w0ok:
    buffer_store_dword v64, v7, s[8:11], s41 offen sc1
    s_xor_b32 s56, s56, 0x40000
    ds_read_b128 v[84:87], v61 offset:3072
    v_mov_b64 v[110:111], 0
    ds_read_b128 v[88:91], v61 offset:32
    v_mov_b64 v[112:113], 0
    ds_read_b128 v[92:95], v61 offset:1056
    v_mov_b64 v[114:115], 0
    ds_read_b128 v[96:99], v61 offset:2080
    v_mov_b64 v[116:117], 0
    buffer_load_dwordx4 v[40:43], v0, s[8:11], s41 offen sc1
    buffer_load_dwordx4 v[44:47], v0, s[8:11], s41 offen offset:1024 sc1
    ds_read_b128 v[100:103], v61 offset:3104
    v_mov_b64 v[118:119], 0
    v_mov_b64 v[120:121], 0
    v_mov_b64 v[122:123], 0
    v_mov_b64 v[124:125], 0
    v_mov_b64 v[126:127], 0
    v_add_u32 v63, s57, v0
    v_mov_b32 v27, 0
    v_mov_b32 v31, 0
    v_mov_b32 v35, 0
    v_mov_b32 v39, 0
    s_waitcnt vmcnt(4)
    ds_read_b64 v[24:25], v63 offset:0
    ds_read_b64 v[28:29], v63 offset:8
    ds_read_b64 v[32:33], v63 offset:1024
    ds_read_b64 v[36:37], v63 offset:1032
    buffer_load_dwordx4 v[40:43], v0, s[8:11], s41 offen sc1
    buffer_load_dwordx4 v[44:47], v0, s[8:11], s41 offen offset:1024 sc1
    v_add_u32 v38, 152192, v0
    s_add_u32 s40, s40, 1
    s_xor_b32 s50, s42, 0x20000
    s_mov_b32 s42, s43
    s_mov_b32 s43, s50
    s_xor_b32 s44, s44, 0x40000
    s_add_u32 s47, s47, 0x20000
    s_mov_b32 s49, 0
    s_mov_b32 s59, s54
    s_sub_u32 s54, 270400, s54
    s_add_u32 s58, s41, 0x1000
    s_add_u32 s51, s40, 2
S_s2:
    buffer_load_dwordx4 v[40:43], v0, s[8:11], s41 offen sc1
    buffer_load_dwordx4 v[44:47], v0, s[8:11], s41 offen offset:1024 sc1
    s_add_u32 s49, s49, 1
    s_cmp_ge_u32 s49, 3000000
    s_cbranch_scc1 L_fail
    s_waitcnt vmcnt(4)
    v_max3_u32 v34, v40, v41, v42
    v_max3_u32 v34, v34, v43, v44
    v_max3_u32 v34, v34, v45, v46
    v_max_u32 v34, v34, v47
    v_cmp_eq_u32 vcc, s36, v34
    s_cbranch_vccnz S_s2
S_s2ok:
    s_barrier
    ds_write_b128 v38, v[40:43]
    ds_write_b128 v38, v[44:47] offset:1024
    buffer_load_dwordx4 v[48:51], v0, s[8:11], s41 offen offset:2048 sc1
    buffer_load_dwordx4 v[52:55], v0, s[8:11], s41 offen offset:3072 sc1
    s_waitcnt lgkmcnt(0)
    s_barrier
    s_branch S_p2go
    s_waitcnt lgkmcnt(0)
    s_waitcnt lgkmcnt(0)
S_w1:
    ds_write_b32 v8, v122
    ds_write_b32 v8, v123 offset:288
    v_mov_b64 v[24:25], 0
    v_mov_b64 v[26:27], 0
    v_mov_b64 v[28:29], 0
    v_mov_b64 v[30:31], 0
    v_mov_b64 v[32:33], 0
    s_waitcnt lgkmcnt(0)
    s_barrier
    ds_read_b128 v[120:123], v10 offset:4608
    ds_read_b128 v[124:127], v10 offset:4736
    v_mov_b64 v[34:35], 0
    v_mov_b64 v[36:37], 0
    v_mov_b64 v[38:39], 0
    s_waitcnt lgkmcnt(1)
    v_smfmac_f32_16x16x64_bf16 v[24:27], v[120:123], v[48:55], v1
    ds_read_b128 v[48:51], v11 offset:32768
    ds_read_b128 v[52:55], v11 offset:36864
    s_waitcnt lgkmcnt(2)
    v_smfmac_f32_16x16x64_bf16 v[28:31], v[120:123], v[40:47], v1
    ds_read_b128 v[40:43], v11 offset:33792
    ds_read_b128 v[44:47], v11 offset:37888
    v_smfmac_f32_16x16x64_bf16 v[24:27], v[124:127], v[72:79], v1
    ds_read_b128 v[72:75], v11 offset:40960
    v_smfmac_f32_16x16x64_bf16 v[28:31], v[124:127], v[80:87], v1
    ds_read_b128 v[76:79], v11 offset:45056
    ds_read_b128 v[80:83], v11 offset:41984
    v_smfmac_f32_16x16x64_bf16 v[32:35], v[120:123], v[88:95], v1
    ds_read_b128 v[84:87], v11 offset:46080
    s_nop 1
    v_add_f32 v24, v24, v26
    v_add_f32 v25, v25, v27
    v_add_f32 v28, v28, v30
    v_add_f32 v29, v29, v31
    v_smfmac_f32_16x16x64_bf16 v[36:39], v[120:123], v[96:103], v1
    ds_read_b128 v[88:91], v11 offset:34816
    ds_read_b128 v[92:95], v11 offset:38912
    v_cvt_pk_bf16_f32 v26, v24, v28
    v_cvt_pk_bf16_f32 v27, v25, v29
    v_smfmac_f32_16x16x64_bf16 v[32:35], v[124:127], v[56:63], v1
    ds_read_b128 v[96:99], v11 offset:35840
    buffer_store_dwordx2 v[26:27], v6, s[8:11], s44 offen offset:0 sc1
    v_mov_b64 v[112:113], 0
    v_mov_b64 v[114:115], 0
    v_smfmac_f32_16x16x64_bf16 v[36:39], v[124:127], v[64:71], v1
    ds_read_b128 v[100:103], v11 offset:39936
    s_waitcnt lgkmcnt(8)
    v_mov_b64 v[116:117], 0
    v_mov_b64 v[118:119], 0
    v_smfmac_f32_16x16x64_bf16 v[104:107], v[120:123], v[48:55], v1
    ds_read_b128 v[56:59], v11 offset:43008
    ds_read_b128 v[60:63], v11 offset:47104
    v_add_f32 v32, v32, v34
    v_smfmac_f32_16x16x64_bf16 v[108:111], v[120:123], v[40:47], v1
    ds_read_b128 v[64:67], v11 offset:44032
    s_waitcnt lgkmcnt(7)
    v_add_f32 v33, v33, v35
    v_smfmac_f32_16x16x64_bf16 v[104:107], v[124:127], v[72:79], v1
    ds_read_b128 v[68:71], v11 offset:48128
    v_add_f32 v36, v36, v38
    v_add_f32 v37, v37, v39
    v_smfmac_f32_16x16x64_bf16 v[108:111], v[124:127], v[80:87], v1
    s_waitcnt lgkmcnt(4)
    v_cvt_pk_bf16_f32 v34, v32, v36
    v_cvt_pk_bf16_f32 v35, v33, v37
    v_smfmac_f32_16x16x64_bf16 v[112:115], v[120:123], v[88:95], v1
    buffer_store_dwordx2 v[34:35], v6, s[8:11], s44 offen offset:2048 sc1
    v_add_f32 v104, v104, v106
    v_smfmac_f32_16x16x64_bf16 v[116:119], v[120:123], v[96:103], v1
    s_waitcnt lgkmcnt(0)
    v_add_f32 v105, v105, v107
    v_smfmac_f32_16x16x64_bf16 v[112:115], v[124:127], v[56:63], v1
    v_add_f32 v108, v108, v110
    v_add_f32 v109, v109, v111
    v_smfmac_f32_16x16x64_bf16 v[116:119], v[124:127], v[64:71], v1
    v_cvt_pk_bf16_f32 v106, v104, v108
    v_cvt_pk_bf16_f32 v107, v105, v109
    buffer_store_dwordx2 v[106:107], v6, s[8:11], s37 offen offset:0 sc1
    s_nop 1
    v_pk_add_f32 v[112:113], v[112:113], v[114:115]
    s_nop 1
    v_pk_add_f32 v[116:117], v[116:117], v[118:119]
    v_cvt_pk_bf16_f32 v114, v112, v116
    v_cvt_pk_bf16_f32 v115, v113, v117
    buffer_store_dwordx2 v[114:115], v6, s[8:11], s37 offen offset:2048 sc1
    s_mov_b32 s41, s42
    v_and_b32 v61, 0x310, v0
    v_and_b32 v62, 0x60, v0
    v_lshl_add_u32 v61, v62, 1, v61
    v_bfe_u32 v62, v0, 7, 1
    v_mul_u32_u24 v62, 4128, v62
    v_add3_u32 v61, v61, v62, s54
    ds_read_b128 v[72:75], v61 offset:0
    v_mov_b64 v[104:105], 0
    ds_read_b128 v[76:79], v61 offset:1024
    v_mov_b64 v[106:107], 0
    ds_read_b128 v[80:83], v61 offset:2048
    v_mov_b64 v[108:109], 0
    ds_read_b128 v[84:87], v61 offset:3072
    v_mov_b64 v[110:111], 0
    ds_read_b128 v[88:91], v61 offset:32
    v_mov_b64 v[112:113], 0
    ds_read_b128 v[92:95], v61 offset:1056
    v_mov_b64 v[114:115], 0
    ds_read_b128 v[96:99], v61 offset:2080
    v_mov_b64 v[116:117], 0
    buffer_load_dwordx4 v[48:51], v0, s[8:11], s56 offen sc1
    buffer_load_dwordx4 v[52:55], v0, s[8:11], s56 offen offset:1024 sc1
    ds_read_b128 v[100:103], v61 offset:3104
    v_mov_b64 v[118:119], 0
    v_mov_b64 v[120:121], 0
    v_mov_b64 v[122:123], 0
    v_mov_b64 v[124:125], 0
    v_mov_b64 v[126:127], 0
    v_add_u32 v63, s57, v0
    v_mov_b32 v27, 0
    v_mov_b32 v31, 0
    v_mov_b32 v35, 0
    v_mov_b32 v39, 0
    s_waitcnt vmcnt(4)
    ds_read_b64 v[24:25], v63 offset:0
    ds_read_b64 v[28:29], v63 offset:8
    ds_read_b64 v[32:33], v63 offset:1024
    ds_read_b64 v[36:37], v63 offset:1032
    v_add_u32 v38, 152192, v0
    s_add_u32 s40, s40, 1
    s_xor_b32 s50, s42, 0x20000
    s_mov_b32 s42, s43
    s_mov_b32 s43, s50
    s_xor_b32 s44, s44, 0x40000
    s_add_u32 s47, s47, 0x20000
    s_mov_b32 s49, 0
    s_mov_b32 s59, s54
    s_sub_u32 s54, 270400, s54
    s_add_u32 s58, s41, 0x1000
    s_add_u32 s51, s40, 2
S_s1w1:
    buffer_load_dwordx4 v[48:51], v0, s[8:11], s56 offen sc1
    buffer_load_dwordx4 v[52:55], v0, s[8:11], s56 offen offset:1024 sc1
    s_add_u32 s49, s49, 1
    s_cmp_ge_u32 s49, 3000000
    s_cbranch_scc1 L_fail
    s_waitcnt vmcnt(2)
    v_max3_u32 v60, v48, v49, v50
    v_max3_u32 v60, v60, v51, v52
    v_mfma_f32_16x16x32_bf16 v[56:59], v[16:19], v[48:51], 0
    v_max3_u32 v60, v60, v53, v54
    v_max_u32 v60, v60, v55
    v_mfma_f32_16x16x32_bf16 v[56:59], v[16:19], v[52:55], v[56:59]
    v_cmp_eq_u32 vcc, s36, v60
    s_nop 6
    v_add_f32_dpp v56, v56, v56 row_ror:4 row_mask:0xf bank_mask:0xf
    v_add_f32_dpp v57, v57, v57 row_ror:4 row_mask:0xf bank_mask:0xf
    s_nop 0
    v_add_f32_dpp v56, v56, v56 row_ror:8 row_mask:0xf bank_mask:0xf
    v_add_f32_dpp v57, v57, v57 row_ror:8 row_mask:0xf bank_mask:0xf
    v_cvt_pk_bf16_f32 v64, v56, v57
    s_cbranch_vccnz S_s1w1
S_s1w1ok:
    buffer_store_dword v64, v7, s[8:11], s41 offen sc1
    s_xor_b32 s56, s56, 0x40000
    s_cmp_ge_u32 s51, s7
    s_cbranch_scc1 S_kvw1
S_kvo1:
    s_waitcnt lgkmcnt(0)
    s_barrier
    buffer_load_dwordx4 v[48:51], v0, s[8:11], s41 offen offset:2048 sc1
    buffer_load_dwordx4 v[52:55], v0, s[8:11], s41 offen offset:3072 sc1
    s_barrier
    ds_read_b128 v[40:43], v38
    ds_read_b128 v[44:47], v38 offset:1024
    s_branch S_p2go
    s_waitcnt lgkmcnt(0)
S_kvw1:
    v_bfe_u32 v68, v0, 4, 3
    v_min_u32 v68, 5, v68
    v_bfe_u32 v66, v0, 7, 1
    v_lshl_add_u32 v66, v66, 3, v68
    v_lshlrev_b32 v66, 2, v66
    s_mov_b32 s49, 0
S_kvl1:
    buffer_load_dword v67, v66, s[8:11], s6 offen sc1
    s_waitcnt vmcnt(0)
    v_mad_u32_u24 v67, v67, 6, v68
    s_nop 1
    v_min_u32_dpp v67, v67, v67 row_ror:8 row_mask:0xf bank_mask:0xf
    s_nop 1
    v_min_u32_dpp v67, v67, v67 row_ror:4 row_mask:0xf bank_mask:0xf
    s_nop 1
    v_min_u32_dpp v67, v67, v67 row_ror:2 row_mask:0xf bank_mask:0xf
    s_nop 1
    v_min_u32_dpp v67, v67, v67 row_ror:1 row_mask:0xf bank_mask:0xf
    s_nop 0
    v_readfirstlane_b32 s7, v67
    s_add_u32 s49, s49, 1
    s_cmp_ge_u32 s49, 3000000
    s_cbranch_scc1 L_fail
    s_cmp_ge_u32 s51, s7
    s_cbranch_scc1 S_kvl1
    s_mov_b32 s49, 0
    s_branch S_kvo1
    s_waitcnt lgkmcnt(0)
S_w2:
    ds_write_b32 v8, v122
    ds_write_b32 v8, v123 offset:288
    v_mov_b64 v[24:25], 0
    v_mov_b64 v[26:27], 0
    v_mov_b64 v[28:29], 0
    v_mov_b64 v[30:31], 0
    v_mov_b64 v[32:33], 0
    s_waitcnt lgkmcnt(0)
    s_barrier
    ds_read_b128 v[120:123], v10 offset:4608
    ds_read_b128 v[124:127], v10 offset:4736
    v_mov_b64 v[34:35], 0
    v_mov_b64 v[36:37], 0
    v_mov_b64 v[38:39], 0
    s_waitcnt lgkmcnt(1)
    v_smfmac_f32_16x16x64_bf16 v[24:27], v[120:123], v[48:55], v1
    ds_read_b128 v[48:51], v11 offset:32768
    ds_read_b128 v[52:55], v11 offset:36864
    s_waitcnt lgkmcnt(2)
    v_smfmac_f32_16x16x64_bf16 v[28:31], v[120:123], v[40:47], v1
    ds_read_b128 v[40:43], v11 offset:33792
    ds_read_b128 v[44:47], v11 offset:37888
    v_smfmac_f32_16x16x64_bf16 v[24:27], v[124:127], v[72:79], v1
    ds_read_b128 v[72:75], v11 offset:40960
    v_smfmac_f32_16x16x64_bf16 v[28:31], v[124:127], v[80:87], v1
    ds_read_b128 v[76:79], v11 offset:45056
    ds_read_b128 v[80:83], v11 offset:41984
    v_smfmac_f32_16x16x64_bf16 v[32:35], v[120:123], v[88:95], v1
    ds_read_b128 v[84:87], v11 offset:46080
    s_nop 1
    v_add_f32 v24, v24, v26
    v_add_f32 v25, v25, v27
    v_add_f32 v28, v28, v30
    v_add_f32 v29, v29, v31
    v_smfmac_f32_16x16x64_bf16 v[36:39], v[120:123], v[96:103], v1
    ds_read_b128 v[88:91], v11 offset:34816
    ds_read_b128 v[92:95], v11 offset:38912
    v_cvt_pk_bf16_f32 v26, v24, v28
    v_cvt_pk_bf16_f32 v27, v25, v29
    v_smfmac_f32_16x16x64_bf16 v[32:35], v[124:127], v[56:63], v1
    ds_read_b128 v[96:99], v11 offset:35840
    buffer_store_dwordx2 v[26:27], v6, s[8:11], s44 offen offset:0 sc1
    v_mov_b64 v[112:113], 0
    v_mov_b64 v[114:115], 0
    v_smfmac_f32_16x16x64_bf16 v[36:39], v[124:127], v[64:71], v1
    ds_read_b128 v[100:103], v11 offset:39936
    s_waitcnt lgkmcnt(8)
    v_mov_b64 v[116:117], 0
    v_mov_b64 v[118:119], 0
    v_smfmac_f32_16x16x64_bf16 v[104:107], v[120:123], v[48:55], v1
    ds_read_b128 v[56:59], v11 offset:43008
    ds_read_b128 v[60:63], v11 offset:47104
    v_add_f32 v32, v32, v34
    v_smfmac_f32_16x16x64_bf16 v[108:111], v[120:123], v[40:47], v1
    ds_read_b128 v[64:67], v11 offset:44032
    s_waitcnt lgkmcnt(7)
    v_add_f32 v33, v33, v35
    v_smfmac_f32_16x16x64_bf16 v[104:107], v[124:127], v[72:79], v1
    ds_read_b128 v[68:71], v11 offset:48128
    v_add_f32 v36, v36, v38
    v_add_f32 v37, v37, v39
    v_smfmac_f32_16x16x64_bf16 v[108:111], v[124:127], v[80:87], v1
    s_waitcnt lgkmcnt(4)
    v_cvt_pk_bf16_f32 v34, v32, v36
    v_cvt_pk_bf16_f32 v35, v33, v37
    v_smfmac_f32_16x16x64_bf16 v[112:115], v[120:123], v[88:95], v1
    buffer_store_dwordx2 v[34:35], v6, s[8:11], s44 offen offset:2048 sc1
    v_add_f32 v104, v104, v106
    v_smfmac_f32_16x16x64_bf16 v[116:119], v[120:123], v[96:103], v1
    s_waitcnt lgkmcnt(0)
    v_add_f32 v105, v105, v107
    v_smfmac_f32_16x16x64_bf16 v[112:115], v[124:127], v[56:63], v1
    v_add_f32 v108, v108, v110
    v_add_f32 v109, v109, v111
    v_smfmac_f32_16x16x64_bf16 v[116:119], v[124:127], v[64:71], v1
    v_cvt_pk_bf16_f32 v106, v104, v108
    v_cvt_pk_bf16_f32 v107, v105, v109
    buffer_store_dwordx2 v[106:107], v6, s[8:11], s37 offen offset:0 sc1
    s_nop 1
    v_pk_add_f32 v[112:113], v[112:113], v[114:115]
    s_nop 1
    v_pk_add_f32 v[116:117], v[116:117], v[118:119]
    v_cvt_pk_bf16_f32 v114, v112, v116
    v_cvt_pk_bf16_f32 v115, v113, v117
    buffer_store_dwordx2 v[114:115], v6, s[8:11], s37 offen offset:2048 sc1
    s_mov_b32 s41, s42
    v_and_b32 v61, 0x310, v0
    v_and_b32 v62, 0x60, v0
    v_lshl_add_u32 v61, v62, 1, v61
    v_bfe_u32 v62, v0, 7, 1
    v_mul_u32_u24 v62, 4128, v62
    v_add3_u32 v61, v61, v62, s54
    ds_read_b128 v[72:75], v61 offset:0
    v_mov_b64 v[104:105], 0
    ds_read_b128 v[76:79], v61 offset:1024
    v_mov_b64 v[106:107], 0
    ds_read_b128 v[80:83], v61 offset:2048
    v_mov_b64 v[108:109], 0
    ds_read_b128 v[84:87], v61 offset:3072
    v_mov_b64 v[110:111], 0
    ds_read_b128 v[88:91], v61 offset:32
    v_mov_b64 v[112:113], 0
    ds_read_b128 v[92:95], v61 offset:1056
    v_mov_b64 v[114:115], 0
    ds_read_b128 v[96:99], v61 offset:2080
    v_mov_b64 v[116:117], 0
    ds_read_b128 v[100:103], v61 offset:3104
    v_mov_b64 v[118:119], 0
    v_mov_b64 v[120:121], 0
    v_mov_b64 v[122:123], 0
    v_mov_b64 v[124:125], 0
    v_mov_b64 v[126:127], 0
    s_waitcnt vmcnt(2)
    buffer_load_dwordx4 v[48:51], v0, s[8:11], s56 offen sc1
    buffer_load_dwordx4 v[52:55], v0, s[8:11], s56 offen offset:1024 sc1
    v_add_u32 v63, s57, v0
    v_mov_b32 v27, 0
    v_mov_b32 v31, 0
    v_mov_b32 v35, 0
    v_mov_b32 v39, 0
    s_waitcnt vmcnt(4)
    ds_read_b64 v[24:25], v63 offset:0
    ds_read_b64 v[28:29], v63 offset:8
    ds_read_b64 v[32:33], v63 offset:1024
    ds_read_b64 v[36:37], v63 offset:1032
    v_add_u32 v38, 152192, v0
    s_add_u32 s40, s40, 1
    s_xor_b32 s50, s42, 0x20000
    s_mov_b32 s42, s43
    s_mov_b32 s43, s50
    s_xor_b32 s44, s44, 0x40000
    s_add_u32 s47, s47, 0x20000
    s_mov_b32 s49, 0
    s_mov_b32 s59, s54
    s_sub_u32 s54, 270400, s54
    s_add_u32 s58, s41, 0x1000
    s_add_u32 s51, s40, 2
S_s1w2:
    buffer_load_dwordx4 v[48:51], v0, s[8:11], s56 offen sc1
    buffer_load_dwordx4 v[52:55], v0, s[8:11], s56 offen offset:1024 sc1
    s_add_u32 s49, s49, 1
    s_cmp_ge_u32 s49, 3000000
    s_cbranch_scc1 L_fail
    s_waitcnt vmcnt(2)
    v_max3_u32 v60, v48, v49, v50
    v_max3_u32 v60, v60, v51, v52
    v_mfma_f32_16x16x32_bf16 v[56:59], v[16:19], v[48:51], 0
    v_max3_u32 v60, v60, v53, v54
    v_max_u32 v60, v60, v55
    v_mfma_f32_16x16x32_bf16 v[56:59], v[16:19], v[52:55], v[56:59]
    v_cmp_eq_u32 vcc, s36, v60
    s_nop 6
    v_add_f32_dpp v56, v56, v56 row_ror:4 row_mask:0xf bank_mask:0xf
    v_add_f32_dpp v57, v57, v57 row_ror:4 row_mask:0xf bank_mask:0xf
    s_nop 0
    v_add_f32_dpp v56, v56, v56 row_ror:8 row_mask:0xf bank_mask:0xf
    v_add_f32_dpp v57, v57, v57 row_ror:8 row_mask:0xf bank_mask:0xf
    v_cvt_pk_bf16_f32 v64, v56, v57
    s_cbranch_vccnz S_s1w2
S_s1w2ok:
    buffer_store_dword v64, v7, s[8:11], s41 offen sc1
    s_xor_b32 s56, s56, 0x40000
    s_waitcnt lgkmcnt(0)
    s_barrier
    buffer_load_dwordx4 v[48:51], v0, s[8:11], s41 offen offset:2048 sc1
    buffer_load_dwordx4 v[52:55], v0, s[8:11], s41 offen offset:3072 sc1
    s_barrier
    ds_read_b128 v[40:43], v38
    ds_read_b128 v[44:47], v38 offset:1024
    s_branch S_p2go
    s_waitcnt lgkmcnt(0)
    s_waitcnt lgkmcnt(0)
S_redo:
    s_add_u32 s49, s49, 1
    s_cmp_ge_u32 s49, 3000000
    s_cbranch_scc1 L_fail
    s_nop 7
    v_mov_b64 v[104:105], 0
    v_mov_b64 v[106:107], 0
    v_mov_b64 v[108:109], 0
    v_mov_b64 v[110:111], 0
    v_mov_b64 v[112:113], 0
    v_mov_b64 v[114:115], 0
    v_mov_b64 v[116:117], 0
    v_mov_b64 v[118:119], 0
    v_mov_b64 v[120:121], 0
    v_mov_b64 v[122:123], 0
    v_mov_b64 v[124:125], 0
    v_mov_b64 v[126:127], 0
    s_branch S_p2ok
S_fin:
    s_waitcnt lgkmcnt(0)
    s_add_u32 s47, s47, 0x20000
    buffer_store_dwordx4 v[12:15], v0, s[8:11], s47 offen sc1
    s_waitcnt vmcnt(0)
    s_endpgm
L_over:
    s_barrier
    s_cmp_lg_u32 s4, 0
    s_cbranch_scc1 L_ov1
    v_mov_b32 v2, 68
    v_mov_b32 v3, 1
    s_mov_b64 exec, 1
    buffer_atomic_add v3, v2, s[12:15], 0 offen sc0
    s_waitcnt vmcnt(0)
    ds_write_b32 v4, v3
    s_waitcnt lgkmcnt(0)
    s_mov_b64 exec, -1
L_ov1:
    s_barrier
    ds_read_b32 v3, v4
    s_waitcnt lgkmcnt(0)
    v_readfirstlane_b32 s7, v3
    v_and_b32 v8, 7, v0
    v_lshlrev_b32 v9, 2, v8
    v_add_u32 v9, 128, v9
    v_cmp_eq_u32 vcc, 0, v8
    s_nop 1
    v_cndmask_b32 v8, v9, v8, vcc
    s_mov_b32 s60, 0
L_ov2:
    buffer_load_dword v9, v8, s[12:15], 0 offen sc1
    s_waitcnt vmcnt(0)
    v_add_u32_dpp v9, v9, v9 row_ror:1 row_mask:0xf bank_mask:0xf
    s_nop 1
    v_add_u32_dpp v9, v9, v9 row_ror:2 row_mask:0xf bank_mask:0xf
    s_nop 1
    v_add_u32_dpp v9, v9, v9 row_ror:4 row_mask:0xf bank_mask:0xf
    s_nop 0
    v_readfirstlane_b32 s63, v9
    s_add_u32 s60, s60, 1
    s_cmp_ge_u32 s60, 3000000
    s_cbranch_scc1 L_fail
    s_cmp_lt_u32 s63, 256
    s_cbranch_scc1 L_ov2
    s_mov_b32 s3, 0
L_ov3:
    s_lshl_b32 s6, s3, 2
    s_add_u32 s6, s6, 128
    s_cmp_eq_u32 s3, 0
    s_cselect_b32 s6, 0, s6
    v_mov_b32 v8, s6
    buffer_load_dword v9, v8, s[12:15], 0 offen sc1
    s_waitcnt vmcnt(0)
    v_readfirstlane_b32 s5, v9
    s_nop 0
    s_min_u32 s5, s5, 32
    s_add_u32 s5, s5, s7
    s_cmp_lt_u32 s5, 32
    s_cbranch_scc1 L_role
    s_sub_u32 s7, s5, 32
    s_add_u32 s3, s3, 1
    s_cmp_lt_u32 s3, 8
    s_cbranch_scc1 L_ov3
    s_branch L_fail
L_worker:
    s_sub_u32 s6, s3, 2
    s_min_u32 s6, s6, 6
    s_lshl_b32 s6, s6, 5
    s_add_u32 s6, s6, s5
    s_cmp_lg_u32 s3, 1
    s_cbranch_scc1 L_wk
    v_and_b32 v3, 63, v0
    v_and_b32 v1, 15, v3
    v_lshrrev_b32 v2, 4, v3
    v_lshlrev_b32 v0, 4, v3
    v_mul_u32_u24 v3, 1056, v1
    v_lshl_add_u32 v3, v2, 4, v3
    s_mov_b32 s37, 0x05040100
    s_mov_b32 s38, 0x07060302
    s_mul_i32 s49, s4, 8448
    s_mov_b32 s47, 0
    v_mov_b32 v12, 0xffbfffbf
    v_mov_b32 v13, 0xffbfffbf
    v_mov_b32 v14, 0xffbfffbf
    v_mov_b32 v15, 0xffbfffbf
    s_load_dwordx2 s[24:25], s[0:1], 0
    s_mov_b32 s26, 0x200000
    s_mov_b32 s27, 0x20000
    s_mov_b32 s63, 128
    s_cmp_eq_u32 s99, 0
    s_cselect_b32 s63, s63, 0x7fffff00
    s_mov_b32 s99, 1
    v_mov_b32 v9, 1
    s_mov_b64 exec, 1
    buffer_atomic_add v9, off, s[12:15], s63
    s_mov_b64 exec, -1
    s_load_dwordx2 s[16:17], s[0:1], 88
    s_mov_b32 s18, 0x400
    s_mov_b32 s19, 0x20000
    s_lshl_b32 s44, s5, 2
    s_add_u32 s44, s44, s4
    s_lshl_b32 s45, s44, 14
    s_lshl_b32 s43, s44, 6
    s_add_u32 s43, s43, 0x10000
    s_waitcnt lgkmcnt(0)
    buffer_load_dwordx4 v[12:15], v0, s[16:19], 0 offen
    v_mov_b32 v11, v1
    v_mov_b32 v10, 0
    s_mov_b32 s48, 0
    buffer_load_dwordx4 v[16:19], v0, s[24:27], s45 offen
    s_add_u32 s45, s45, 1024
    buffer_load_dwordx4 v[20:23], v0, s[24:27], s45 offen
    s_add_u32 s45, s45, 1024
    buffer_load_dwordx4 v[24:27], v0, s[24:27], s45 offen
    s_add_u32 s45, s45, 1024
    buffer_load_dwordx4 v[28:31], v0, s[24:27], s45 offen
    s_add_u32 s45, s45, 1024
    buffer_load_dwordx4 v[32:35], v0, s[24:27], s45 offen
    s_add_u32 s45, s45, 1024
    buffer_load_dwordx4 v[36:39], v0, s[24:27], s45 offen
    s_add_u32 s45, s45, 1024
    buffer_load_dwordx4 v[40:43], v0, s[24:27], s45 offen
    s_add_u32 s45, s45, 1024
    buffer_load_dwordx4 v[44:47], v0, s[24:27], s45 offen
    s_add_u32 s45, s45, 1024
    buffer_load_dwordx4 v[48:51], v0, s[24:27], s45 offen
    s_add_u32 s45, s45, 1024
    buffer_load_dwordx4 v[52:55], v0, s[24:27], s45 offen
    s_add_u32 s45, s45, 1024
    buffer_load_dwordx4 v[56:59], v0, s[24:27], s45 offen
    s_add_u32 s45, s45, 1024
    buffer_load_dwordx4 v[60:63], v0, s[24:27], s45 offen
    s_add_u32 s45, s45, 1024
    buffer_load_dwordx4 v[64:67], v0, s[24:27], s45 offen
    s_add_u32 s45, s45, 1024
    buffer_load_dwordx4 v[68:71], v0, s[24:27], s45 offen
    s_add_u32 s45, s45, 1024
    buffer_load_dwordx4 v[72:75], v0, s[24:27], s45 offen
    s_add_u32 s45, s45, 1024
    buffer_load_dwordx4 v[76:79], v0, s[24:27], s45 offen
    s_add_u32 s45, s45, 1024
    s_waitcnt vmcnt(0)
    v_dot2_f32_bf16 v80, v16, v12, 0
    v_dot2_f32_bf16 v81, v20, v12, 0
    v_dot2_f32_bf16 v82, v24, v12, 0
    v_dot2_f32_bf16 v83, v28, v12, 0
    v_dot2_f32_bf16 v84, v32, v12, 0
    v_dot2_f32_bf16 v85, v36, v12, 0
    v_dot2_f32_bf16 v86, v40, v12, 0
    v_dot2_f32_bf16 v87, v44, v12, 0
    v_dot2_f32_bf16 v88, v48, v12, 0
    v_dot2_f32_bf16 v89, v52, v12, 0
    v_dot2_f32_bf16 v90, v56, v12, 0
    v_dot2_f32_bf16 v91, v60, v12, 0
    v_dot2_f32_bf16 v92, v64, v12, 0
    v_dot2_f32_bf16 v93, v68, v12, 0
    v_dot2_f32_bf16 v94, v72, v12, 0
    v_dot2_f32_bf16 v95, v76, v12, 0
    v_dot2_f32_bf16 v80, v17, v13, v80
    v_dot2_f32_bf16 v81, v21, v13, v81
    v_dot2_f32_bf16 v82, v25, v13, v82
    v_dot2_f32_bf16 v83, v29, v13, v83
    v_dot2_f32_bf16 v84, v33, v13, v84
    v_dot2_f32_bf16 v85, v37, v13, v85
    v_dot2_f32_bf16 v86, v41, v13, v86
    v_dot2_f32_bf16 v87, v45, v13, v87
    v_dot2_f32_bf16 v88, v49, v13, v88
    v_dot2_f32_bf16 v89, v53, v13, v89
    v_dot2_f32_bf16 v90, v57, v13, v90
    v_dot2_f32_bf16 v91, v61, v13, v91
    v_dot2_f32_bf16 v92, v65, v13, v92
    v_dot2_f32_bf16 v93, v69, v13, v93
    v_dot2_f32_bf16 v94, v73, v13, v94
    v_dot2_f32_bf16 v95, v77, v13, v95
    v_dot2_f32_bf16 v80, v18, v14, v80
    v_dot2_f32_bf16 v81, v22, v14, v81
    v_dot2_f32_bf16 v82, v26, v14, v82
    v_dot2_f32_bf16 v83, v30, v14, v83
    v_dot2_f32_bf16 v84, v34, v14, v84
    v_dot2_f32_bf16 v85, v38, v14, v85
    v_dot2_f32_bf16 v86, v42, v14, v86
    v_dot2_f32_bf16 v87, v46, v14, v87
    v_dot2_f32_bf16 v88, v50, v14, v88
    v_dot2_f32_bf16 v89, v54, v14, v89
    v_dot2_f32_bf16 v90, v58, v14, v90
    v_dot2_f32_bf16 v91, v62, v14, v91
    v_dot2_f32_bf16 v92, v66, v14, v92
    v_dot2_f32_bf16 v93, v70, v14, v93
    v_dot2_f32_bf16 v94, v74, v14, v94
    v_dot2_f32_bf16 v95, v78, v14, v95
    v_dot2_f32_bf16 v80, v19, v15, v80
    v_dot2_f32_bf16 v81, v23, v15, v81
    v_dot2_f32_bf16 v82, v27, v15, v82
    v_dot2_f32_bf16 v83, v31, v15, v83
    v_dot2_f32_bf16 v84, v35, v15, v84
    v_dot2_f32_bf16 v85, v39, v15, v85
    v_dot2_f32_bf16 v86, v43, v15, v86
    v_dot2_f32_bf16 v87, v47, v15, v87
    v_dot2_f32_bf16 v88, v51, v15, v88
    v_dot2_f32_bf16 v89, v55, v15, v89
    v_dot2_f32_bf16 v90, v59, v15, v90
    v_dot2_f32_bf16 v91, v63, v15, v91
    v_dot2_f32_bf16 v92, v67, v15, v92
    v_dot2_f32_bf16 v93, v71, v15, v93
    v_dot2_f32_bf16 v94, v75, v15, v94
    v_dot2_f32_bf16 v95, v79, v15, v95
    s_nop 3
    v_add_f32_dpp v80, v80, v80 row_ror:8 row_mask:0xf bank_mask:0xf
    v_add_f32_dpp v81, v81, v81 row_ror:8 row_mask:0xf bank_mask:0xf
    v_add_f32_dpp v82, v82, v82 row_ror:8 row_mask:0xf bank_mask:0xf
    v_add_f32_dpp v83, v83, v83 row_ror:8 row_mask:0xf bank_mask:0xf
    v_add_f32_dpp v84, v84, v84 row_ror:8 row_mask:0xf bank_mask:0xf
    v_add_f32_dpp v85, v85, v85 row_ror:8 row_mask:0xf bank_mask:0xf
    v_add_f32_dpp v86, v86, v86 row_ror:8 row_mask:0xf bank_mask:0xf
    v_add_f32_dpp v87, v87, v87 row_ror:8 row_mask:0xf bank_mask:0xf
    v_add_f32_dpp v88, v88, v88 row_ror:8 row_mask:0xf bank_mask:0xf
    v_add_f32_dpp v89, v89, v89 row_ror:8 row_mask:0xf bank_mask:0xf
    v_add_f32_dpp v90, v90, v90 row_ror:8 row_mask:0xf bank_mask:0xf
    v_add_f32_dpp v91, v91, v91 row_ror:8 row_mask:0xf bank_mask:0xf
    v_add_f32_dpp v92, v92, v92 row_ror:8 row_mask:0xf bank_mask:0xf
    v_add_f32_dpp v93, v93, v93 row_ror:8 row_mask:0xf bank_mask:0xf
    v_add_f32_dpp v94, v94, v94 row_ror:8 row_mask:0xf bank_mask:0xf
    v_add_f32_dpp v95, v95, v95 row_ror:8 row_mask:0xf bank_mask:0xf
    v_add_f32_dpp v80, v80, v80 row_ror:4 row_mask:0xf bank_mask:0xf
    v_add_f32_dpp v81, v81, v81 row_ror:4 row_mask:0xf bank_mask:0xf
    v_add_f32_dpp v82, v82, v82 row_ror:4 row_mask:0xf bank_mask:0xf
    v_add_f32_dpp v83, v83, v83 row_ror:4 row_mask:0xf bank_mask:0xf
    v_add_f32_dpp v84, v84, v84 row_ror:4 row_mask:0xf bank_mask:0xf
    v_add_f32_dpp v85, v85, v85 row_ror:4 row_mask:0xf bank_mask:0xf
    v_add_f32_dpp v86, v86, v86 row_ror:4 row_mask:0xf bank_mask:0xf
    v_add_f32_dpp v87, v87, v87 row_ror:4 row_mask:0xf bank_mask:0xf
    v_add_f32_dpp v88, v88, v88 row_ror:4 row_mask:0xf bank_mask:0xf
    v_add_f32_dpp v89, v89, v89 row_ror:4 row_mask:0xf bank_mask:0xf
    v_add_f32_dpp v90, v90, v90 row_ror:4 row_mask:0xf bank_mask:0xf
    v_add_f32_dpp v91, v91, v91 row_ror:4 row_mask:0xf bank_mask:0xf
    v_add_f32_dpp v92, v92, v92 row_ror:4 row_mask:0xf bank_mask:0xf
    v_add_f32_dpp v93, v93, v93 row_ror:4 row_mask:0xf bank_mask:0xf
    v_add_f32_dpp v94, v94, v94 row_ror:4 row_mask:0xf bank_mask:0xf
    v_add_f32_dpp v95, v95, v95 row_ror:4 row_mask:0xf bank_mask:0xf
    v_add_f32_dpp v80, v80, v80 row_ror:2 row_mask:0xf bank_mask:0xf
    v_add_f32_dpp v81, v81, v81 row_ror:2 row_mask:0xf bank_mask:0xf
    v_add_f32_dpp v82, v82, v82 row_ror:2 row_mask:0xf bank_mask:0xf
    v_add_f32_dpp v83, v83, v83 row_ror:2 row_mask:0xf bank_mask:0xf
    v_add_f32_dpp v84, v84, v84 row_ror:2 row_mask:0xf bank_mask:0xf
    v_add_f32_dpp v85, v85, v85 row_ror:2 row_mask:0xf bank_mask:0xf
    v_add_f32_dpp v86, v86, v86 row_ror:2 row_mask:0xf bank_mask:0xf
    v_add_f32_dpp v87, v87, v87 row_ror:2 row_mask:0xf bank_mask:0xf
    v_add_f32_dpp v88, v88, v88 row_ror:2 row_mask:0xf bank_mask:0xf
    v_add_f32_dpp v89, v89, v89 row_ror:2 row_mask:0xf bank_mask:0xf
    v_add_f32_dpp v90, v90, v90 row_ror:2 row_mask:0xf bank_mask:0xf
    v_add_f32_dpp v91, v91, v91 row_ror:2 row_mask:0xf bank_mask:0xf
    v_add_f32_dpp v92, v92, v92 row_ror:2 row_mask:0xf bank_mask:0xf
    v_add_f32_dpp v93, v93, v93 row_ror:2 row_mask:0xf bank_mask:0xf
    v_add_f32_dpp v94, v94, v94 row_ror:2 row_mask:0xf bank_mask:0xf
    v_add_f32_dpp v95, v95, v95 row_ror:2 row_mask:0xf bank_mask:0xf
    v_add_f32_dpp v80, v80, v80 row_ror:1 row_mask:0xf bank_mask:0xf
    v_add_f32_dpp v81, v81, v81 row_ror:1 row_mask:0xf bank_mask:0xf
    v_add_f32_dpp v82, v82, v82 row_ror:1 row_mask:0xf bank_mask:0xf
    v_add_f32_dpp v83, v83, v83 row_ror:1 row_mask:0xf bank_mask:0xf
    v_add_f32_dpp v84, v84, v84 row_ror:1 row_mask:0xf bank_mask:0xf
    v_add_f32_dpp v85, v85, v85 row_ror:1 row_mask:0xf bank_mask:0xf
    v_add_f32_dpp v86, v86, v86 row_ror:1 row_mask:0xf bank_mask:0xf
    v_add_f32_dpp v87, v87, v87 row_ror:1 row_mask:0xf bank_mask:0xf
    v_add_f32_dpp v88, v88, v88 row_ror:1 row_mask:0xf bank_mask:0xf
    v_add_f32_dpp v89, v89, v89 row_ror:1 row_mask:0xf bank_mask:0xf
    v_add_f32_dpp v90, v90, v90 row_ror:1 row_mask:0xf bank_mask:0xf
    v_add_f32_dpp v91, v91, v91 row_ror:1 row_mask:0xf bank_mask:0xf
    v_add_f32_dpp v92, v92, v92 row_ror:1 row_mask:0xf bank_mask:0xf
    v_add_f32_dpp v93, v93, v93 row_ror:1 row_mask:0xf bank_mask:0xf
    v_add_f32_dpp v94, v94, v94 row_ror:1 row_mask:0xf bank_mask:0xf
    v_add_f32_dpp v95, v95, v95 row_ror:1 row_mask:0xf bank_mask:0xf
    v_mov_b32 v16, v80
    v_mov_b32 v17, v81
    v_mov_b32 v18, v82
    v_mov_b32 v19, v83
    v_mov_b32 v20, v84
    v_mov_b32 v21, v85
    v_mov_b32 v22, v86
    v_mov_b32 v23, v87
    v_mov_b32 v24, v88
    v_mov_b32 v25, v89
    v_mov_b32 v26, v90
    v_mov_b32 v27, v91
    v_mov_b32 v28, v92
    v_mov_b32 v29, v93
    v_mov_b32 v30, v94
    v_mov_b32 v31, v95
    v_permlane16_swap_b32 v80, v16
    v_permlane16_swap_b32 v81, v17
    v_permlane16_swap_b32 v82, v18
    v_permlane16_swap_b32 v83, v19
    v_permlane16_swap_b32 v84, v20
    v_permlane16_swap_b32 v85, v21
    v_permlane16_swap_b32 v86, v22
    v_permlane16_swap_b32 v87, v23
    v_permlane16_swap_b32 v88, v24
    v_permlane16_swap_b32 v89, v25
    v_permlane16_swap_b32 v90, v26
    v_permlane16_swap_b32 v91, v27
    v_permlane16_swap_b32 v92, v28
    v_permlane16_swap_b32 v93, v29
    v_permlane16_swap_b32 v94, v30
    v_permlane16_swap_b32 v95, v31
    v_add_f32 v80, v80, v16
    v_add_f32 v81, v81, v17
    v_add_f32 v82, v82, v18
    v_add_f32 v83, v83, v19
    v_add_f32 v84, v84, v20
    v_add_f32 v85, v85, v21
    v_add_f32 v86, v86, v22
    v_add_f32 v87, v87, v23
    v_add_f32 v88, v88, v24
    v_add_f32 v89, v89, v25
    v_add_f32 v90, v90, v26
    v_add_f32 v91, v91, v27
    v_add_f32 v92, v92, v28
    v_add_f32 v93, v93, v29
    v_add_f32 v94, v94, v30
    v_add_f32 v95, v95, v31
    v_mov_b32 v16, v80
    v_mov_b32 v17, v81
    v_mov_b32 v18, v82
    v_mov_b32 v19, v83
    v_mov_b32 v20, v84
    v_mov_b32 v21, v85
    v_mov_b32 v22, v86
    v_mov_b32 v23, v87
    v_mov_b32 v24, v88
    v_mov_b32 v25, v89
    v_mov_b32 v26, v90
    v_mov_b32 v27, v91
    v_mov_b32 v28, v92
    v_mov_b32 v29, v93
    v_mov_b32 v30, v94
    v_mov_b32 v31, v95
    v_permlane32_swap_b32 v80, v16
    v_permlane32_swap_b32 v81, v17
    v_permlane32_swap_b32 v82, v18
    v_permlane32_swap_b32 v83, v19
    v_permlane32_swap_b32 v84, v20
    v_permlane32_swap_b32 v85, v21
    v_permlane32_swap_b32 v86, v22
    v_permlane32_swap_b32 v87, v23
    v_permlane32_swap_b32 v88, v24
    v_permlane32_swap_b32 v89, v25
    v_permlane32_swap_b32 v90, v26
    v_permlane32_swap_b32 v91, v27
    v_permlane32_swap_b32 v92, v28
    v_permlane32_swap_b32 v93, v29
    v_permlane32_swap_b32 v94, v30
    v_permlane32_swap_b32 v95, v31
    v_add_f32 v80, v80, v16
    v_add_f32 v81, v81, v17
    v_add_f32 v82, v82, v18
    v_add_f32 v83, v83, v19
    v_add_f32 v84, v84, v20
    v_add_f32 v85, v85, v21
    v_add_f32 v86, v86, v22
    v_add_f32 v87, v87, v23
    v_add_f32 v88, v88, v24
    v_add_f32 v89, v89, v25
    v_add_f32 v90, v90, v26
    v_add_f32 v91, v91, v27
    v_add_f32 v92, v92, v28
    v_add_f32 v93, v93, v29
    v_add_f32 v94, v94, v30
    v_add_f32 v95, v95, v31
    s_add_u32 s46, s48, 0
    v_cmp_eq_u32 vcc, s46, v11
    s_nop 1
    v_cndmask_b32 v10, v10, v80, vcc
    s_add_u32 s46, s48, 1
    v_cmp_eq_u32 vcc, s46, v11
    s_nop 1
    v_cndmask_b32 v10, v10, v81, vcc
    s_add_u32 s46, s48, 2
    v_cmp_eq_u32 vcc, s46, v11
    s_nop 1
    v_cndmask_b32 v10, v10, v82, vcc
    s_add_u32 s46, s48, 3
    v_cmp_eq_u32 vcc, s46, v11
    s_nop 1
    v_cndmask_b32 v10, v10, v83, vcc
    s_add_u32 s46, s48, 4
    v_cmp_eq_u32 vcc, s46, v11
    s_nop 1
    v_cndmask_b32 v10, v10, v84, vcc
    s_add_u32 s46, s48, 5
    v_cmp_eq_u32 vcc, s46, v11
    s_nop 1
    v_cndmask_b32 v10, v10, v85, vcc
    s_add_u32 s46, s48, 6
    v_cmp_eq_u32 vcc, s46, v11
    s_nop 1
    v_cndmask_b32 v10, v10, v86, vcc
    s_add_u32 s46, s48, 7
    v_cmp_eq_u32 vcc, s46, v11
    s_nop 1
    v_cndmask_b32 v10, v10, v87, vcc
    s_add_u32 s46, s48, 8
    v_cmp_eq_u32 vcc, s46, v11
    s_nop 1
    v_cndmask_b32 v10, v10, v88, vcc
    s_add_u32 s46, s48, 9
    v_cmp_eq_u32 vcc, s46, v11
    s_nop 1
    v_cndmask_b32 v10, v10, v89, vcc
    s_add_u32 s46, s48, 10
    v_cmp_eq_u32 vcc, s46, v11
    s_nop 1
    v_cndmask_b32 v10, v10, v90, vcc
    s_add_u32 s46, s48, 11
    v_cmp_eq_u32 vcc, s46, v11
    s_nop 1
    v_cndmask_b32 v10, v10, v91, vcc
    s_add_u32 s46, s48, 12
    v_cmp_eq_u32 vcc, s46, v11
    s_nop 1
    v_cndmask_b32 v10, v10, v92, vcc
    s_add_u32 s46, s48, 13
    v_cmp_eq_u32 vcc, s46, v11
    s_nop 1
    v_cndmask_b32 v10, v10, v93, vcc
    s_add_u32 s46, s48, 14
    v_cmp_eq_u32 vcc, s46, v11
    s_nop 1
    v_cndmask_b32 v10, v10, v94, vcc
    s_add_u32 s46, s48, 15
    v_cmp_eq_u32 vcc, s46, v11
    s_nop 1
    v_cndmask_b32 v10, v10, v95, vcc
    v_cvt_pk_bf16_f32 v10, v10, v10
    v_and_b32 v10, 0xffff0000, v10
    v_mul_f32 v10, 0xbfb8aa3b, v10
    v_exp_f32 v10, v10
    s_nop 0
    v_add_f32 v10, 1.0, v10
    v_rcp_f32 v10, v10
    s_nop 0
    v_cvt_pk_bf16_f32 v10, v10, v10
    v_and_b32 v10, 0xffff0000, v10
    v_lshlrev_b32 v11, 2, v11
    buffer_store_dword v10, v11, s[8:11], s43 offen sc1
    s_cmp_lg_u32 s4, 0
    s_cbranch_scc1 H_rdy_e
    v_mov_b32 v8, 128
    s_mov_b32 s60, 0
H_rdy:
    s_sleep 40
    buffer_load_dword v9, v8, s[12:15], 0 offen sc1
    s_waitcnt vmcnt(0)
    v_readfirstlane_b32 s63, v9
    s_add_u32 s60, s60, 1
    s_cmp_ge_u32 s60, 3000000
    s_cbranch_scc1 L_fail
    s_cmp_lt_u32 s63, 256
    s_cbranch_scc1 H_rdy
H_rdy_e:
    s_waitcnt vmcnt(0)
    s_barrier
    s_cmp_lg_u32 s4, 0
    s_cbranch_scc1 H_f2
    s_lshl_b32 s44, s6, 2
    v_mov_b32 v8, 1
    buffer_store_dword v8, off, s[8:11], s44 offset:1024 sc1
H_f2:
    s_waitcnt vmcnt(0)
    s_endpgm
L_wk:
    v_and_b32 v3, 63, v0
    v_and_b32 v1, 15, v3
    v_lshrrev_b32 v2, 4, v3
    v_lshlrev_b32 v0, 4, v3
    v_mul_u32_u24 v3, 1056, v1
    v_lshl_add_u32 v3, v2, 4, v3
    s_mov_b32 s37, 0x05040100
    s_mov_b32 s38, 0x07060302
    s_mul_i32 s49, s4, 8448
    s_mov_b32 s47, 0
    v_mov_b32 v12, 0xffbfffbf
    v_mov_b32 v13, 0xffbfffbf
    v_mov_b32 v14, 0xffbfffbf
    v_mov_b32 v15, 0xffbfffbf
    s_load_dwordx2 s[28:29], s[0:1], 40
    s_mov_b32 s30, 0x400000
    s_mov_b32 s31, 0x20000
    s_mov_b32 s97, 0
    s_mul_hi_u32 s96, s6, 0x2aaaaaab
    s_mul_i32 s44, s96, 6
    s_sub_u32 s44, s6, s44
    s_lshl_b32 s96, s96, 2
    s_add_u32 s96, s96, s44
    s_sub_u32 s96, s96, 2
    s_cmp_lt_u32 s44, 2
    s_waitcnt lgkmcnt(0)
    s_cbranch_scc1 W_nwo
    s_mov_b32 s97, 1
    v_lshrrev_b32 v10, 1, v2
    v_lshlrev_b32 v9, 14, v10
    v_and_b32 v10, 1, v2
    v_lshl_add_u32 v9, v10, 12, v9
    v_and_b32 v10, 8, v1
    v_lshl_add_u32 v9, v10, 2, v9
    v_and_b32 v10, 1, v1
    v_lshl_add_u32 v9, v10, 4, v9
    v_and_b32 v10, 6, v1
    v_lshl_add_u32 v9, v10, 1, v9
    s_lshr_b32 s44, s96, 2
    s_lshl_b32 s44, s44, 17
    s_and_b32 s45, s96, 3
    s_lshl_b32 s45, s45, 6
    s_add_u32 s44, s44, s45
    s_lshl_b32 s45, s4, 8
    s_add_u32 s44, s44, s45
    s_add_u32 s45, s44, 0x0
    buffer_load_dword v140, v9, s[28:31], s45 offen offset:0
    buffer_load_dword v141, v9, s[28:31], s45 offen offset:1024
    s_add_u32 s45, s44, 0x2000
    buffer_load_dword v142, v9, s[28:31], s45 offen offset:0
    buffer_load_dword v143, v9, s[28:31], s45 offen offset:1024
    s_add_u32 s45, s44, 0x800
    buffer_load_dword v144, v9, s[28:31], s45 offen offset:0
    buffer_load_dword v145, v9, s[28:31], s45 offen offset:1024
    s_add_u32 s45, s44, 0x2800
    buffer_load_dword v146, v9, s[28:31], s45 offen offset:0
    buffer_load_dword v147, v9, s[28:31], s45 offen offset:1024
    s_add_u32 s45, s44, 0x8000
    buffer_load_dword v148, v9, s[28:31], s45 offen offset:0
    buffer_load_dword v149, v9, s[28:31], s45 offen offset:1024
    s_add_u32 s45, s44, 0xa000
    buffer_load_dword v150, v9, s[28:31], s45 offen offset:0
    buffer_load_dword v151, v9, s[28:31], s45 offen offset:1024
    s_add_u32 s45, s44, 0x8800
    buffer_load_dword v152, v9, s[28:31], s45 offen offset:0
    buffer_load_dword v153, v9, s[28:31], s45 offen offset:1024
    s_add_u32 s45, s44, 0xa800
    buffer_load_dword v154, v9, s[28:31], s45 offen offset:0
    buffer_load_dword v155, v9, s[28:31], s45 offen offset:1024
    s_add_u32 s45, s44, 0x10000
    buffer_load_dword v156, v9, s[28:31], s45 offen offset:0
    buffer_load_dword v157, v9, s[28:31], s45 offen offset:1024
    s_add_u32 s45, s44, 0x12000
    buffer_load_dword v158, v9, s[28:31], s45 offen offset:0
    buffer_load_dword v159, v9, s[28:31], s45 offen offset:1024
    s_add_u32 s45, s44, 0x10800
    buffer_load_dword v160, v9, s[28:31], s45 offen offset:0
    buffer_load_dword v161, v9, s[28:31], s45 offen offset:1024
    s_add_u32 s45, s44, 0x12800
    buffer_load_dword v162, v9, s[28:31], s45 offen offset:0
    buffer_load_dword v163, v9, s[28:31], s45 offen offset:1024
    s_add_u32 s45, s44, 0x18000
    buffer_load_dword v164, v9, s[28:31], s45 offen offset:0
    buffer_load_dword v165, v9, s[28:31], s45 offen offset:1024
    s_add_u32 s45, s44, 0x1a000
    buffer_load_dword v166, v9, s[28:31], s45 offen offset:0
    buffer_load_dword v167, v9, s[28:31], s45 offen offset:1024
    s_add_u32 s45, s44, 0x18800
    buffer_load_dword v168, v9, s[28:31], s45 offen offset:0
    buffer_load_dword v169, v9, s[28:31], s45 offen offset:1024
    s_add_u32 s45, s44, 0x1a800
    buffer_load_dword v170, v9, s[28:31], s45 offen offset:0
    buffer_load_dword v171, v9, s[28:31], s45 offen offset:1024
W_nwo:
    s_load_dwordx2 s[24:25], s[0:1], 0
    s_mov_b32 s26, 0x200000
    s_mov_b32 s27, 0x20000
    s_mul_hi_u32 s52, s6, 0x2aaaaaab
    s_mul_i32 s44, s52, 6
    s_sub_u32 s40, s6, s44
    s_mov_b32 s41, 6
    s_and_b32 s53, s52, 15
    s_mov_b32 s95, -1
    s_mov_b32 s54, 1
    s_lshl_b32 s56, s53, 4
    s_lshr_b32 s44, s52, 4
    s_lshl_b32 s44, s44, 3
    s_add_u32 s56, s56, s44
    s_add_u32 s56, s56, s40
    s_lshl_b32 s56, s56, 2
    s_add_u32 s56, s56, 0
    s_cmp_eq_u32 s4, 0
    s_cselect_b32 s56, s56, 0x7fffff00
    s_cmp_ge_u32 s40, 7
    s_cselect_b32 s98, 1, 2
    s_cmp_ge_u32 s52, 16
    s_waitcnt lgkmcnt(0)
    s_cbranch_scc1 W_v
    s_load_dwordx2 s[16:17], s[0:1], 24
    s_mov_b32 s18, 0x400000
    s_mov_b32 s19, 0x20000
    s_load_dwordx2 s[20:21], s[0:1], 24
    s_mov_b32 s22, 0x400000
    s_mov_b32 s23, 0x20000
    s_lshl_b32 s44, s53, 9
    s_lshl_b32 s45, s4, 7
    s_add_u32 s44, s44, s45
    s_mov_b32 s55, s44
    v_mul_u32_u24 v4, 65536, v2
    v_lshl_add_u32 v4, v1, 2, v4
    v_add_u32 v4, s44, v4
    v_add_u32 v5, 8192, v4
    v_mov_b32 v6, v4
    v_mov_b32 v7, v5
    s_lshl_b32 s43, s53, 14
    s_lshr_b32 s45, s4, 1
    s_lshl_b32 s45, s45, 13
    s_add_u32 s43, s43, s45
    s_and_b32 s45, s4, 1
    s_lshl_b32 s45, s45, 11
    s_add_u32 s43, s43, s45
    s_add_u32 s43, s43, 0x2000000
    s_mov_b32 s51, 0x40000
    s_waitcnt lgkmcnt(0)
    s_lshl_b32 s58, s53, 13
    s_lshl_b32 s44, s4, 11
    s_add_u32 s58, s58, s44
    s_add_u32 s58, s58, 0x800000
W_kq:
    s_barrier
    s_mov_b32 s50, s40
    s_mov_b32 s57, 0
    s_mov_b32 s42, 0
    s_lshl_b32 s44, s50, 15
    s_lshl_b32 s45, s4, 13
    s_add_u32 s44, s44, s45
    s_add_u32 s45, s42, s49
    s_add_u32 m0, s45, 0
    s_nop 0
    buffer_load_dwordx4 v0, s[24:27], s44 offen lds
    s_add_u32 m0, s45, 1056
    s_add_u32 s44, s44, 1024
    buffer_load_dwordx4 v0, s[24:27], s44 offen lds
    s_add_u32 m0, s45, 2112
    s_add_u32 s44, s44, 1024
    buffer_load_dwordx4 v0, s[24:27], s44 offen lds
    s_add_u32 m0, s45, 3168
    s_add_u32 s44, s44, 1024
    buffer_load_dwordx4 v0, s[24:27], s44 offen lds
    s_add_u32 m0, s45, 4224
    s_add_u32 s44, s44, 1024
    buffer_load_dwordx4 v0, s[24:27], s44 offen lds
    s_add_u32 m0, s45, 5280
    s_add_u32 s44, s44, 1024
    buffer_load_dwordx4 v0, s[24:27], s44 offen lds
    s_add_u32 m0, s45, 6336
    s_add_u32 s44, s44, 1024
    buffer_load_dwordx4 v0, s[24:27], s44 offen lds
    s_add_u32 m0, s45, 7392
    s_add_u32 s44, s44, 1024
    buffer_load_dwordx4 v0, s[24:27], s44 offen lds
    s_add_u32 s50, s50, s41
    v_lshrrev_b32 v10, 9, v0
    v_bfe_u32 v4, v0, 7, 2
    v_lshl_add_u32 v4, v4, 3, v10
    v_and_b32 v10, 0x70, v0
    v_lshl_add_u32 v4, v4, 13, v10
    v_add_u32 v4, s55, v4
    s_mul_i32 s48, s4, 20480
    s_add_u32 s48, s48, 33792
    s_add_u32 m0, s48, 0
    s_mov_b32 s46, 0x0
    buffer_load_dwordx4 v4, s[16:19], s46 offen lds
    s_add_u32 m0, s48, 1024
    s_mov_b32 s46, 0x4000
    buffer_load_dwordx4 v4, s[16:19], s46 offen lds
    s_add_u32 m0, s48, 2048
    s_mov_b32 s46, 0x8000
    buffer_load_dwordx4 v4, s[16:19], s46 offen lds
    s_add_u32 m0, s48, 3072
    s_mov_b32 s46, 0xc000
    buffer_load_dwordx4 v4, s[16:19], s46 offen lds
    s_add_u32 m0, s48, 4096
    s_mov_b32 s46, 0x40000
    buffer_load_dwordx4 v4, s[16:19], s46 offen lds
    s_add_u32 m0, s48, 5120
    s_mov_b32 s46, 0x44000
    buffer_load_dwordx4 v4, s[16:19], s46 offen lds
    s_add_u32 m0, s48, 6144
    s_mov_b32 s46, 0x48000
    buffer_load_dwordx4 v4, s[16:19], s46 offen lds
    s_add_u32 m0, s48, 7168
    s_mov_b32 s46, 0x4c000
    buffer_load_dwordx4 v4, s[16:19], s46 offen lds
    s_add_u32 m0, s48, 8192
    s_mov_b32 s46, 0x80000
    buffer_load_dwordx4 v4, s[16:19], s46 offen lds
    s_add_u32 m0, s48, 9216
    s_mov_b32 s46, 0x84000
    buffer_load_dwordx4 v4, s[16:19], s46 offen lds
    s_add_u32 m0, s48, 10240
    s_mov_b32 s46, 0x88000
    buffer_load_dwordx4 v4, s[16:19], s46 offen lds
    s_add_u32 m0, s48, 11264
    s_mov_b32 s46, 0x8c000
    buffer_load_dwordx4 v4, s[16:19], s46 offen lds
    s_add_u32 m0, s48, 12288
    s_mov_b32 s46, 0xc0000
    buffer_load_dwordx4 v4, s[16:19], s46 offen lds
    s_add_u32 m0, s48, 13312
    s_mov_b32 s46, 0xc4000
    buffer_load_dwordx4 v4, s[16:19], s46 offen lds
    s_add_u32 m0, s48, 14336
    s_mov_b32 s46, 0xc8000
    buffer_load_dwordx4 v4, s[16:19], s46 offen lds
    s_add_u32 m0, s48, 15360
    s_mov_b32 s46, 0xcc000
    buffer_load_dwordx4 v4, s[16:19], s46 offen lds
    s_add_u32 m0, s48, 16384
    s_mov_b32 s46, 0x100000
    buffer_load_dwordx4 v4, s[16:19], s46 offen lds
    s_add_u32 m0, s48, 17408
    s_mov_b32 s46, 0x104000
    buffer_load_dwordx4 v4, s[16:19], s46 offen lds
    s_add_u32 m0, s48, 18432
    s_mov_b32 s46, 0x108000
    buffer_load_dwordx4 v4, s[16:19], s46 offen lds
    s_add_u32 m0, s48, 19456
    s_mov_b32 s46, 0x10c000
    buffer_load_dwordx4 v4, s[16:19], s46 offen lds
    v_lshlrev_b32 v6, 7, v2
    v_lshl_add_u32 v6, v1, 2, v6
    v_add_u32 v6, s48, v6
    v_add_u32 v7, 64, v6
    s_waitcnt vmcnt(16)
    ds_read2st64_b32 v[104:105], v6 offset0:0 offset1:2
    ds_read2st64_b32 v[106:107], v7 offset0:0 offset1:2
    ds_read2st64_b32 v[108:109], v6 offset0:4 offset1:6
    ds_read2st64_b32 v[110:111], v7 offset0:4 offset1:6
    ds_read2st64_b32 v[112:113], v6 offset0:8 offset1:10
    ds_read2st64_b32 v[114:115], v7 offset0:8 offset1:10
    ds_read2st64_b32 v[116:117], v6 offset0:12 offset1:14
    ds_read2st64_b32 v[118:119], v7 offset0:12 offset1:14
    s_waitcnt vmcnt(12) lgkmcnt(0)
    ds_read2st64_b32 v[120:121], v6 offset0:16 offset1:18
    ds_read2st64_b32 v[122:123], v7 offset0:16 offset1:18
    ds_read2st64_b32 v[124:125], v6 offset0:20 offset1:22
    ds_read2st64_b32 v[126:127], v7 offset0:20 offset1:22
    ds_read2st64_b32 v[128:129], v6 offset0:24 offset1:26
    ds_read2st64_b32 v[130:131], v7 offset0:24 offset1:26
    ds_read2st64_b32 v[132:133], v6 offset0:28 offset1:30
    ds_read2st64_b32 v[134:135], v7 offset0:28 offset1:30
    s_cmp_eq_u32 s97, 0
    s_cbranch_scc1 GK_ws
    s_mov_b32 s97, 0
    s_lshl_b32 s44, s96, 15
    s_lshr_b32 s45, s4, 1
    s_lshl_b32 s45, s45, 14
    s_add_u32 s44, s44, s45
    s_and_b32 s45, s4, 1
    s_lshl_b32 s45, s45, 11
    s_add_u32 s44, s44, s45
    s_add_u32 s44, s44, 0x200000
    s_add_u32 s45, s44, 0
    v_perm_b32 v172, v141, v140, s37
    v_perm_b32 v173, v143, v142, s37
    v_perm_b32 v174, v145, v144, s37
    v_perm_b32 v175, v147, v146, s37
    buffer_store_dwordx4 v[172:175], v0, s[8:11], s45 offen offset:0 sc1
    v_perm_b32 v176, v141, v140, s38
    v_perm_b32 v177, v143, v142, s38
    v_perm_b32 v178, v145, v144, s38
    v_perm_b32 v179, v147, v146, s38
    buffer_store_dwordx4 v[176:179], v0, s[8:11], s45 offen offset:1024 sc1
    s_add_u32 s45, s44, 4096
    v_perm_b32 v180, v149, v148, s37
    v_perm_b32 v181, v151, v150, s37
    v_perm_b32 v182, v153, v152, s37
    v_perm_b32 v183, v155, v154, s37
    buffer_store_dwordx4 v[180:183], v0, s[8:11], s45 offen offset:0 sc1
    v_perm_b32 v184, v149, v148, s38
    v_perm_b32 v185, v151, v150, s38
    v_perm_b32 v186, v153, v152, s38
    v_perm_b32 v187, v155, v154, s38
    buffer_store_dwordx4 v[184:187], v0, s[8:11], s45 offen offset:1024 sc1
    s_add_u32 s45, s44, 8192
    v_perm_b32 v188, v157, v156, s37
    v_perm_b32 v189, v159, v158, s37
    v_perm_b32 v190, v161, v160, s37
    v_perm_b32 v191, v163, v162, s37
    buffer_store_dwordx4 v[188:191], v0, s[8:11], s45 offen offset:0 sc1
    v_perm_b32 v192, v157, v156, s38
    v_perm_b32 v193, v159, v158, s38
    v_perm_b32 v194, v161, v160, s38
    v_perm_b32 v195, v163, v162, s38
    buffer_store_dwordx4 v[192:195], v0, s[8:11], s45 offen offset:1024 sc1
    s_add_u32 s45, s44, 12288
    v_perm_b32 v196, v165, v164, s37
    v_perm_b32 v197, v167, v166, s37
    v_perm_b32 v198, v169, v168, s37
    v_perm_b32 v199, v171, v170, s37
    buffer_store_dwordx4 v[196:199], v0, s[8:11], s45 offen offset:0 sc1
    v_perm_b32 v200, v165, v164, s38
    v_perm_b32 v201, v167, v166, s38
    v_perm_b32 v202, v169, v168, s38
    v_perm_b32 v203, v171, v170, s38
    buffer_store_dwordx4 v[200:203], v0, s[8:11], s45 offen offset:1024 sc1
GK_ws:
    s_add_u32 m0, s48, 0
    s_mov_b32 s46, 0x140000
    buffer_load_dwordx4 v4, s[16:19], s46 offen lds
    v_perm_b32 v8, v105, v104, s37
    v_accvgpr_write_b32 a0, v8
    v_perm_b32 v9, v105, v104, s38
    v_accvgpr_write_b32 a4, v9
    v_perm_b32 v8, v107, v106, s37
    v_accvgpr_write_b32 a8, v8
    v_perm_b32 v9, v107, v106, s38
    v_accvgpr_write_b32 a12, v9
    s_add_u32 m0, s48, 1024
    s_mov_b32 s46, 0x144000
    buffer_load_dwordx4 v4, s[16:19], s46 offen lds
    v_perm_b32 v8, v109, v108, s37
    v_accvgpr_write_b32 a1, v8
    v_perm_b32 v9, v109, v108, s38
    v_accvgpr_write_b32 a5, v9
    v_perm_b32 v8, v111, v110, s37
    v_accvgpr_write_b32 a9, v8
    v_perm_b32 v9, v111, v110, s38
    v_accvgpr_write_b32 a13, v9
    s_add_u32 m0, s48, 2048
    s_mov_b32 s46, 0x148000
    buffer_load_dwordx4 v4, s[16:19], s46 offen lds
    v_perm_b32 v8, v113, v112, s37
    v_accvgpr_write_b32 a2, v8
    v_perm_b32 v9, v113, v112, s38
    v_accvgpr_write_b32 a6, v9
    v_perm_b32 v8, v115, v114, s37
    v_accvgpr_write_b32 a10, v8
    v_perm_b32 v9, v115, v114, s38
    v_accvgpr_write_b32 a14, v9
    s_add_u32 m0, s48, 3072
    s_mov_b32 s46, 0x14c000
    buffer_load_dwordx4 v4, s[16:19], s46 offen lds
    v_perm_b32 v8, v117, v116, s37
    v_accvgpr_write_b32 a3, v8
    v_perm_b32 v9, v117, v116, s38
    v_accvgpr_write_b32 a7, v9
    v_perm_b32 v8, v119, v118, s37
    v_accvgpr_write_b32 a11, v8
    v_perm_b32 v9, v119, v118, s38
    v_accvgpr_write_b32 a15, v9
    s_waitcnt vmcnt(12) lgkmcnt(0)
    ds_read2st64_b32 v[104:105], v6 offset0:32 offset1:34
    ds_read2st64_b32 v[106:107], v7 offset0:32 offset1:34
    ds_read2st64_b32 v[108:109], v6 offset0:36 offset1:38
    ds_read2st64_b32 v[110:111], v7 offset0:36 offset1:38
    ds_read2st64_b32 v[112:113], v6 offset0:40 offset1:42
    ds_read2st64_b32 v[114:115], v7 offset0:40 offset1:42
    ds_read2st64_b32 v[116:117], v6 offset0:44 offset1:46
    ds_read2st64_b32 v[118:119], v7 offset0:44 offset1:46
    s_add_u32 m0, s48, 4096
    s_mov_b32 s46, 0x180000
    buffer_load_dwordx4 v4, s[16:19], s46 offen lds
    v_perm_b32 v8, v121, v120, s37
    v_accvgpr_write_b32 a16, v8
    v_perm_b32 v9, v121, v120, s38
    v_accvgpr_write_b32 a20, v9
    v_perm_b32 v8, v123, v122, s37
    v_accvgpr_write_b32 a24, v8
    v_perm_b32 v9, v123, v122, s38
    v_accvgpr_write_b32 a28, v9
    s_add_u32 m0, s48, 5120
    s_mov_b32 s46, 0x184000
    buffer_load_dwordx4 v4, s[16:19], s46 offen lds
    v_perm_b32 v8, v125, v124, s37
    v_accvgpr_write_b32 a17, v8
    v_perm_b32 v9, v125, v124, s38
    v_accvgpr_write_b32 a21, v9
    v_perm_b32 v8, v127, v126, s37
    v_accvgpr_write_b32 a25, v8
    v_perm_b32 v9, v127, v126, s38
    v_accvgpr_write_b32 a29, v9
    s_add_u32 m0, s48, 6144
    s_mov_b32 s46, 0x188000
    buffer_load_dwordx4 v4, s[16:19], s46 offen lds
    v_perm_b32 v8, v129, v128, s37
    v_accvgpr_write_b32 a18, v8
    v_perm_b32 v9, v129, v128, s38
    v_accvgpr_write_b32 a22, v9
    v_perm_b32 v8, v131, v130, s37
    v_accvgpr_write_b32 a26, v8
    v_perm_b32 v9, v131, v130, s38
    v_accvgpr_write_b32 a30, v9
    s_add_u32 m0, s48, 7168
    s_mov_b32 s46, 0x18c000
    buffer_load_dwordx4 v4, s[16:19], s46 offen lds
    v_perm_b32 v8, v133, v132, s37
    v_accvgpr_write_b32 a19, v8
    v_perm_b32 v9, v133, v132, s38
    v_accvgpr_write_b32 a23, v9
    v_perm_b32 v8, v135, v134, s37
    v_accvgpr_write_b32 a27, v8
    v_perm_b32 v9, v135, v134, s38
    v_accvgpr_write_b32 a31, v9
    s_waitcnt vmcnt(12) lgkmcnt(0)
    ds_read2st64_b32 v[120:121], v6 offset0:48 offset1:50
    ds_read2st64_b32 v[122:123], v7 offset0:48 offset1:50
    ds_read2st64_b32 v[124:125], v6 offset0:52 offset1:54
    ds_read2st64_b32 v[126:127], v7 offset0:52 offset1:54
    ds_read2st64_b32 v[128:129], v6 offset0:56 offset1:58
    ds_read2st64_b32 v[130:131], v7 offset0:56 offset1:58
    ds_read2st64_b32 v[132:133], v6 offset0:60 offset1:62
    ds_read2st64_b32 v[134:135], v7 offset0:60 offset1:62
    s_add_u32 m0, s48, 8192
    s_mov_b32 s46, 0x1c0000
    buffer_load_dwordx4 v4, s[16:19], s46 offen lds
    v_perm_b32 v8, v105, v104, s37
    v_accvgpr_write_b32 a32, v8
    v_perm_b32 v9, v105, v104, s38
    v_accvgpr_write_b32 a36, v9
    v_perm_b32 v8, v107, v106, s37
    v_accvgpr_write_b32 a40, v8
    v_perm_b32 v9, v107, v106, s38
    v_accvgpr_write_b32 a44, v9
    s_add_u32 m0, s48, 9216
    s_mov_b32 s46, 0x1c4000
    buffer_load_dwordx4 v4, s[16:19], s46 offen lds
    v_perm_b32 v8, v109, v108, s37
    v_accvgpr_write_b32 a33, v8
    v_perm_b32 v9, v109, v108, s38
    v_accvgpr_write_b32 a37, v9
    v_perm_b32 v8, v111, v110, s37
    v_accvgpr_write_b32 a41, v8
    v_perm_b32 v9, v111, v110, s38
    v_accvgpr_write_b32 a45, v9
    s_add_u32 m0, s48, 10240
    s_mov_b32 s46, 0x1c8000
    buffer_load_dwordx4 v4, s[16:19], s46 offen lds
    v_perm_b32 v8, v113, v112, s37
    v_accvgpr_write_b32 a34, v8
    v_perm_b32 v9, v113, v112, s38
    v_accvgpr_write_b32 a38, v9
    v_perm_b32 v8, v115, v114, s37
    v_accvgpr_write_b32 a42, v8
    v_perm_b32 v9, v115, v114, s38
    v_accvgpr_write_b32 a46, v9
    s_add_u32 m0, s48, 11264
    s_mov_b32 s46, 0x1cc000
    buffer_load_dwordx4 v4, s[16:19], s46 offen lds
    v_perm_b32 v8, v117, v116, s37
    v_accvgpr_write_b32 a35, v8
    v_perm_b32 v9, v117, v116, s38
    v_accvgpr_write_b32 a39, v9
    v_perm_b32 v8, v119, v118, s37
    v_accvgpr_write_b32 a43, v8
    v_perm_b32 v9, v119, v118, s38
    v_accvgpr_write_b32 a47, v9
    s_waitcnt vmcnt(12) lgkmcnt(0)
    ds_read2st64_b32 v[104:105], v6 offset0:64 offset1:66
    ds_read2st64_b32 v[106:107], v7 offset0:64 offset1:66
    ds_read2st64_b32 v[108:109], v6 offset0:68 offset1:70
    ds_read2st64_b32 v[110:111], v7 offset0:68 offset1:70
    ds_read2st64_b32 v[112:113], v6 offset0:72 offset1:74
    ds_read2st64_b32 v[114:115], v7 offset0:72 offset1:74
    ds_read2st64_b32 v[116:117], v6 offset0:76 offset1:78
    ds_read2st64_b32 v[118:119], v7 offset0:76 offset1:78
    s_add_u32 m0, s48, 12288
    s_mov_b32 s46, 0x200000
    buffer_load_dwordx4 v4, s[16:19], s46 offen lds
    v_perm_b32 v8, v121, v120, s37
    v_accvgpr_write_b32 a48, v8
    v_perm_b32 v9, v121, v120, s38
    v_accvgpr_write_b32 a52, v9
    v_perm_b32 v8, v123, v122, s37
    v_accvgpr_write_b32 a56, v8
    v_perm_b32 v9, v123, v122, s38
    v_accvgpr_write_b32 a60, v9
    s_add_u32 m0, s48, 13312
    s_mov_b32 s46, 0x204000
    buffer_load_dwordx4 v4, s[16:19], s46 offen lds
    v_perm_b32 v8, v125, v124, s37
    v_accvgpr_write_b32 a49, v8
    v_perm_b32 v9, v125, v124, s38
    v_accvgpr_write_b32 a53, v9
    v_perm_b32 v8, v127, v126, s37
    v_accvgpr_write_b32 a57, v8
    v_perm_b32 v9, v127, v126, s38
    v_accvgpr_write_b32 a61, v9
    s_add_u32 m0, s48, 14336
    s_mov_b32 s46, 0x208000
    buffer_load_dwordx4 v4, s[16:19], s46 offen lds
    v_perm_b32 v8, v129, v128, s37
    v_accvgpr_write_b32 a50, v8
    v_perm_b32 v9, v129, v128, s38
    v_accvgpr_write_b32 a54, v9
    v_perm_b32 v8, v131, v130, s37
    v_accvgpr_write_b32 a58, v8
    v_perm_b32 v9, v131, v130, s38
    v_accvgpr_write_b32 a62, v9
    s_add_u32 m0, s48, 15360
    s_mov_b32 s46, 0x20c000
    buffer_load_dwordx4 v4, s[16:19], s46 offen lds
    v_perm_b32 v8, v133, v132, s37
    v_accvgpr_write_b32 a51, v8
    v_perm_b32 v9, v133, v132, s38
    v_accvgpr_write_b32 a55, v9
    v_perm_b32 v8, v135, v134, s37
    v_accvgpr_write_b32 a59, v8
    v_perm_b32 v9, v135, v134, s38
    v_accvgpr_write_b32 a63, v9
    s_waitcnt vmcnt(12) lgkmcnt(0)
    ds_read2st64_b32 v[120:121], v6 offset0:0 offset1:2
    ds_read2st64_b32 v[122:123], v7 offset0:0 offset1:2
    ds_read2st64_b32 v[124:125], v6 offset0:4 offset1:6
    ds_read2st64_b32 v[126:127], v7 offset0:4 offset1:6
    ds_read2st64_b32 v[128:129], v6 offset0:8 offset1:10
    ds_read2st64_b32 v[130:131], v7 offset0:8 offset1:10
    ds_read2st64_b32 v[132:133], v6 offset0:12 offset1:14
    ds_read2st64_b32 v[134:135], v7 offset0:12 offset1:14
    s_add_u32 m0, s48, 16384
    s_mov_b32 s46, 0x240000
    buffer_load_dwordx4 v4, s[16:19], s46 offen lds
    v_perm_b32 v8, v105, v104, s37
    v_accvgpr_write_b32 a64, v8
    v_perm_b32 v9, v105, v104, s38
    v_accvgpr_write_b32 a68, v9
    v_perm_b32 v8, v107, v106, s37
    v_accvgpr_write_b32 a72, v8
    v_perm_b32 v9, v107, v106, s38
    v_accvgpr_write_b32 a76, v9
    s_add_u32 m0, s48, 17408
    s_mov_b32 s46, 0x244000
    buffer_load_dwordx4 v4, s[16:19], s46 offen lds
    v_perm_b32 v8, v109, v108, s37
    v_accvgpr_write_b32 a65, v8
    v_perm_b32 v9, v109, v108, s38
    v_accvgpr_write_b32 a69, v9
    v_perm_b32 v8, v111, v110, s37
    v_accvgpr_write_b32 a73, v8
    v_perm_b32 v9, v111, v110, s38
    v_accvgpr_write_b32 a77, v9
    s_add_u32 m0, s48, 18432
    s_mov_b32 s46, 0x248000
    buffer_load_dwordx4 v4, s[16:19], s46 offen lds
    v_perm_b32 v8, v113, v112, s37
    v_accvgpr_write_b32 a66, v8
    v_perm_b32 v9, v113, v112, s38
    v_accvgpr_write_b32 a70, v9
    v_perm_b32 v8, v115, v114, s37
    v_accvgpr_write_b32 a74, v8
    v_perm_b32 v9, v115, v114, s38
    v_accvgpr_write_b32 a78, v9
    s_add_u32 m0, s48, 19456
    s_mov_b32 s46, 0x24c000
    buffer_load_dwordx4 v4, s[16:19], s46 offen lds
    v_perm_b32 v8, v117, v116, s37
    v_accvgpr_write_b32 a67, v8
    v_perm_b32 v9, v117, v116, s38
    v_accvgpr_write_b32 a71, v9
    v_perm_b32 v8, v119, v118, s37
    v_accvgpr_write_b32 a75, v8
    v_perm_b32 v9, v119, v118, s38
    v_accvgpr_write_b32 a79, v9
    s_waitcnt vmcnt(12) lgkmcnt(0)
    ds_read2st64_b32 v[104:105], v6 offset0:16 offset1:18
    ds_read2st64_b32 v[106:107], v7 offset0:16 offset1:18
    ds_read2st64_b32 v[108:109], v6 offset0:20 offset1:22
    ds_read2st64_b32 v[110:111], v7 offset0:20 offset1:22
    ds_read2st64_b32 v[112:113], v6 offset0:24 offset1:26
    ds_read2st64_b32 v[114:115], v7 offset0:24 offset1:26
    ds_read2st64_b32 v[116:117], v6 offset0:28 offset1:30
    ds_read2st64_b32 v[118:119], v7 offset0:28 offset1:30
    s_barrier
    s_mov_b32 s63, 128
    s_cmp_eq_u32 s99, 0
    s_cselect_b32 s63, s63, 0x7fffff00
    s_mov_b32 s99, 1
    v_mov_b32 v11, 1
    s_mov_b64 exec, 1
    buffer_atomic_add v11, off, s[12:15], s63
    s_mov_b64 exec, -1
    s_add_u32 m0, s48, 0
    s_mov_b32 s46, 0x280000
    buffer_load_dwordx4 v4, s[16:19], s46 offen lds
    v_perm_b32 v8, v121, v120, s37
    v_accvgpr_write_b32 a80, v8
    v_perm_b32 v9, v121, v120, s38
    v_accvgpr_write_b32 a84, v9
    v_perm_b32 v8, v123, v122, s37
    v_accvgpr_write_b32 a88, v8
    v_perm_b32 v9, v123, v122, s38
    v_accvgpr_write_b32 a92, v9
    s_add_u32 m0, s48, 1024
    s_mov_b32 s46, 0x284000
    buffer_load_dwordx4 v4, s[16:19], s46 offen lds
    v_perm_b32 v8, v125, v124, s37
    v_accvgpr_write_b32 a81, v8
    v_perm_b32 v9, v125, v124, s38
    v_accvgpr_write_b32 a85, v9
    v_perm_b32 v8, v127, v126, s37
    v_accvgpr_write_b32 a89, v8
    v_perm_b32 v9, v127, v126, s38
    v_accvgpr_write_b32 a93, v9
    s_add_u32 m0, s48, 2048
    s_mov_b32 s46, 0x288000
    buffer_load_dwordx4 v4, s[16:19], s46 offen lds
    v_perm_b32 v8, v129, v128, s37
    v_accvgpr_write_b32 a82, v8
    v_perm_b32 v9, v129, v128, s38
    v_accvgpr_write_b32 a86, v9
    v_perm_b32 v8, v131, v130, s37
    v_accvgpr_write_b32 a90, v8
    v_perm_b32 v9, v131, v130, s38
    v_accvgpr_write_b32 a94, v9
    s_add_u32 m0, s48, 3072
    s_mov_b32 s46, 0x28c000
    buffer_load_dwordx4 v4, s[16:19], s46 offen lds
    v_perm_b32 v8, v133, v132, s37
    v_accvgpr_write_b32 a83, v8
    v_perm_b32 v9, v133, v132, s38
    v_accvgpr_write_b32 a87, v9
    v_perm_b32 v8, v135, v134, s37
    v_accvgpr_write_b32 a91, v8
    v_perm_b32 v9, v135, v134, s38
    v_accvgpr_write_b32 a95, v9
    s_waitcnt vmcnt(12) lgkmcnt(0)
    ds_read2st64_b32 v[120:121], v6 offset0:32 offset1:34
    ds_read2st64_b32 v[122:123], v7 offset0:32 offset1:34
    ds_read2st64_b32 v[124:125], v6 offset0:36 offset1:38
    ds_read2st64_b32 v[126:127], v7 offset0:36 offset1:38
    ds_read2st64_b32 v[128:129], v6 offset0:40 offset1:42
    ds_read2st64_b32 v[130:131], v7 offset0:40 offset1:42
    ds_read2st64_b32 v[132:133], v6 offset0:44 offset1:46
    ds_read2st64_b32 v[134:135], v7 offset0:44 offset1:46
    s_add_u32 m0, s48, 4096
    s_mov_b32 s46, 0x2c0000
    buffer_load_dwordx4 v4, s[16:19], s46 offen lds
    v_perm_b32 v8, v105, v104, s37
    v_accvgpr_write_b32 a96, v8
    v_perm_b32 v9, v105, v104, s38
    v_accvgpr_write_b32 a100, v9
    v_perm_b32 v8, v107, v106, s37
    v_accvgpr_write_b32 a104, v8
    v_perm_b32 v9, v107, v106, s38
    v_accvgpr_write_b32 a108, v9
    s_add_u32 m0, s48, 5120
    s_mov_b32 s46, 0x2c4000
    buffer_load_dwordx4 v4, s[16:19], s46 offen lds
    v_perm_b32 v8, v109, v108, s37
    v_accvgpr_write_b32 a97, v8
    v_perm_b32 v9, v109, v108, s38
    v_accvgpr_write_b32 a101, v9
    v_perm_b32 v8, v111, v110, s37
    v_accvgpr_write_b32 a105, v8
    v_perm_b32 v9, v111, v110, s38
    v_accvgpr_write_b32 a109, v9
    s_add_u32 m0, s48, 6144
    s_mov_b32 s46, 0x2c8000
    buffer_load_dwordx4 v4, s[16:19], s46 offen lds
    v_perm_b32 v8, v113, v112, s37
    v_accvgpr_write_b32 a98, v8
    v_perm_b32 v9, v113, v112, s38
    v_accvgpr_write_b32 a102, v9
    v_perm_b32 v8, v115, v114, s37
    v_accvgpr_write_b32 a106, v8
    v_perm_b32 v9, v115, v114, s38
    v_accvgpr_write_b32 a110, v9
    s_add_u32 m0, s48, 7168
    s_mov_b32 s46, 0x2cc000
    buffer_load_dwordx4 v4, s[16:19], s46 offen lds
    v_perm_b32 v8, v117, v116, s37
    v_accvgpr_write_b32 a99, v8
    v_perm_b32 v9, v117, v116, s38
    v_accvgpr_write_b32 a103, v9
    v_perm_b32 v8, v119, v118, s37
    v_accvgpr_write_b32 a107, v8
    v_perm_b32 v9, v119, v118, s38
    v_accvgpr_write_b32 a111, v9
    s_waitcnt vmcnt(12) lgkmcnt(0)
    ds_read2st64_b32 v[104:105], v6 offset0:48 offset1:50
    ds_read2st64_b32 v[106:107], v7 offset0:48 offset1:50
    ds_read2st64_b32 v[108:109], v6 offset0:52 offset1:54
    ds_read2st64_b32 v[110:111], v7 offset0:52 offset1:54
    ds_read2st64_b32 v[112:113], v6 offset0:56 offset1:58
    ds_read2st64_b32 v[114:115], v7 offset0:56 offset1:58
    ds_read2st64_b32 v[116:117], v6 offset0:60 offset1:62
    ds_read2st64_b32 v[118:119], v7 offset0:60 offset1:62
    s_add_u32 m0, s48, 8192
    s_mov_b32 s46, 0x300000
    buffer_load_dwordx4 v4, s[16:19], s46 offen lds
    v_perm_b32 v8, v121, v120, s37
    v_accvgpr_write_b32 a112, v8
    v_perm_b32 v9, v121, v120, s38
    v_accvgpr_write_b32 a116, v9
    v_perm_b32 v8, v123, v122, s37
    v_accvgpr_write_b32 a120, v8
    v_perm_b32 v9, v123, v122, s38
    v_accvgpr_write_b32 a124, v9
    s_add_u32 m0, s48, 9216
    s_mov_b32 s46, 0x304000
    buffer_load_dwordx4 v4, s[16:19], s46 offen lds
    v_perm_b32 v8, v125, v124, s37
    v_accvgpr_write_b32 a113, v8
    v_perm_b32 v9, v125, v124, s38
    v_accvgpr_write_b32 a117, v9
    v_perm_b32 v8, v127, v126, s37
    v_accvgpr_write_b32 a121, v8
    v_perm_b32 v9, v127, v126, s38
    v_accvgpr_write_b32 a125, v9
    s_add_u32 m0, s48, 10240
    s_mov_b32 s46, 0x308000
    buffer_load_dwordx4 v4, s[16:19], s46 offen lds
    v_perm_b32 v8, v129, v128, s37
    v_accvgpr_write_b32 a114, v8
    v_perm_b32 v9, v129, v128, s38
    v_accvgpr_write_b32 a118, v9
    v_perm_b32 v8, v131, v130, s37
    v_accvgpr_write_b32 a122, v8
    v_perm_b32 v9, v131, v130, s38
    v_accvgpr_write_b32 a126, v9
    s_add_u32 m0, s48, 11264
    s_mov_b32 s46, 0x30c000
    buffer_load_dwordx4 v4, s[16:19], s46 offen lds
    v_perm_b32 v8, v133, v132, s37
    v_accvgpr_write_b32 a115, v8
    v_perm_b32 v9, v133, v132, s38
    v_accvgpr_write_b32 a119, v9
    v_perm_b32 v8, v135, v134, s37
    v_accvgpr_write_b32 a123, v8
    v_perm_b32 v9, v135, v134, s38
    v_accvgpr_write_b32 a127, v9
    s_waitcnt vmcnt(12) lgkmcnt(0)
    ds_read2st64_b32 v[120:121], v6 offset0:64 offset1:66
    ds_read2st64_b32 v[122:123], v7 offset0:64 offset1:66
    ds_read2st64_b32 v[124:125], v6 offset0:68 offset1:70
    ds_read2st64_b32 v[126:127], v7 offset0:68 offset1:70
    ds_read2st64_b32 v[128:129], v6 offset0:72 offset1:74
    ds_read2st64_b32 v[130:131], v7 offset0:72 offset1:74
    ds_read2st64_b32 v[132:133], v6 offset0:76 offset1:78
    ds_read2st64_b32 v[134:135], v7 offset0:76 offset1:78
    s_add_u32 m0, s48, 12288
    s_mov_b32 s46, 0x340000
    buffer_load_dwordx4 v4, s[16:19], s46 offen lds
    v_perm_b32 v8, v105, v104, s37
    v_accvgpr_write_b32 a128, v8
    v_perm_b32 v9, v105, v104, s38
    v_accvgpr_write_b32 a132, v9
    v_perm_b32 v8, v107, v106, s37
    v_accvgpr_write_b32 a136, v8
    v_perm_b32 v9, v107, v106, s38
    v_accvgpr_write_b32 a140, v9
    s_add_u32 m0, s48, 13312
    s_mov_b32 s46, 0x344000
    buffer_load_dwordx4 v4, s[16:19], s46 offen lds
    v_perm_b32 v8, v109, v108, s37
    v_accvgpr_write_b32 a129, v8
    v_perm_b32 v9, v109, v108, s38
    v_accvgpr_write_b32 a133, v9
    v_perm_b32 v8, v111, v110, s37
    v_accvgpr_write_b32 a137, v8
    v_perm_b32 v9, v111, v110, s38
    v_accvgpr_write_b32 a141, v9
    s_add_u32 m0, s48, 14336
    s_mov_b32 s46, 0x348000
    buffer_load_dwordx4 v4, s[16:19], s46 offen lds
    v_perm_b32 v8, v113, v112, s37
    v_accvgpr_write_b32 a130, v8
    v_perm_b32 v9, v113, v112, s38
    v_accvgpr_write_b32 a134, v9
    v_perm_b32 v8, v115, v114, s37
    v_accvgpr_write_b32 a138, v8
    v_perm_b32 v9, v115, v114, s38
    v_accvgpr_write_b32 a142, v9
    s_add_u32 m0, s48, 15360
    s_mov_b32 s46, 0x34c000
    buffer_load_dwordx4 v4, s[16:19], s46 offen lds
    v_perm_b32 v8, v117, v116, s37
    v_accvgpr_write_b32 a131, v8
    v_perm_b32 v9, v117, v116, s38
    v_accvgpr_write_b32 a135, v9
    v_perm_b32 v8, v119, v118, s37
    v_accvgpr_write_b32 a139, v8
    v_perm_b32 v9, v119, v118, s38
    v_accvgpr_write_b32 a143, v9
    s_waitcnt vmcnt(12) lgkmcnt(0)
    ds_read2st64_b32 v[104:105], v6 offset0:0 offset1:2
    ds_read2st64_b32 v[106:107], v7 offset0:0 offset1:2
    ds_read2st64_b32 v[108:109], v6 offset0:4 offset1:6
    ds_read2st64_b32 v[110:111], v7 offset0:4 offset1:6
    ds_read2st64_b32 v[112:113], v6 offset0:8 offset1:10
    ds_read2st64_b32 v[114:115], v7 offset0:8 offset1:10
    ds_read2st64_b32 v[116:117], v6 offset0:12 offset1:14
    ds_read2st64_b32 v[118:119], v7 offset0:12 offset1:14
    s_add_u32 m0, s48, 16384
    s_mov_b32 s46, 0x380000
    buffer_load_dwordx4 v4, s[16:19], s46 offen lds
    v_perm_b32 v8, v121, v120, s37
    v_accvgpr_write_b32 a144, v8
    v_perm_b32 v9, v121, v120, s38
    v_accvgpr_write_b32 a148, v9
    v_perm_b32 v8, v123, v122, s37
    v_accvgpr_write_b32 a152, v8
    v_perm_b32 v9, v123, v122, s38
    v_accvgpr_write_b32 a156, v9
    s_add_u32 m0, s48, 17408
    s_mov_b32 s46, 0x384000
    buffer_load_dwordx4 v4, s[16:19], s46 offen lds
    v_perm_b32 v8, v125, v124, s37
    v_accvgpr_write_b32 a145, v8
    v_perm_b32 v9, v125, v124, s38
    v_accvgpr_write_b32 a149, v9
    v_perm_b32 v8, v127, v126, s37
    v_accvgpr_write_b32 a153, v8
    v_perm_b32 v9, v127, v126, s38
    v_accvgpr_write_b32 a157, v9
    s_add_u32 m0, s48, 18432
    s_mov_b32 s46, 0x388000
    buffer_load_dwordx4 v4, s[16:19], s46 offen lds
    v_perm_b32 v8, v129, v128, s37
    v_accvgpr_write_b32 a146, v8
    v_perm_b32 v9, v129, v128, s38
    v_accvgpr_write_b32 a150, v9
    v_perm_b32 v8, v131, v130, s37
    v_accvgpr_write_b32 a154, v8
    v_perm_b32 v9, v131, v130, s38
    v_accvgpr_write_b32 a158, v9
    s_add_u32 m0, s48, 19456
    s_mov_b32 s46, 0x38c000
    buffer_load_dwordx4 v4, s[16:19], s46 offen lds
    v_perm_b32 v8, v133, v132, s37
    v_accvgpr_write_b32 a147, v8
    v_perm_b32 v9, v133, v132, s38
    v_accvgpr_write_b32 a151, v9
    v_perm_b32 v8, v135, v134, s37
    v_accvgpr_write_b32 a155, v8
    v_perm_b32 v9, v135, v134, s38
    v_accvgpr_write_b32 a159, v9
    s_waitcnt vmcnt(12) lgkmcnt(0)
    ds_read2st64_b32 v[120:121], v6 offset0:16 offset1:18
    ds_read2st64_b32 v[122:123], v7 offset0:16 offset1:18
    ds_read2st64_b32 v[124:125], v6 offset0:20 offset1:22
    ds_read2st64_b32 v[126:127], v7 offset0:20 offset1:22
    ds_read2st64_b32 v[128:129], v6 offset0:24 offset1:26
    ds_read2st64_b32 v[130:131], v7 offset0:24 offset1:26
    ds_read2st64_b32 v[132:133], v6 offset0:28 offset1:30
    ds_read2st64_b32 v[134:135], v7 offset0:28 offset1:30
    s_add_u32 m0, s48, 0
    s_mov_b32 s46, 0x3c0000
    buffer_load_dwordx4 v4, s[16:19], s46 offen lds
    v_perm_b32 v8, v105, v104, s37
    v_accvgpr_write_b32 a160, v8
    v_perm_b32 v9, v105, v104, s38
    v_accvgpr_write_b32 a164, v9
    v_perm_b32 v8, v107, v106, s37
    v_accvgpr_write_b32 a168, v8
    v_perm_b32 v9, v107, v106, s38
    v_accvgpr_write_b32 a172, v9
    s_add_u32 m0, s48, 1024
    s_mov_b32 s46, 0x3c4000
    buffer_load_dwordx4 v4, s[16:19], s46 offen lds
    v_perm_b32 v8, v109, v108, s37
    v_accvgpr_write_b32 a161, v8
    v_perm_b32 v9, v109, v108, s38
    v_accvgpr_write_b32 a165, v9
    v_perm_b32 v8, v111, v110, s37
    v_accvgpr_write_b32 a169, v8
    v_perm_b32 v9, v111, v110, s38
    v_accvgpr_write_b32 a173, v9
    s_add_u32 m0, s48, 2048
    s_mov_b32 s46, 0x3c8000
    buffer_load_dwordx4 v4, s[16:19], s46 offen lds
    v_perm_b32 v8, v113, v112, s37
    v_accvgpr_write_b32 a162, v8
    v_perm_b32 v9, v113, v112, s38
    v_accvgpr_write_b32 a166, v9
    v_perm_b32 v8, v115, v114, s37
    v_accvgpr_write_b32 a170, v8
    v_perm_b32 v9, v115, v114, s38
    v_accvgpr_write_b32 a174, v9
    s_add_u32 m0, s48, 3072
    s_mov_b32 s46, 0x3cc000
    buffer_load_dwordx4 v4, s[16:19], s46 offen lds
    v_perm_b32 v8, v117, v116, s37
    v_accvgpr_write_b32 a163, v8
    v_perm_b32 v9, v117, v116, s38
    v_accvgpr_write_b32 a167, v9
    v_perm_b32 v8, v119, v118, s37
    v_accvgpr_write_b32 a171, v8
    v_perm_b32 v9, v119, v118, s38
    v_accvgpr_write_b32 a175, v9
    s_waitcnt vmcnt(12) lgkmcnt(0)
    ds_read2st64_b32 v[104:105], v6 offset0:32 offset1:34
    ds_read2st64_b32 v[106:107], v7 offset0:32 offset1:34
    ds_read2st64_b32 v[108:109], v6 offset0:36 offset1:38
    ds_read2st64_b32 v[110:111], v7 offset0:36 offset1:38
    ds_read2st64_b32 v[112:113], v6 offset0:40 offset1:42
    ds_read2st64_b32 v[114:115], v7 offset0:40 offset1:42
    ds_read2st64_b32 v[116:117], v6 offset0:44 offset1:46
    ds_read2st64_b32 v[118:119], v7 offset0:44 offset1:46
    v_perm_b32 v8, v121, v120, s37
    v_accvgpr_write_b32 a176, v8
    v_perm_b32 v9, v121, v120, s38
    v_accvgpr_write_b32 a180, v9
    v_perm_b32 v8, v123, v122, s37
    v_accvgpr_write_b32 a184, v8
    v_perm_b32 v9, v123, v122, s38
    v_accvgpr_write_b32 a188, v9
    v_perm_b32 v8, v125, v124, s37
    v_accvgpr_write_b32 a177, v8
    v_perm_b32 v9, v125, v124, s38
    v_accvgpr_write_b32 a181, v9
    v_perm_b32 v8, v127, v126, s37
    v_accvgpr_write_b32 a185, v8
    v_perm_b32 v9, v127, v126, s38
    v_accvgpr_write_b32 a189, v9
    v_perm_b32 v8, v129, v128, s37
    v_accvgpr_write_b32 a178, v8
    v_perm_b32 v9, v129, v128, s38
    v_accvgpr_write_b32 a182, v9
    v_perm_b32 v8, v131, v130, s37
    v_accvgpr_write_b32 a186, v8
    v_perm_b32 v9, v131, v130, s38
    v_accvgpr_write_b32 a190, v9
    v_perm_b32 v8, v133, v132, s37
    v_accvgpr_write_b32 a179, v8
    v_perm_b32 v9, v133, v132, s38
    v_accvgpr_write_b32 a183, v9
    v_perm_b32 v8, v135, v134, s37
    v_accvgpr_write_b32 a187, v8
    v_perm_b32 v9, v135, v134, s38
    v_accvgpr_write_b32 a191, v9
    s_waitcnt vmcnt(8) lgkmcnt(0)
    ds_read2st64_b32 v[120:121], v6 offset0:48 offset1:50
    ds_read2st64_b32 v[122:123], v7 offset0:48 offset1:50
    ds_read2st64_b32 v[124:125], v6 offset0:52 offset1:54
    ds_read2st64_b32 v[126:127], v7 offset0:52 offset1:54
    ds_read2st64_b32 v[128:129], v6 offset0:56 offset1:58
    ds_read2st64_b32 v[130:131], v7 offset0:56 offset1:58
    ds_read2st64_b32 v[132:133], v6 offset0:60 offset1:62
    ds_read2st64_b32 v[134:135], v7 offset0:60 offset1:62
    v_perm_b32 v8, v105, v104, s37
    v_accvgpr_write_b32 a192, v8
    v_perm_b32 v9, v105, v104, s38
    v_accvgpr_write_b32 a196, v9
    v_perm_b32 v8, v107, v106, s37
    v_accvgpr_write_b32 a200, v8
    v_perm_b32 v9, v107, v106, s38
    v_accvgpr_write_b32 a204, v9
    v_perm_b32 v8, v109, v108, s37
    v_accvgpr_write_b32 a193, v8
    v_perm_b32 v9, v109, v108, s38
    v_accvgpr_write_b32 a197, v9
    v_perm_b32 v8, v111, v110, s37
    v_accvgpr_write_b32 a201, v8
    v_perm_b32 v9, v111, v110, s38
    v_accvgpr_write_b32 a205, v9
    v_perm_b32 v8, v113, v112, s37
    v_accvgpr_write_b32 a194, v8
    v_perm_b32 v9, v113, v112, s38
    v_accvgpr_write_b32 a198, v9
    v_perm_b32 v8, v115, v114, s37
    v_accvgpr_write_b32 a202, v8
    v_perm_b32 v9, v115, v114, s38
    v_accvgpr_write_b32 a206, v9
    v_perm_b32 v8, v117, v116, s37
    v_accvgpr_write_b32 a195, v8
    v_perm_b32 v9, v117, v116, s38
    v_accvgpr_write_b32 a199, v9
    v_perm_b32 v8, v119, v118, s37
    v_accvgpr_write_b32 a203, v8
    v_perm_b32 v9, v119, v118, s38
    v_accvgpr_write_b32 a207, v9
    s_waitcnt vmcnt(4) lgkmcnt(0)
    ds_read2st64_b32 v[104:105], v6 offset0:64 offset1:66
    ds_read2st64_b32 v[106:107], v7 offset0:64 offset1:66
    ds_read2st64_b32 v[108:109], v6 offset0:68 offset1:70
    ds_read2st64_b32 v[110:111], v7 offset0:68 offset1:70
    ds_read2st64_b32 v[112:113], v6 offset0:72 offset1:74
    ds_read2st64_b32 v[114:115], v7 offset0:72 offset1:74
    ds_read2st64_b32 v[116:117], v6 offset0:76 offset1:78
    ds_read2st64_b32 v[118:119], v7 offset0:76 offset1:78
    v_perm_b32 v8, v121, v120, s37
    v_accvgpr_write_b32 a208, v8
    v_perm_b32 v9, v121, v120, s38
    v_accvgpr_write_b32 a212, v9
    v_perm_b32 v8, v123, v122, s37
    v_accvgpr_write_b32 a216, v8
    v_perm_b32 v9, v123, v122, s38
    v_accvgpr_write_b32 a220, v9
    v_perm_b32 v8, v125, v124, s37
    v_accvgpr_write_b32 a209, v8
    v_perm_b32 v9, v125, v124, s38
    v_accvgpr_write_b32 a213, v9
    v_perm_b32 v8, v127, v126, s37
    v_accvgpr_write_b32 a217, v8
    v_perm_b32 v9, v127, v126, s38
    v_accvgpr_write_b32 a221, v9
    v_perm_b32 v8, v129, v128, s37
    v_accvgpr_write_b32 a210, v8
    v_perm_b32 v9, v129, v128, s38
    v_accvgpr_write_b32 a214, v9
    v_perm_b32 v8, v131, v130, s37
    v_accvgpr_write_b32 a218, v8
    v_perm_b32 v9, v131, v130, s38
    v_accvgpr_write_b32 a222, v9
    v_perm_b32 v8, v133, v132, s37
    v_accvgpr_write_b32 a211, v8
    v_perm_b32 v9, v133, v132, s38
    v_accvgpr_write_b32 a215, v9
    v_perm_b32 v8, v135, v134, s37
    v_accvgpr_write_b32 a219, v8
    v_perm_b32 v9, v135, v134, s38
    v_accvgpr_write_b32 a223, v9
    s_waitcnt vmcnt(0) lgkmcnt(0)
    ds_read2st64_b32 v[120:121], v6 offset0:0 offset1:2
    ds_read2st64_b32 v[122:123], v7 offset0:0 offset1:2
    ds_read2st64_b32 v[124:125], v6 offset0:4 offset1:6
    ds_read2st64_b32 v[126:127], v7 offset0:4 offset1:6
    ds_read2st64_b32 v[128:129], v6 offset0:8 offset1:10
    ds_read2st64_b32 v[130:131], v7 offset0:8 offset1:10
    ds_read2st64_b32 v[132:133], v6 offset0:12 offset1:14
    ds_read2st64_b32 v[134:135], v7 offset0:12 offset1:14
    v_perm_b32 v8, v105, v104, s37
    v_accvgpr_write_b32 a224, v8
    v_perm_b32 v9, v105, v104, s38
    v_accvgpr_write_b32 a228, v9
    v_perm_b32 v8, v107, v106, s37
    v_accvgpr_write_b32 a232, v8
    v_perm_b32 v9, v107, v106, s38
    v_accvgpr_write_b32 a236, v9
    v_perm_b32 v8, v109, v108, s37
    v_accvgpr_write_b32 a225, v8
    v_perm_b32 v9, v109, v108, s38
    v_accvgpr_write_b32 a229, v9
    v_perm_b32 v8, v111, v110, s37
    v_accvgpr_write_b32 a233, v8
    v_perm_b32 v9, v111, v110, s38
    v_accvgpr_write_b32 a237, v9
    v_perm_b32 v8, v113, v112, s37
    v_accvgpr_write_b32 a226, v8
    v_perm_b32 v9, v113, v112, s38
    v_accvgpr_write_b32 a230, v9
    v_perm_b32 v8, v115, v114, s37
    v_accvgpr_write_b32 a234, v8
    v_perm_b32 v9, v115, v114, s38
    v_accvgpr_write_b32 a238, v9
    v_perm_b32 v8, v117, v116, s37
    v_accvgpr_write_b32 a227, v8
    v_perm_b32 v9, v117, v116, s38
    v_accvgpr_write_b32 a231, v9
    v_perm_b32 v8, v119, v118, s37
    v_accvgpr_write_b32 a235, v8
    v_perm_b32 v9, v119, v118, s38
    v_accvgpr_write_b32 a239, v9
    s_waitcnt vmcnt(0) lgkmcnt(0)
    v_perm_b32 v8, v121, v120, s37
    v_accvgpr_write_b32 a240, v8
    v_perm_b32 v9, v121, v120, s38
    v_accvgpr_write_b32 a244, v9
    v_perm_b32 v8, v123, v122, s37
    v_accvgpr_write_b32 a248, v8
    v_perm_b32 v9, v123, v122, s38
    v_accvgpr_write_b32 a252, v9
    v_perm_b32 v8, v125, v124, s37
    v_accvgpr_write_b32 a241, v8
    v_perm_b32 v9, v125, v124, s38
    v_accvgpr_write_b32 a245, v9
    v_perm_b32 v8, v127, v126, s37
    v_accvgpr_write_b32 a249, v8
    v_perm_b32 v9, v127, v126, s38
    v_accvgpr_write_b32 a253, v9
    v_perm_b32 v8, v129, v128, s37
    v_accvgpr_write_b32 a242, v8
    v_perm_b32 v9, v129, v128, s38
    v_accvgpr_write_b32 a246, v9
    v_perm_b32 v8, v131, v130, s37
    v_accvgpr_write_b32 a250, v8
    v_perm_b32 v9, v131, v130, s38
    v_accvgpr_write_b32 a254, v9
    v_perm_b32 v8, v133, v132, s37
    v_accvgpr_write_b32 a243, v8
    v_perm_b32 v9, v133, v132, s38
    v_accvgpr_write_b32 a247, v9
    v_perm_b32 v8, v135, v134, s37
    v_accvgpr_write_b32 a251, v8
    v_perm_b32 v9, v135, v134, s38
    v_accvgpr_write_b32 a255, v9
    s_barrier
    s_mov_b32 s42, 33792
    s_lshl_b32 s44, s50, 15
    s_lshl_b32 s45, s4, 13
    s_add_u32 s44, s44, s45
    s_add_u32 s45, s42, s49
    s_add_u32 m0, s45, 0
    s_nop 0
    buffer_load_dwordx4 v0, s[24:27], s44 offen lds
    s_add_u32 m0, s45, 1056
    s_add_u32 s44, s44, 1024
    buffer_load_dwordx4 v0, s[24:27], s44 offen lds
    s_add_u32 m0, s45, 2112
    s_add_u32 s44, s44, 1024
    buffer_load_dwordx4 v0, s[24:27], s44 offen lds
    s_add_u32 m0, s45, 3168
    s_add_u32 s44, s44, 1024
    buffer_load_dwordx4 v0, s[24:27], s44 offen lds
    s_add_u32 m0, s45, 4224
    s_add_u32 s44, s44, 1024
    buffer_load_dwordx4 v0, s[24:27], s44 offen lds
    s_add_u32 m0, s45, 5280
    s_add_u32 s44, s44, 1024
    buffer_load_dwordx4 v0, s[24:27], s44 offen lds
    s_add_u32 m0, s45, 6336
    s_add_u32 s44, s44, 1024
    buffer_load_dwordx4 v0, s[24:27], s44 offen lds
    s_add_u32 m0, s45, 7392
    s_add_u32 s44, s44, 1024
    buffer_load_dwordx4 v0, s[24:27], s44 offen lds
    s_add_u32 s50, s50, s41
    s_mov_b32 s42, 67584
    s_lshl_b32 s44, s50, 15
    s_lshl_b32 s45, s4, 13
    s_add_u32 s44, s44, s45
    s_add_u32 s45, s42, s49
    s_add_u32 m0, s45, 0
    s_nop 0
    buffer_load_dwordx4 v0, s[24:27], s44 offen lds
    s_add_u32 m0, s45, 1056
    s_add_u32 s44, s44, 1024
    buffer_load_dwordx4 v0, s[24:27], s44 offen lds
    s_add_u32 m0, s45, 2112
    s_add_u32 s44, s44, 1024
    buffer_load_dwordx4 v0, s[24:27], s44 offen lds
    s_add_u32 m0, s45, 3168
    s_add_u32 s44, s44, 1024
    buffer_load_dwordx4 v0, s[24:27], s44 offen lds
    s_add_u32 m0, s45, 4224
    s_add_u32 s44, s44, 1024
    buffer_load_dwordx4 v0, s[24:27], s44 offen lds
    s_add_u32 m0, s45, 5280
    s_add_u32 s44, s44, 1024
    buffer_load_dwordx4 v0, s[24:27], s44 offen lds
    s_add_u32 m0, s45, 6336
    s_add_u32 s44, s44, 1024
    buffer_load_dwordx4 v0, s[24:27], s44 offen lds
    s_add_u32 m0, s45, 7392
    s_add_u32 s44, s44, 1024
    buffer_load_dwordx4 v0, s[24:27], s44 offen lds
    s_add_u32 s50, s50, s41
    s_mov_b32 s42, 0
    s_branch GK_in
GK_loop:
    s_cmp_lg_u32 s57, s54
    s_cbranch_scc1 GK_nd
    s_waitcnt vmcnt(0)
    s_cmp_lg_u32 s4, 0
    s_cbranch_scc1 W_rdy1_e
    v_mov_b32 v8, 128
    s_mov_b32 s60, 0
W_rdy1:
    s_sleep 4
    buffer_load_dword v9, v8, s[12:15], 0 offen sc1
    s_waitcnt vmcnt(0)
    v_readfirstlane_b32 s63, v9
    s_add_u32 s60, s60, 1
    s_cmp_ge_u32 s60, 3000000
    s_cbranch_scc1 L_fail
    s_cmp_lt_u32 s63, 256
    s_cbranch_scc1 W_rdy1
W_rdy1_e:
GK_nd:
    s_waitcnt vmcnt(15)
    s_barrier
    s_sub_u32 s59, s57, 1
    s_min_i32 s44, s57, 1
    s_max_i32 s59, s59, s44
    v_mov_b32 v8, s59
    buffer_store_dword v8, off, s[8:11], s56 sc1
GK_in:
    s_add_u32 s57, s57, 1
    v_add_u32 v72, s42, v3
    ds_read_b128 v[48:51], v72 offset:0
    ds_read_b128 v[52:55], v72 offset:16896
    ds_read_b128 v[56:59], v72 offset:64
    ds_read_b128 v[60:63], v72 offset:16960
    s_add_u32 s46, s42, 101376
    s_cmp_ge_u32 s46, 135168
    s_cselect_b32 s48, 135168, 0
    s_sub_u32 s46, s46, s48
    s_lshl_b32 s44, s50, 15
    s_lshl_b32 s45, s4, 13
    s_add_u32 s44, s44, s45
    s_add_u32 s45, s46, s49
    s_add_u32 s50, s50, s41
    s_waitcnt lgkmcnt(3)
    v_mfma_f32_16x16x32_bf16 v[16:19], a[0:3], v[48:51], 0
    v_mfma_f32_16x16x32_bf16 v[20:23], a[4:7], v[48:51], 0
    ds_read_b128 v[64:67], v72 offset:128
    v_mfma_f32_16x16x32_bf16 v[24:27], a[8:11], v[48:51], 0
    v_mfma_f32_16x16x32_bf16 v[28:31], a[12:15], v[48:51], 0
    ds_read_b128 v[68:71], v72 offset:17024
    s_waitcnt lgkmcnt(4)
    v_mfma_f32_16x16x32_bf16 v[32:35], a[0:3], v[52:55], 0
    v_mfma_f32_16x16x32_bf16 v[36:39], a[4:7], v[52:55], 0
    v_mfma_f32_16x16x32_bf16 v[40:43], a[8:11], v[52:55], 0
    v_mfma_f32_16x16x32_bf16 v[44:47], a[12:15], v[52:55], 0
    s_waitcnt lgkmcnt(3)
    v_mfma_f32_16x16x32_bf16 v[16:19], a[16:19], v[56:59], v[16:19]
    v_mfma_f32_16x16x32_bf16 v[20:23], a[20:23], v[56:59], v[20:23]
    ds_read_b128 v[48:51], v72 offset:192
    v_mfma_f32_16x16x32_bf16 v[24:27], a[24:27], v[56:59], v[24:27]
    v_mfma_f32_16x16x32_bf16 v[28:31], a[28:31], v[56:59], v[28:31]
    ds_read_b128 v[52:55], v72 offset:17088
    s_waitcnt lgkmcnt(4)
    v_mfma_f32_16x16x32_bf16 v[32:35], a[16:19], v[60:63], v[32:35]
    v_mfma_f32_16x16x32_bf16 v[36:39], a[20:23], v[60:63], v[36:39]
    s_add_u32 m0, s45, 0
    v_mfma_f32_16x16x32_bf16 v[40:43], a[24:27], v[60:63], v[40:43]
    buffer_load_dwordx4 v0, s[24:27], s44 offen lds
    v_mfma_f32_16x16x32_bf16 v[44:47], a[28:31], v[60:63], v[44:47]
    s_waitcnt lgkmcnt(3)
    v_mfma_f32_16x16x32_bf16 v[16:19], a[32:35], v[64:67], v[16:19]
    v_mfma_f32_16x16x32_bf16 v[20:23], a[36:39], v[64:67], v[20:23]
    ds_read_b128 v[56:59], v72 offset:256
    v_mfma_f32_16x16x32_bf16 v[24:27], a[40:43], v[64:67], v[24:27]
    v_mfma_f32_16x16x32_bf16 v[28:31], a[44:47], v[64:67], v[28:31]
    ds_read_b128 v[60:63], v72 offset:17152
    s_waitcnt lgkmcnt(4)
    v_mfma_f32_16x16x32_bf16 v[32:35], a[32:35], v[68:71], v[32:35]
    v_mfma_f32_16x16x32_bf16 v[36:39], a[36:39], v[68:71], v[36:39]
    s_add_u32 m0, s45, 1056
    s_add_u32 s44, s44, 1024
    v_mfma_f32_16x16x32_bf16 v[40:43], a[40:43], v[68:71], v[40:43]
    buffer_load_dwordx4 v0, s[24:27], s44 offen lds
    v_mfma_f32_16x16x32_bf16 v[44:47], a[44:47], v[68:71], v[44:47]
    s_waitcnt lgkmcnt(3)
    v_mfma_f32_16x16x32_bf16 v[16:19], a[48:51], v[48:51], v[16:19]
    v_mfma_f32_16x16x32_bf16 v[20:23], a[52:55], v[48:51], v[20:23]
    ds_read_b128 v[64:67], v72 offset:320
    v_mfma_f32_16x16x32_bf16 v[24:27], a[56:59], v[48:51], v[24:27]
    v_mfma_f32_16x16x32_bf16 v[28:31], a[60:63], v[48:51], v[28:31]
    ds_read_b128 v[68:71], v72 offset:17216
    s_waitcnt lgkmcnt(4)
    v_mfma_f32_16x16x32_bf16 v[32:35], a[48:51], v[52:55], v[32:35]
    v_mfma_f32_16x16x32_bf16 v[36:39], a[52:55], v[52:55], v[36:39]
    s_add_u32 m0, s45, 2112
    s_add_u32 s44, s44, 1024
    v_mfma_f32_16x16x32_bf16 v[40:43], a[56:59], v[52:55], v[40:43]
    buffer_load_dwordx4 v0, s[24:27], s44 offen lds
    v_mfma_f32_16x16x32_bf16 v[44:47], a[60:63], v[52:55], v[44:47]
    s_waitcnt lgkmcnt(3)
    v_mfma_f32_16x16x32_bf16 v[16:19], a[64:67], v[56:59], v[16:19]
    v_mfma_f32_16x16x32_bf16 v[20:23], a[68:71], v[56:59], v[20:23]
    ds_read_b128 v[48:51], v72 offset:384
    v_mfma_f32_16x16x32_bf16 v[24:27], a[72:75], v[56:59], v[24:27]
    v_mfma_f32_16x16x32_bf16 v[28:31], a[76:79], v[56:59], v[28:31]
    ds_read_b128 v[52:55], v72 offset:17280
    s_waitcnt lgkmcnt(4)
    v_mfma_f32_16x16x32_bf16 v[32:35], a[64:67], v[60:63], v[32:35]
    v_mfma_f32_16x16x32_bf16 v[36:39], a[68:71], v[60:63], v[36:39]
    s_add_u32 m0, s45, 3168
    s_add_u32 s44, s44, 1024
    v_mfma_f32_16x16x32_bf16 v[40:43], a[72:75], v[60:63], v[40:43]
    buffer_load_dwordx4 v0, s[24:27], s44 offen lds
    v_mfma_f32_16x16x32_bf16 v[44:47], a[76:79], v[60:63], v[44:47]
    s_waitcnt lgkmcnt(3)
    v_mfma_f32_16x16x32_bf16 v[16:19], a[80:83], v[64:67], v[16:19]
    v_mfma_f32_16x16x32_bf16 v[20:23], a[84:87], v[64:67], v[20:23]
    ds_read_b128 v[56:59], v72 offset:448
    v_mfma_f32_16x16x32_bf16 v[24:27], a[88:91], v[64:67], v[24:27]
    v_mfma_f32_16x16x32_bf16 v[28:31], a[92:95], v[64:67], v[28:31]
    ds_read_b128 v[60:63], v72 offset:17344
    s_waitcnt lgkmcnt(4)
    v_mfma_f32_16x16x32_bf16 v[32:35], a[80:83], v[68:71], v[32:35]
    v_mfma_f32_16x16x32_bf16 v[36:39], a[84:87], v[68:71], v[36:39]
    s_add_u32 m0, s45, 4224
    s_add_u32 s44, s44, 1024
    v_mfma_f32_16x16x32_bf16 v[40:43], a[88:91], v[68:71], v[40:43]
    buffer_load_dwordx4 v0, s[24:27], s44 offen lds
    v_mfma_f32_16x16x32_bf16 v[44:47], a[92:95], v[68:71], v[44:47]
    s_waitcnt lgkmcnt(3)
    v_mfma_f32_16x16x32_bf16 v[16:19], a[96:99], v[48:51], v[16:19]
    v_mfma_f32_16x16x32_bf16 v[20:23], a[100:103], v[48:51], v[20:23]
    ds_read_b128 v[64:67], v72 offset:512
    v_mfma_f32_16x16x32_bf16 v[24:27], a[104:107], v[48:51], v[24:27]
    v_mfma_f32_16x16x32_bf16 v[28:31], a[108:111], v[48:51], v[28:31]
    ds_read_b128 v[68:71], v72 offset:17408
    s_waitcnt lgkmcnt(4)
    v_mfma_f32_16x16x32_bf16 v[32:35], a[96:99], v[52:55], v[32:35]
    v_mfma_f32_16x16x32_bf16 v[36:39], a[100:103], v[52:55], v[36:39]
    s_add_u32 m0, s45, 5280
    s_add_u32 s44, s44, 1024
    v_mfma_f32_16x16x32_bf16 v[40:43], a[104:107], v[52:55], v[40:43]
    buffer_load_dwordx4 v0, s[24:27], s44 offen lds
    v_mfma_f32_16x16x32_bf16 v[44:47], a[108:111], v[52:55], v[44:47]
    s_waitcnt lgkmcnt(3)
    v_mfma_f32_16x16x32_bf16 v[16:19], a[112:115], v[56:59], v[16:19]
    v_mfma_f32_16x16x32_bf16 v[20:23], a[116:119], v[56:59], v[20:23]
    ds_read_b128 v[48:51], v72 offset:576
    v_mfma_f32_16x16x32_bf16 v[24:27], a[120:123], v[56:59], v[24:27]
    v_mfma_f32_16x16x32_bf16 v[28:31], a[124:127], v[56:59], v[28:31]
    ds_read_b128 v[52:55], v72 offset:17472
    s_waitcnt lgkmcnt(4)
    v_mfma_f32_16x16x32_bf16 v[32:35], a[112:115], v[60:63], v[32:35]
    v_mfma_f32_16x16x32_bf16 v[36:39], a[116:119], v[60:63], v[36:39]
    s_add_u32 m0, s45, 6336
    s_add_u32 s44, s44, 1024
    v_mfma_f32_16x16x32_bf16 v[40:43], a[120:123], v[60:63], v[40:43]
    buffer_load_dwordx4 v0, s[24:27], s44 offen lds
    v_mfma_f32_16x16x32_bf16 v[44:47], a[124:127], v[60:63], v[44:47]
    s_waitcnt lgkmcnt(3)
    v_mfma_f32_16x16x32_bf16 v[16:19], a[128:131], v[64:67], v[16:19]
    v_mfma_f32_16x16x32_bf16 v[20:23], a[132:135], v[64:67], v[20:23]
    ds_read_b128 v[56:59], v72 offset:640
    v_mfma_f32_16x16x32_bf16 v[24:27], a[136:139], v[64:67], v[24:27]
    v_mfma_f32_16x16x32_bf16 v[28:31], a[140:143], v[64:67], v[28:31]
    ds_read_b128 v[60:63], v72 offset:17536
    s_waitcnt lgkmcnt(4)
    v_mfma_f32_16x16x32_bf16 v[32:35], a[128:131], v[68:71], v[32:35]
    v_mfma_f32_16x16x32_bf16 v[36:39], a[132:135], v[68:71], v[36:39]
    s_add_u32 m0, s45, 7392
    s_add_u32 s44, s44, 1024
    v_mfma_f32_16x16x32_bf16 v[40:43], a[136:139], v[68:71], v[40:43]
    buffer_load_dwordx4 v0, s[24:27], s44 offen lds
    v_mfma_f32_16x16x32_bf16 v[44:47], a[140:143], v[68:71], v[44:47]
    s_waitcnt lgkmcnt(3)
    v_mfma_f32_16x16x32_bf16 v[16:19], a[144:147], v[48:51], v[16:19]
    v_mfma_f32_16x16x32_bf16 v[20:23], a[148:151], v[48:51], v[20:23]
    ds_read_b128 v[64:67], v72 offset:704
    v_mfma_f32_16x16x32_bf16 v[24:27], a[152:155], v[48:51], v[24:27]
    v_mfma_f32_16x16x32_bf16 v[28:31], a[156:159], v[48:51], v[28:31]
    ds_read_b128 v[68:71], v72 offset:17600
    s_waitcnt lgkmcnt(4)
    v_mfma_f32_16x16x32_bf16 v[32:35], a[144:147], v[52:55], v[32:35]
    v_mfma_f32_16x16x32_bf16 v[36:39], a[148:151], v[52:55], v[36:39]
    v_mfma_f32_16x16x32_bf16 v[40:43], a[152:155], v[52:55], v[40:43]
    v_mfma_f32_16x16x32_bf16 v[44:47], a[156:159], v[52:55], v[44:47]
    s_waitcnt lgkmcnt(3)
    v_mfma_f32_16x16x32_bf16 v[16:19], a[160:163], v[56:59], v[16:19]
    v_mfma_f32_16x16x32_bf16 v[20:23], a[164:167], v[56:59], v[20:23]
    ds_read_b128 v[48:51], v72 offset:768
    v_mfma_f32_16x16x32_bf16 v[24:27], a[168:171], v[56:59], v[24:27]
    v_mfma_f32_16x16x32_bf16 v[28:31], a[172:175], v[56:59], v[28:31]
    ds_read_b128 v[52:55], v72 offset:17664
    s_waitcnt lgkmcnt(4)
    v_mfma_f32_16x16x32_bf16 v[32:35], a[160:163], v[60:63], v[32:35]
    v_mfma_f32_16x16x32_bf16 v[36:39], a[164:167], v[60:63], v[36:39]
    v_mfma_f32_16x16x32_bf16 v[40:43], a[168:171], v[60:63], v[40:43]
    v_mfma_f32_16x16x32_bf16 v[44:47], a[172:175], v[60:63], v[44:47]
    s_waitcnt lgkmcnt(3)
    v_mfma_f32_16x16x32_bf16 v[16:19], a[176:179], v[64:67], v[16:19]
    v_mfma_f32_16x16x32_bf16 v[20:23], a[180:183], v[64:67], v[20:23]
    ds_read_b128 v[56:59], v72 offset:832
    v_mfma_f32_16x16x32_bf16 v[24:27], a[184:187], v[64:67], v[24:27]
    v_mfma_f32_16x16x32_bf16 v[28:31], a[188:191], v[64:67], v[28:31]
    ds_read_b128 v[60:63], v72 offset:17728
    s_waitcnt lgkmcnt(4)
    v_mfma_f32_16x16x32_bf16 v[32:35], a[176:179], v[68:71], v[32:35]
    v_mfma_f32_16x16x32_bf16 v[36:39], a[180:183], v[68:71], v[36:39]
    v_mfma_f32_16x16x32_bf16 v[40:43], a[184:187], v[68:71], v[40:43]
    v_mfma_f32_16x16x32_bf16 v[44:47], a[188:191], v[68:71], v[44:47]
    s_waitcnt lgkmcnt(3)
    v_mfma_f32_16x16x32_bf16 v[16:19], a[192:195], v[48:51], v[16:19]
    v_mfma_f32_16x16x32_bf16 v[20:23], a[196:199], v[48:51], v[20:23]
    ds_read_b128 v[64:67], v72 offset:896
    v_mfma_f32_16x16x32_bf16 v[24:27], a[200:203], v[48:51], v[24:27]
    v_mfma_f32_16x16x32_bf16 v[28:31], a[204:207], v[48:51], v[28:31]
    ds_read_b128 v[68:71], v72 offset:17792
    s_waitcnt lgkmcnt(4)
    v_mfma_f32_16x16x32_bf16 v[32:35], a[192:195], v[52:55], v[32:35]
    v_mfma_f32_16x16x32_bf16 v[36:39], a[196:199], v[52:55], v[36:39]
    v_mfma_f32_16x16x32_bf16 v[40:43], a[200:203], v[52:55], v[40:43]
    v_mfma_f32_16x16x32_bf16 v[44:47], a[204:207], v[52:55], v[44:47]
    s_waitcnt lgkmcnt(3)
    v_mfma_f32_16x16x32_bf16 v[16:19], a[208:211], v[56:59], v[16:19]
    v_mfma_f32_16x16x32_bf16 v[20:23], a[212:215], v[56:59], v[20:23]
    ds_read_b128 v[48:51], v72 offset:960
    v_mfma_f32_16x16x32_bf16 v[24:27], a[216:219], v[56:59], v[24:27]
    v_mfma_f32_16x16x32_bf16 v[28:31], a[220:223], v[56:59], v[28:31]
    ds_read_b128 v[52:55], v72 offset:17856
    s_waitcnt lgkmcnt(4)
    v_mfma_f32_16x16x32_bf16 v[32:35], a[208:211], v[60:63], v[32:35]
    v_mfma_f32_16x16x32_bf16 v[36:39], a[212:215], v[60:63], v[36:39]
    v_mfma_f32_16x16x32_bf16 v[40:43], a[216:219], v[60:63], v[40:43]
    v_mfma_f32_16x16x32_bf16 v[44:47], a[220:223], v[60:63], v[44:47]
    s_waitcnt lgkmcnt(3)
    v_mfma_f32_16x16x32_bf16 v[16:19], a[224:227], v[64:67], v[16:19]
    v_mfma_f32_16x16x32_bf16 v[20:23], a[228:231], v[64:67], v[20:23]
    v_mfma_f32_16x16x32_bf16 v[24:27], a[232:235], v[64:67], v[24:27]
    v_mfma_f32_16x16x32_bf16 v[28:31], a[236:239], v[64:67], v[28:31]
    s_waitcnt lgkmcnt(2)
    v_mfma_f32_16x16x32_bf16 v[32:35], a[224:227], v[68:71], v[32:35]
    v_mfma_f32_16x16x32_bf16 v[36:39], a[228:231], v[68:71], v[36:39]
    v_mfma_f32_16x16x32_bf16 v[40:43], a[232:235], v[68:71], v[40:43]
    v_mfma_f32_16x16x32_bf16 v[44:47], a[236:239], v[68:71], v[44:47]
    s_waitcnt lgkmcnt(1)
    v_mfma_f32_16x16x32_bf16 v[16:19], a[240:243], v[48:51], v[16:19]
    v_mfma_f32_16x16x32_bf16 v[20:23], a[244:247], v[48:51], v[20:23]
    v_mfma_f32_16x16x32_bf16 v[24:27], a[248:251], v[48:51], v[24:27]
    v_mfma_f32_16x16x32_bf16 v[28:31], a[252:255], v[48:51], v[28:31]
    s_waitcnt lgkmcnt(0)
    v_mfma_f32_16x16x32_bf16 v[32:35], a[240:243], v[52:55], v[32:35]
    v_mfma_f32_16x16x32_bf16 v[36:39], a[244:247], v[52:55], v[36:39]
    v_mfma_f32_16x16x32_bf16 v[40:43], a[248:251], v[52:55], v[40:43]
    v_mfma_f32_16x16x32_bf16 v[44:47], a[252:255], v[52:55], v[44:47]
    s_cmp_lg_u32 s57, s98
    s_cbranch_scc1 GK_np
    s_load_dwordx2 s[20:21], s[0:1], 80
    s_mov_b32 s22, 0x158000
    s_mov_b32 s23, 0x20000
    s_and_b32 s44, s6, 15
    s_lshl_b32 s44, s44, 6
    v_lshlrev_b32 v4, 13, v2
    v_lshl_add_u32 v4, v1, 2, v4
    v_add_u32 v4, s44, v4
    v_add_u32 v5, 1024, v4
    s_mul_i32 s45, s4, 0x58000
    s_waitcnt lgkmcnt(0)
    s_add_u32 s46, s45, 0x0
    buffer_load_dword v104, v4, s[20:23], s46 offen
    buffer_load_dword v105, v5, s[20:23], s46 offen
    s_add_u32 s46, s45, 0x800
    buffer_load_dword v106, v4, s[20:23], s46 offen
    buffer_load_dword v107, v5, s[20:23], s46 offen
    s_add_u32 s46, s45, 0x1000
    buffer_load_dword v108, v4, s[20:23], s46 offen
    buffer_load_dword v109, v5, s[20:23], s46 offen
    s_add_u32 s46, s45, 0x1800
    buffer_load_dword v110, v4, s[20:23], s46 offen
    buffer_load_dword v111, v5, s[20:23], s46 offen
    s_add_u32 s46, s45, 0x8000
    buffer_load_dword v112, v4, s[20:23], s46 offen
    buffer_load_dword v113, v5, s[20:23], s46 offen
    s_add_u32 s46, s45, 0x8800
    buffer_load_dword v114, v4, s[20:23], s46 offen
    buffer_load_dword v115, v5, s[20:23], s46 offen
    s_add_u32 s46, s45, 0x9000
    buffer_load_dword v116, v4, s[20:23], s46 offen
    buffer_load_dword v117, v5, s[20:23], s46 offen
    s_add_u32 s46, s45, 0x9800
    buffer_load_dword v118, v4, s[20:23], s46 offen
    buffer_load_dword v119, v5, s[20:23], s46 offen
    s_add_u32 s46, s45, 0x10000
    buffer_load_dword v120, v4, s[20:23], s46 offen
    buffer_load_dword v121, v5, s[20:23], s46 offen
    s_add_u32 s46, s45, 0x10800
    buffer_load_dword v122, v4, s[20:23], s46 offen
    buffer_load_dword v123, v5, s[20:23], s46 offen
    s_add_u32 s46, s45, 0x11000
    buffer_load_dword v124, v4, s[20:23], s46 offen
    buffer_load_dword v125, v5, s[20:23], s46 offen
    s_add_u32 s46, s45, 0x11800
    buffer_load_dword v126, v4, s[20:23], s46 offen
    buffer_load_dword v127, v5, s[20:23], s46 offen
    s_add_u32 s46, s45, 0x18000
    buffer_load_dword v128, v4, s[20:23], s46 offen
    buffer_load_dword v129, v5, s[20:23], s46 offen
    s_add_u32 s46, s45, 0x18800
    buffer_load_dword v130, v4, s[20:23], s46 offen
    buffer_load_dword v131, v5, s[20:23], s46 offen
    s_add_u32 s46, s45, 0x19000
    buffer_load_dword v132, v4, s[20:23], s46 offen
    buffer_load_dword v133, v5, s[20:23], s46 offen
    s_add_u32 s46, s45, 0x19800
    buffer_load_dword v134, v4, s[20:23], s46 offen
    buffer_load_dword v135, v5, s[20:23], s46 offen
    s_add_u32 s46, s45, 0x20000
    buffer_load_dword v136, v4, s[20:23], s46 offen
    buffer_load_dword v137, v5, s[20:23], s46 offen
    s_add_u32 s46, s45, 0x20800
    buffer_load_dword v138, v4, s[20:23], s46 offen
    buffer_load_dword v139, v5, s[20:23], s46 offen
    s_add_u32 s46, s45, 0x21000
    buffer_load_dword v140, v4, s[20:23], s46 offen
    buffer_load_dword v141, v5, s[20:23], s46 offen
    s_add_u32 s46, s45, 0x21800
    buffer_load_dword v142, v4, s[20:23], s46 offen
    buffer_load_dword v143, v5, s[20:23], s46 offen
    s_add_u32 s46, s45, 0x28000
    buffer_load_dword v144, v4, s[20:23], s46 offen
    buffer_load_dword v145, v5, s[20:23], s46 offen
    s_add_u32 s46, s45, 0x28800
    buffer_load_dword v146, v4, s[20:23], s46 offen
    buffer_load_dword v147, v5, s[20:23], s46 offen
    s_add_u32 s46, s45, 0x29000
    buffer_load_dword v148, v4, s[20:23], s46 offen
    buffer_load_dword v149, v5, s[20:23], s46 offen
    s_add_u32 s46, s45, 0x29800
    buffer_load_dword v150, v4, s[20:23], s46 offen
    buffer_load_dword v151, v5, s[20:23], s46 offen
    s_waitcnt vmcnt(46)
    v_perm_b32 v168, v105, v104, s37
    v_perm_b32 v172, v105, v104, s38
    s_add_u32 s46, s45, 0x30000
    buffer_load_dword v152, v4, s[20:23], s46 offen
    buffer_load_dword v153, v5, s[20:23], s46 offen
    s_add_u32 s46, s45, 0x30800
    buffer_load_dword v154, v4, s[20:23], s46 offen
    buffer_load_dword v155, v5, s[20:23], s46 offen
    s_add_u32 s46, s45, 0x31000
    buffer_load_dword v156, v4, s[20:23], s46 offen
    buffer_load_dword v157, v5, s[20:23], s46 offen
    s_add_u32 s46, s45, 0x31800
    buffer_load_dword v158, v4, s[20:23], s46 offen
    buffer_load_dword v159, v5, s[20:23], s46 offen
    s_add_u32 s46, s45, 0x38000
    buffer_load_dword v160, v4, s[20:23], s46 offen
    buffer_load_dword v161, v5, s[20:23], s46 offen
    s_add_u32 s46, s45, 0x38800
    buffer_load_dword v162, v4, s[20:23], s46 offen
    buffer_load_dword v163, v5, s[20:23], s46 offen
    s_add_u32 s46, s45, 0x39000
    buffer_load_dword v164, v4, s[20:23], s46 offen
    buffer_load_dword v165, v5, s[20:23], s46 offen
    s_waitcnt vmcnt(58)
    v_perm_b32 v169, v107, v106, s37
    v_perm_b32 v173, v107, v106, s38
    s_add_u32 s46, s45, 0x39800
    buffer_load_dword v166, v4, s[20:23], s46 offen
    buffer_load_dword v167, v5, s[20:23], s46 offen
    s_waitcnt vmcnt(58)
    v_perm_b32 v170, v109, v108, s37
    v_perm_b32 v174, v109, v108, s38
    s_add_u32 s46, s45, 0x40000
    buffer_load_dword v104, v4, s[20:23], s46 offen
    buffer_load_dword v105, v5, s[20:23], s46 offen
    s_waitcnt vmcnt(58)
    v_perm_b32 v171, v111, v110, s37
    v_perm_b32 v175, v111, v110, s38
    s_add_u32 s46, s45, 0x40800
    buffer_load_dword v106, v4, s[20:23], s46 offen
    buffer_load_dword v107, v5, s[20:23], s46 offen
    s_waitcnt vmcnt(58)
    v_perm_b32 v176, v113, v112, s37
    v_perm_b32 v180, v113, v112, s38
    s_add_u32 s46, s45, 0x41000
    buffer_load_dword v108, v4, s[20:23], s46 offen
    buffer_load_dword v109, v5, s[20:23], s46 offen
    s_waitcnt vmcnt(58)
    v_perm_b32 v177, v115, v114, s37
    v_perm_b32 v181, v115, v114, s38
    s_add_u32 s46, s45, 0x41800
    buffer_load_dword v110, v4, s[20:23], s46 offen
    buffer_load_dword v111, v5, s[20:23], s46 offen
    s_waitcnt vmcnt(58)
    v_perm_b32 v178, v117, v116, s37
    v_perm_b32 v182, v117, v116, s38
    s_add_u32 s46, s45, 0x48000
    buffer_load_dword v112, v4, s[20:23], s46 offen
    buffer_load_dword v113, v5, s[20:23], s46 offen
    s_waitcnt vmcnt(58)
    v_perm_b32 v179, v119, v118, s37
    v_perm_b32 v183, v119, v118, s38
    s_add_u32 s46, s45, 0x48800
    buffer_load_dword v114, v4, s[20:23], s46 offen
    buffer_load_dword v115, v5, s[20:23], s46 offen
    s_waitcnt vmcnt(58)
    v_perm_b32 v184, v121, v120, s37
    v_perm_b32 v188, v121, v120, s38
    s_add_u32 s46, s45, 0x49000
    buffer_load_dword v116, v4, s[20:23], s46 offen
    buffer_load_dword v117, v5, s[20:23], s46 offen
    s_waitcnt vmcnt(58)
    v_perm_b32 v185, v123, v122, s37
    v_perm_b32 v189, v123, v122, s38
    s_add_u32 s46, s45, 0x49800
    buffer_load_dword v118, v4, s[20:23], s46 offen
    buffer_load_dword v119, v5, s[20:23], s46 offen
    s_waitcnt vmcnt(58)
    v_perm_b32 v186, v125, v124, s37
    v_perm_b32 v190, v125, v124, s38
    s_add_u32 s46, s45, 0x50000
    buffer_load_dword v120, v4, s[20:23], s46 offen
    buffer_load_dword v121, v5, s[20:23], s46 offen
    s_waitcnt vmcnt(58)
    v_perm_b32 v187, v127, v126, s37
    v_perm_b32 v191, v127, v126, s38
    s_add_u32 s46, s45, 0x50800
    buffer_load_dword v122, v4, s[20:23], s46 offen
    buffer_load_dword v123, v5, s[20:23], s46 offen
    s_waitcnt vmcnt(58)
    v_perm_b32 v192, v129, v128, s37
    v_perm_b32 v196, v129, v128, s38
    s_add_u32 s46, s45, 0x51000
    buffer_load_dword v124, v4, s[20:23], s46 offen
    buffer_load_dword v125, v5, s[20:23], s46 offen
    s_waitcnt vmcnt(58)
    v_perm_b32 v193, v131, v130, s37
    v_perm_b32 v197, v131, v130, s38
    s_add_u32 s46, s45, 0x51800
    buffer_load_dword v126, v4, s[20:23], s46 offen
    buffer_load_dword v127, v5, s[20:23], s46 offen
    s_waitcnt vmcnt(58)
    v_perm_b32 v194, v133, v132, s37
    v_perm_b32 v198, v133, v132, s38
    s_waitcnt vmcnt(56)
    v_perm_b32 v195, v135, v134, s37
    v_perm_b32 v199, v135, v134, s38
    s_waitcnt vmcnt(54)
    v_perm_b32 v200, v137, v136, s37
    v_perm_b32 v204, v137, v136, s38
    s_waitcnt vmcnt(52)
    v_perm_b32 v201, v139, v138, s37
    v_perm_b32 v205, v139, v138, s38
    s_waitcnt vmcnt(50)
    v_perm_b32 v202, v141, v140, s37
    v_perm_b32 v206, v141, v140, s38
    s_waitcnt vmcnt(48)
    v_perm_b32 v203, v143, v142, s37
    v_perm_b32 v207, v143, v142, s38
    s_waitcnt vmcnt(46)
    v_perm_b32 v208, v145, v144, s37
    v_perm_b32 v212, v145, v144, s38
    s_waitcnt vmcnt(44)
    v_perm_b32 v209, v147, v146, s37
    v_perm_b32 v213, v147, v146, s38
    s_waitcnt vmcnt(42)
    v_perm_b32 v210, v149, v148, s37
    v_perm_b32 v214, v149, v148, s38
    s_waitcnt vmcnt(40)
    v_perm_b32 v211, v151, v150, s37
    v_perm_b32 v215, v151, v150, s38
    s_waitcnt vmcnt(38)
    v_perm_b32 v216, v153, v152, s37
    v_perm_b32 v220, v153, v152, s38
    s_waitcnt vmcnt(36)
    v_perm_b32 v217, v155, v154, s37
    v_perm_b32 v221, v155, v154, s38
    s_waitcnt vmcnt(34)
    v_perm_b32 v218, v157, v156, s37
    v_perm_b32 v222, v157, v156, s38
    s_waitcnt vmcnt(32)
    v_perm_b32 v219, v159, v158, s37
    v_perm_b32 v223, v159, v158, s38
    s_waitcnt vmcnt(30)
    v_perm_b32 v224, v161, v160, s37
    v_perm_b32 v228, v161, v160, s38
    s_waitcnt vmcnt(28)
    v_perm_b32 v225, v163, v162, s37
    v_perm_b32 v229, v163, v162, s38
    s_waitcnt vmcnt(26)
    v_perm_b32 v226, v165, v164, s37
    v_perm_b32 v230, v165, v164, s38
    s_waitcnt vmcnt(24)
    v_perm_b32 v227, v167, v166, s37
    v_perm_b32 v231, v167, v166, s38
    s_waitcnt vmcnt(22)
    v_perm_b32 v232, v105, v104, s37
    v_perm_b32 v236, v105, v104, s38
    s_waitcnt vmcnt(20)
    v_perm_b32 v233, v107, v106, s37
    v_perm_b32 v237, v107, v106, s38
    s_waitcnt vmcnt(18)
    v_perm_b32 v234, v109, v108, s37
    v_perm_b32 v238, v109, v108, s38
    s_waitcnt vmcnt(16)
    v_perm_b32 v235, v111, v110, s37
    v_perm_b32 v239, v111, v110, s38
    s_waitcnt vmcnt(14)
    v_perm_b32 v240, v113, v112, s37
    v_perm_b32 v244, v113, v112, s38
    s_waitcnt vmcnt(12)
    v_perm_b32 v241, v115, v114, s37
    v_perm_b32 v245, v115, v114, s38
    s_waitcnt vmcnt(10)
    v_perm_b32 v242, v117, v116, s37
    v_perm_b32 v246, v117, v116, s38
    s_waitcnt vmcnt(8)
    v_perm_b32 v243, v119, v118, s37
    v_perm_b32 v247, v119, v118, s38
    s_waitcnt vmcnt(6)
    v_perm_b32 v248, v121, v120, s37
    v_perm_b32 v252, v121, v120, s38
    s_waitcnt vmcnt(4)
    v_perm_b32 v249, v123, v122, s37
    v_perm_b32 v253, v123, v122, s38
    s_waitcnt vmcnt(2)
    v_perm_b32 v250, v125, v124, s37
    v_perm_b32 v254, v125, v124, s38
    s_waitcnt vmcnt(0)
    v_perm_b32 v251, v127, v126, s37
    v_perm_b32 v255, v127, v126, s38
    s_cmp_lg_u32 s4, 0
    s_cbranch_scc1 GK_pz_e
    v_and_b32 v8, 0x1f0, v0
    v_lshrrev_b32 v8, 2, v8
    s_mov_b32 s62, 0
GK_pz:
    buffer_load_dword v9, v8, s[8:11], 0 offen offset:2048 sc1
    s_waitcnt vmcnt(0)
    v_cmp_gt_i32 vcc, 1, v9
    s_cbranch_vccz GK_pz_ok
    s_sleep 8
    s_add_u32 s62, s62, 1
    s_cmp_lt_u32 s62, 3000000
    s_cbranch_scc1 GK_pz
    s_branch L_fail
GK_pz_ok:
GK_pz_e:
    s_barrier
GK_np:
    s_mul_i32 s44, s40, s51
    s_add_u32 s44, s44, s43
    s_lshl_b32 s45, s40, 17
    s_add_u32 s45, s45, s58
    buffer_store_dwordx4 v[12:15], v0, s[8:11], s45 offen offset:0 sc1
    buffer_store_dwordx4 v[12:15], v0, s[8:11], s45 offen offset:1024 sc1
    s_add_u32 s45, s44, 4096
    v_cvt_pk_bf16_f32 v76, v16, v20
    v_cvt_pk_bf16_f32 v77, v17, v21
    v_cvt_pk_bf16_f32 v78, v18, v22
    v_cvt_pk_bf16_f32 v79, v19, v23
    buffer_store_dwordx4 v[76:79], v0, s[8:11], s44 offen offset:0 sc1
    v_cvt_pk_bf16_f32 v80, v24, v28
    v_cvt_pk_bf16_f32 v81, v25, v29
    v_cvt_pk_bf16_f32 v82, v26, v30
    v_cvt_pk_bf16_f32 v83, v27, v31
    buffer_store_dwordx4 v[80:83], v0, s[8:11], s44 offen offset:1024 sc1
    v_cvt_pk_bf16_f32 v84, v32, v36
    v_cvt_pk_bf16_f32 v85, v33, v37
    v_cvt_pk_bf16_f32 v86, v34, v38
    v_cvt_pk_bf16_f32 v87, v35, v39
    buffer_store_dwordx4 v[84:87], v0, s[8:11], s45 offen offset:0 sc1
    v_cvt_pk_bf16_f32 v88, v40, v44
    v_cvt_pk_bf16_f32 v89, v41, v45
    v_cvt_pk_bf16_f32 v90, v42, v46
    v_cvt_pk_bf16_f32 v91, v43, v47
    buffer_store_dwordx4 v[88:91], v0, s[8:11], s45 offen offset:1024 sc1
    s_add_u32 s42, s42, 33792
    s_cmp_ge_u32 s42, 135168
    s_cselect_b32 s42, 0, s42
    s_add_u32 s40, s40, s41
    s_cmp_lt_u32 s40, 64
    s_cbranch_scc1 GK_loop
    s_cmp_eq_u32 s54, 99
    s_cbranch_scc1 W_r2done
    s_branch W_r1done
W_v:
    s_load_dwordx2 s[16:17], s[0:1], 32
    s_mov_b32 s18, 0x400000
    s_mov_b32 s19, 0x20000
    s_load_dwordx2 s[20:21], s[0:1], 32
    s_mov_b32 s22, 0x400000
    s_mov_b32 s23, 0x20000
    s_lshl_b32 s44, s53, 9
    s_lshl_b32 s45, s4, 7
    s_add_u32 s44, s44, s45
    s_mov_b32 s55, s44
    v_mul_u32_u24 v4, 65536, v2
    v_lshl_add_u32 v4, v1, 2, v4
    v_add_u32 v4, s44, v4
    v_add_u32 v5, 8192, v4
    v_mov_b32 v6, v4
    v_mov_b32 v7, v5
    s_lshl_b32 s43, s53, 14
    s_lshr_b32 s45, s4, 1
    s_lshl_b32 s45, s45, 13
    s_add_u32 s43, s43, s45
    s_and_b32 s45, s4, 1
    s_lshl_b32 s45, s45, 12
    s_add_u32 s43, s43, s45
    s_add_u32 s43, s43, 0x3000000
    s_mov_b32 s51, 0x40000
    s_waitcnt lgkmcnt(0)
    s_barrier
    s_mov_b32 s50, s40
    s_mov_b32 s57, 0
    s_mov_b32 s42, 0
    s_lshl_b32 s44, s50, 15
    s_lshl_b32 s45, s4, 13
    s_add_u32 s44, s44, s45
    s_add_u32 s45, s42, s49
    s_add_u32 m0, s45, 0
    s_nop 0
    buffer_load_dwordx4 v0, s[24:27], s44 offen lds
    s_add_u32 m0, s45, 1056
    s_add_u32 s44, s44, 1024
    buffer_load_dwordx4 v0, s[24:27], s44 offen lds
    s_add_u32 m0, s45, 2112
    s_add_u32 s44, s44, 1024
    buffer_load_dwordx4 v0, s[24:27], s44 offen lds
    s_add_u32 m0, s45, 3168
    s_add_u32 s44, s44, 1024
    buffer_load_dwordx4 v0, s[24:27], s44 offen lds
    s_add_u32 m0, s45, 4224
    s_add_u32 s44, s44, 1024
    buffer_load_dwordx4 v0, s[24:27], s44 offen lds
    s_add_u32 m0, s45, 5280
    s_add_u32 s44, s44, 1024
    buffer_load_dwordx4 v0, s[24:27], s44 offen lds
    s_add_u32 m0, s45, 6336
    s_add_u32 s44, s44, 1024
    buffer_load_dwordx4 v0, s[24:27], s44 offen lds
    s_add_u32 m0, s45, 7392
    s_add_u32 s44, s44, 1024
    buffer_load_dwordx4 v0, s[24:27], s44 offen lds
    s_add_u32 s50, s50, s41
    v_lshrrev_b32 v10, 9, v0
    v_bfe_u32 v4, v0, 7, 2
    v_lshl_add_u32 v4, v4, 3, v10
    v_and_b32 v10, 0x70, v0
    v_lshl_add_u32 v4, v4, 13, v10
    v_add_u32 v4, s55, v4
    s_mul_i32 s48, s4, 20480
    s_add_u32 s48, s48, 33792
    s_add_u32 m0, s48, 0
    s_mov_b32 s46, 0x0
    buffer_load_dwordx4 v4, s[16:19], s46 offen lds
    s_add_u32 m0, s48, 1024
    s_mov_b32 s46, 0x4000
    buffer_load_dwordx4 v4, s[16:19], s46 offen lds
    s_add_u32 m0, s48, 2048
    s_mov_b32 s46, 0x8000
    buffer_load_dwordx4 v4, s[16:19], s46 offen lds
    s_add_u32 m0, s48, 3072
    s_mov_b32 s46, 0xc000
    buffer_load_dwordx4 v4, s[16:19], s46 offen lds
    s_add_u32 m0, s48, 4096
    s_mov_b32 s46, 0x40000
    buffer_load_dwordx4 v4, s[16:19], s46 offen lds
    s_add_u32 m0, s48, 5120
    s_mov_b32 s46, 0x44000
    buffer_load_dwordx4 v4, s[16:19], s46 offen lds
    s_add_u32 m0, s48, 6144
    s_mov_b32 s46, 0x48000
    buffer_load_dwordx4 v4, s[16:19], s46 offen lds
    s_add_u32 m0, s48, 7168
    s_mov_b32 s46, 0x4c000
    buffer_load_dwordx4 v4, s[16:19], s46 offen lds
    s_add_u32 m0, s48, 8192
    s_mov_b32 s46, 0x80000
    buffer_load_dwordx4 v4, s[16:19], s46 offen lds
    s_add_u32 m0, s48, 9216
    s_mov_b32 s46, 0x84000
    buffer_load_dwordx4 v4, s[16:19], s46 offen lds
    s_add_u32 m0, s48, 10240
    s_mov_b32 s46, 0x88000
    buffer_load_dwordx4 v4, s[16:19], s46 offen lds
    s_add_u32 m0, s48, 11264
    s_mov_b32 s46, 0x8c000
    buffer_load_dwordx4 v4, s[16:19], s46 offen lds
    s_add_u32 m0, s48, 12288
    s_mov_b32 s46, 0xc0000
    buffer_load_dwordx4 v4, s[16:19], s46 offen lds
    s_add_u32 m0, s48, 13312
    s_mov_b32 s46, 0xc4000
    buffer_load_dwordx4 v4, s[16:19], s46 offen lds
    s_add_u32 m0, s48, 14336
    s_mov_b32 s46, 0xc8000
    buffer_load_dwordx4 v4, s[16:19], s46 offen lds
    s_add_u32 m0, s48, 15360
    s_mov_b32 s46, 0xcc000
    buffer_load_dwordx4 v4, s[16:19], s46 offen lds
    s_add_u32 m0, s48, 16384
    s_mov_b32 s46, 0x100000
    buffer_load_dwordx4 v4, s[16:19], s46 offen lds
    s_add_u32 m0, s48, 17408
    s_mov_b32 s46, 0x104000
    buffer_load_dwordx4 v4, s[16:19], s46 offen lds
    s_add_u32 m0, s48, 18432
    s_mov_b32 s46, 0x108000
    buffer_load_dwordx4 v4, s[16:19], s46 offen lds
    s_add_u32 m0, s48, 19456
    s_mov_b32 s46, 0x10c000
    buffer_load_dwordx4 v4, s[16:19], s46 offen lds
    v_lshlrev_b32 v6, 7, v2
    v_lshl_add_u32 v6, v1, 2, v6
    v_add_u32 v6, s48, v6
    v_add_u32 v7, 64, v6
    s_waitcnt vmcnt(16)
    ds_read2st64_b32 v[104:105], v6 offset0:0 offset1:2
    ds_read2st64_b32 v[106:107], v7 offset0:0 offset1:2
    ds_read2st64_b32 v[108:109], v6 offset0:4 offset1:6
    ds_read2st64_b32 v[110:111], v7 offset0:4 offset1:6
    ds_read2st64_b32 v[112:113], v6 offset0:8 offset1:10
    ds_read2st64_b32 v[114:115], v7 offset0:8 offset1:10
    ds_read2st64_b32 v[116:117], v6 offset0:12 offset1:14
    ds_read2st64_b32 v[118:119], v7 offset0:12 offset1:14
    s_waitcnt vmcnt(12) lgkmcnt(0)
    ds_read2st64_b32 v[120:121], v6 offset0:16 offset1:18
    ds_read2st64_b32 v[122:123], v7 offset0:16 offset1:18
    ds_read2st64_b32 v[124:125], v6 offset0:20 offset1:22
    ds_read2st64_b32 v[126:127], v7 offset0:20 offset1:22
    ds_read2st64_b32 v[128:129], v6 offset0:24 offset1:26
    ds_read2st64_b32 v[130:131], v7 offset0:24 offset1:26
    ds_read2st64_b32 v[132:133], v6 offset0:28 offset1:30
    ds_read2st64_b32 v[134:135], v7 offset0:28 offset1:30
    s_cmp_eq_u32 s97, 0
    s_cbranch_scc1 GV_ws
    s_mov_b32 s97, 0
    s_lshl_b32 s44, s96, 15
    s_lshr_b32 s45, s4, 1
    s_lshl_b32 s45, s45, 14
    s_add_u32 s44, s44, s45
    s_and_b32 s45, s4, 1
    s_lshl_b32 s45, s45, 11
    s_add_u32 s44, s44, s45
    s_add_u32 s44, s44, 0x200000
    s_add_u32 s45, s44, 0
    v_perm_b32 v172, v141, v140, s37
    v_perm_b32 v173, v143, v142, s37
    v_perm_b32 v174, v145, v144, s37
    v_perm_b32 v175, v147, v146, s37
    buffer_store_dwordx4 v[172:175], v0, s[8:11], s45 offen offset:0 sc1
    v_perm_b32 v176, v141, v140, s38
    v_perm_b32 v177, v143, v142, s38
    v_perm_b32 v178, v145, v144, s38
    v_perm_b32 v179, v147, v146, s38
    buffer_store_dwordx4 v[176:179], v0, s[8:11], s45 offen offset:1024 sc1
    s_add_u32 s45, s44, 4096
    v_perm_b32 v180, v149, v148, s37
    v_perm_b32 v181, v151, v150, s37
    v_perm_b32 v182, v153, v152, s37
    v_perm_b32 v183, v155, v154, s37
    buffer_store_dwordx4 v[180:183], v0, s[8:11], s45 offen offset:0 sc1
    v_perm_b32 v184, v149, v148, s38
    v_perm_b32 v185, v151, v150, s38
    v_perm_b32 v186, v153, v152, s38
    v_perm_b32 v187, v155, v154, s38
    buffer_store_dwordx4 v[184:187], v0, s[8:11], s45 offen offset:1024 sc1
    s_add_u32 s45, s44, 8192
    v_perm_b32 v188, v157, v156, s37
    v_perm_b32 v189, v159, v158, s37
    v_perm_b32 v190, v161, v160, s37
    v_perm_b32 v191, v163, v162, s37
    buffer_store_dwordx4 v[188:191], v0, s[8:11], s45 offen offset:0 sc1
    v_perm_b32 v192, v157, v156, s38
    v_perm_b32 v193, v159, v158, s38
    v_perm_b32 v194, v161, v160, s38
    v_perm_b32 v195, v163, v162, s38
    buffer_store_dwordx4 v[192:195], v0, s[8:11], s45 offen offset:1024 sc1
    s_add_u32 s45, s44, 12288
    v_perm_b32 v196, v165, v164, s37
    v_perm_b32 v197, v167, v166, s37
    v_perm_b32 v198, v169, v168, s37
    v_perm_b32 v199, v171, v170, s37
    buffer_store_dwordx4 v[196:199], v0, s[8:11], s45 offen offset:0 sc1
    v_perm_b32 v200, v165, v164, s38
    v_perm_b32 v201, v167, v166, s38
    v_perm_b32 v202, v169, v168, s38
    v_perm_b32 v203, v171, v170, s38
    buffer_store_dwordx4 v[200:203], v0, s[8:11], s45 offen offset:1024 sc1
GV_ws:
    s_add_u32 m0, s48, 0
    s_mov_b32 s46, 0x140000
    buffer_load_dwordx4 v4, s[16:19], s46 offen lds
    v_perm_b32 v8, v105, v104, s37
    v_accvgpr_write_b32 a0, v8
    v_perm_b32 v9, v105, v104, s38
    v_accvgpr_write_b32 a4, v9
    v_perm_b32 v8, v107, v106, s37
    v_accvgpr_write_b32 a8, v8
    v_perm_b32 v9, v107, v106, s38
    v_accvgpr_write_b32 a12, v9
    s_add_u32 m0, s48, 1024
    s_mov_b32 s46, 0x144000
    buffer_load_dwordx4 v4, s[16:19], s46 offen lds
    v_perm_b32 v8, v109, v108, s37
    v_accvgpr_write_b32 a1, v8
    v_perm_b32 v9, v109, v108, s38
    v_accvgpr_write_b32 a5, v9
    v_perm_b32 v8, v111, v110, s37
    v_accvgpr_write_b32 a9, v8
    v_perm_b32 v9, v111, v110, s38
    v_accvgpr_write_b32 a13, v9
    s_add_u32 m0, s48, 2048
    s_mov_b32 s46, 0x148000
    buffer_load_dwordx4 v4, s[16:19], s46 offen lds
    v_perm_b32 v8, v113, v112, s37
    v_accvgpr_write_b32 a2, v8
    v_perm_b32 v9, v113, v112, s38
    v_accvgpr_write_b32 a6, v9
    v_perm_b32 v8, v115, v114, s37
    v_accvgpr_write_b32 a10, v8
    v_perm_b32 v9, v115, v114, s38
    v_accvgpr_write_b32 a14, v9
    s_add_u32 m0, s48, 3072
    s_mov_b32 s46, 0x14c000
    buffer_load_dwordx4 v4, s[16:19], s46 offen lds
    v_perm_b32 v8, v117, v116, s37
    v_accvgpr_write_b32 a3, v8
    v_perm_b32 v9, v117, v116, s38
    v_accvgpr_write_b32 a7, v9
    v_perm_b32 v8, v119, v118, s37
    v_accvgpr_write_b32 a11, v8
    v_perm_b32 v9, v119, v118, s38
    v_accvgpr_write_b32 a15, v9
    s_waitcnt vmcnt(12) lgkmcnt(0)
    ds_read2st64_b32 v[104:105], v6 offset0:32 offset1:34
    ds_read2st64_b32 v[106:107], v7 offset0:32 offset1:34
    ds_read2st64_b32 v[108:109], v6 offset0:36 offset1:38
    ds_read2st64_b32 v[110:111], v7 offset0:36 offset1:38
    ds_read2st64_b32 v[112:113], v6 offset0:40 offset1:42
    ds_read2st64_b32 v[114:115], v7 offset0:40 offset1:42
    ds_read2st64_b32 v[116:117], v6 offset0:44 offset1:46
    ds_read2st64_b32 v[118:119], v7 offset0:44 offset1:46
    s_add_u32 m0, s48, 4096
    s_mov_b32 s46, 0x180000
    buffer_load_dwordx4 v4, s[16:19], s46 offen lds
    v_perm_b32 v8, v121, v120, s37
    v_accvgpr_write_b32 a16, v8
    v_perm_b32 v9, v121, v120, s38
    v_accvgpr_write_b32 a20, v9
    v_perm_b32 v8, v123, v122, s37
    v_accvgpr_write_b32 a24, v8
    v_perm_b32 v9, v123, v122, s38
    v_accvgpr_write_b32 a28, v9
    s_add_u32 m0, s48, 5120
    s_mov_b32 s46, 0x184000
    buffer_load_dwordx4 v4, s[16:19], s46 offen lds
    v_perm_b32 v8, v125, v124, s37
    v_accvgpr_write_b32 a17, v8
    v_perm_b32 v9, v125, v124, s38
    v_accvgpr_write_b32 a21, v9
    v_perm_b32 v8, v127, v126, s37
    v_accvgpr_write_b32 a25, v8
    v_perm_b32 v9, v127, v126, s38
    v_accvgpr_write_b32 a29, v9
    s_add_u32 m0, s48, 6144
    s_mov_b32 s46, 0x188000
    buffer_load_dwordx4 v4, s[16:19], s46 offen lds
    v_perm_b32 v8, v129, v128, s37
    v_accvgpr_write_b32 a18, v8
    v_perm_b32 v9, v129, v128, s38
    v_accvgpr_write_b32 a22, v9
    v_perm_b32 v8, v131, v130, s37
    v_accvgpr_write_b32 a26, v8
    v_perm_b32 v9, v131, v130, s38
    v_accvgpr_write_b32 a30, v9
    s_add_u32 m0, s48, 7168
    s_mov_b32 s46, 0x18c000
    buffer_load_dwordx4 v4, s[16:19], s46 offen lds
    v_perm_b32 v8, v133, v132, s37
    v_accvgpr_write_b32 a19, v8
    v_perm_b32 v9, v133, v132, s38
    v_accvgpr_write_b32 a23, v9
    v_perm_b32 v8, v135, v134, s37
    v_accvgpr_write_b32 a27, v8
    v_perm_b32 v9, v135, v134, s38
    v_accvgpr_write_b32 a31, v9
    s_waitcnt vmcnt(12) lgkmcnt(0)
    ds_read2st64_b32 v[120:121], v6 offset0:48 offset1:50
    ds_read2st64_b32 v[122:123], v7 offset0:48 offset1:50
    ds_read2st64_b32 v[124:125], v6 offset0:52 offset1:54
    ds_read2st64_b32 v[126:127], v7 offset0:52 offset1:54
    ds_read2st64_b32 v[128:129], v6 offset0:56 offset1:58
    ds_read2st64_b32 v[130:131], v7 offset0:56 offset1:58
    ds_read2st64_b32 v[132:133], v6 offset0:60 offset1:62
    ds_read2st64_b32 v[134:135], v7 offset0:60 offset1:62
    s_add_u32 m0, s48, 8192
    s_mov_b32 s46, 0x1c0000
    buffer_load_dwordx4 v4, s[16:19], s46 offen lds
    v_perm_b32 v8, v105, v104, s37
    v_accvgpr_write_b32 a32, v8
    v_perm_b32 v9, v105, v104, s38
    v_accvgpr_write_b32 a36, v9
    v_perm_b32 v8, v107, v106, s37
    v_accvgpr_write_b32 a40, v8
    v_perm_b32 v9, v107, v106, s38
    v_accvgpr_write_b32 a44, v9
    s_add_u32 m0, s48, 9216
    s_mov_b32 s46, 0x1c4000
    buffer_load_dwordx4 v4, s[16:19], s46 offen lds
    v_perm_b32 v8, v109, v108, s37
    v_accvgpr_write_b32 a33, v8
    v_perm_b32 v9, v109, v108, s38
    v_accvgpr_write_b32 a37, v9
    v_perm_b32 v8, v111, v110, s37
    v_accvgpr_write_b32 a41, v8
    v_perm_b32 v9, v111, v110, s38
    v_accvgpr_write_b32 a45, v9
    s_add_u32 m0, s48, 10240
    s_mov_b32 s46, 0x1c8000
    buffer_load_dwordx4 v4, s[16:19], s46 offen lds
    v_perm_b32 v8, v113, v112, s37
    v_accvgpr_write_b32 a34, v8
    v_perm_b32 v9, v113, v112, s38
    v_accvgpr_write_b32 a38, v9
    v_perm_b32 v8, v115, v114, s37
    v_accvgpr_write_b32 a42, v8
    v_perm_b32 v9, v115, v114, s38
    v_accvgpr_write_b32 a46, v9
    s_add_u32 m0, s48, 11264
    s_mov_b32 s46, 0x1cc000
    buffer_load_dwordx4 v4, s[16:19], s46 offen lds
    v_perm_b32 v8, v117, v116, s37
    v_accvgpr_write_b32 a35, v8
    v_perm_b32 v9, v117, v116, s38
    v_accvgpr_write_b32 a39, v9
    v_perm_b32 v8, v119, v118, s37
    v_accvgpr_write_b32 a43, v8
    v_perm_b32 v9, v119, v118, s38
    v_accvgpr_write_b32 a47, v9
    s_waitcnt vmcnt(12) lgkmcnt(0)
    ds_read2st64_b32 v[104:105], v6 offset0:64 offset1:66
    ds_read2st64_b32 v[106:107], v7 offset0:64 offset1:66
    ds_read2st64_b32 v[108:109], v6 offset0:68 offset1:70
    ds_read2st64_b32 v[110:111], v7 offset0:68 offset1:70
    ds_read2st64_b32 v[112:113], v6 offset0:72 offset1:74
    ds_read2st64_b32 v[114:115], v7 offset0:72 offset1:74
    ds_read2st64_b32 v[116:117], v6 offset0:76 offset1:78
    ds_read2st64_b32 v[118:119], v7 offset0:76 offset1:78
    s_add_u32 m0, s48, 12288
    s_mov_b32 s46, 0x200000
    buffer_load_dwordx4 v4, s[16:19], s46 offen lds
    v_perm_b32 v8, v121, v120, s37
    v_accvgpr_write_b32 a48, v8
    v_perm_b32 v9, v121, v120, s38
    v_accvgpr_write_b32 a52, v9
    v_perm_b32 v8, v123, v122, s37
    v_accvgpr_write_b32 a56, v8
    v_perm_b32 v9, v123, v122, s38
    v_accvgpr_write_b32 a60, v9
    s_add_u32 m0, s48, 13312
    s_mov_b32 s46, 0x204000
    buffer_load_dwordx4 v4, s[16:19], s46 offen lds
    v_perm_b32 v8, v125, v124, s37
    v_accvgpr_write_b32 a49, v8
    v_perm_b32 v9, v125, v124, s38
    v_accvgpr_write_b32 a53, v9
    v_perm_b32 v8, v127, v126, s37
    v_accvgpr_write_b32 a57, v8
    v_perm_b32 v9, v127, v126, s38
    v_accvgpr_write_b32 a61, v9
    s_add_u32 m0, s48, 14336
    s_mov_b32 s46, 0x208000
    buffer_load_dwordx4 v4, s[16:19], s46 offen lds
    v_perm_b32 v8, v129, v128, s37
    v_accvgpr_write_b32 a50, v8
    v_perm_b32 v9, v129, v128, s38
    v_accvgpr_write_b32 a54, v9
    v_perm_b32 v8, v131, v130, s37
    v_accvgpr_write_b32 a58, v8
    v_perm_b32 v9, v131, v130, s38
    v_accvgpr_write_b32 a62, v9
    s_add_u32 m0, s48, 15360
    s_mov_b32 s46, 0x20c000
    buffer_load_dwordx4 v4, s[16:19], s46 offen lds
    v_perm_b32 v8, v133, v132, s37
    v_accvgpr_write_b32 a51, v8
    v_perm_b32 v9, v133, v132, s38
    v_accvgpr_write_b32 a55, v9
    v_perm_b32 v8, v135, v134, s37
    v_accvgpr_write_b32 a59, v8
    v_perm_b32 v9, v135, v134, s38
    v_accvgpr_write_b32 a63, v9
    s_waitcnt vmcnt(12) lgkmcnt(0)
    ds_read2st64_b32 v[120:121], v6 offset0:0 offset1:2
    ds_read2st64_b32 v[122:123], v7 offset0:0 offset1:2
    ds_read2st64_b32 v[124:125], v6 offset0:4 offset1:6
    ds_read2st64_b32 v[126:127], v7 offset0:4 offset1:6
    ds_read2st64_b32 v[128:129], v6 offset0:8 offset1:10
    ds_read2st64_b32 v[130:131], v7 offset0:8 offset1:10
    ds_read2st64_b32 v[132:133], v6 offset0:12 offset1:14
    ds_read2st64_b32 v[134:135], v7 offset0:12 offset1:14
    s_add_u32 m0, s48, 16384
    s_mov_b32 s46, 0x240000
    buffer_load_dwordx4 v4, s[16:19], s46 offen lds
    v_perm_b32 v8, v105, v104, s37
    v_accvgpr_write_b32 a64, v8
    v_perm_b32 v9, v105, v104, s38
    v_accvgpr_write_b32 a68, v9
    v_perm_b32 v8, v107, v106, s37
    v_accvgpr_write_b32 a72, v8
    v_perm_b32 v9, v107, v106, s38
    v_accvgpr_write_b32 a76, v9
    s_add_u32 m0, s48, 17408
    s_mov_b32 s46, 0x244000
    buffer_load_dwordx4 v4, s[16:19], s46 offen lds
    v_perm_b32 v8, v109, v108, s37
    v_accvgpr_write_b32 a65, v8
    v_perm_b32 v9, v109, v108, s38
    v_accvgpr_write_b32 a69, v9
    v_perm_b32 v8, v111, v110, s37
    v_accvgpr_write_b32 a73, v8
    v_perm_b32 v9, v111, v110, s38
    v_accvgpr_write_b32 a77, v9
    s_add_u32 m0, s48, 18432
    s_mov_b32 s46, 0x248000
    buffer_load_dwordx4 v4, s[16:19], s46 offen lds
    v_perm_b32 v8, v113, v112, s37
    v_accvgpr_write_b32 a66, v8
    v_perm_b32 v9, v113, v112, s38
    v_accvgpr_write_b32 a70, v9
    v_perm_b32 v8, v115, v114, s37
    v_accvgpr_write_b32 a74, v8
    v_perm_b32 v9, v115, v114, s38
    v_accvgpr_write_b32 a78, v9
    s_add_u32 m0, s48, 19456
    s_mov_b32 s46, 0x24c000
    buffer_load_dwordx4 v4, s[16:19], s46 offen lds
    v_perm_b32 v8, v117, v116, s37
    v_accvgpr_write_b32 a67, v8
    v_perm_b32 v9, v117, v116, s38
    v_accvgpr_write_b32 a71, v9
    v_perm_b32 v8, v119, v118, s37
    v_accvgpr_write_b32 a75, v8
    v_perm_b32 v9, v119, v118, s38
    v_accvgpr_write_b32 a79, v9
    s_waitcnt vmcnt(12) lgkmcnt(0)
    ds_read2st64_b32 v[104:105], v6 offset0:16 offset1:18
    ds_read2st64_b32 v[106:107], v7 offset0:16 offset1:18
    ds_read2st64_b32 v[108:109], v6 offset0:20 offset1:22
    ds_read2st64_b32 v[110:111], v7 offset0:20 offset1:22
    ds_read2st64_b32 v[112:113], v6 offset0:24 offset1:26
    ds_read2st64_b32 v[114:115], v7 offset0:24 offset1:26
    ds_read2st64_b32 v[116:117], v6 offset0:28 offset1:30
    ds_read2st64_b32 v[118:119], v7 offset0:28 offset1:30
    s_barrier
    s_mov_b32 s63, 128
    s_cmp_eq_u32 s99, 0
    s_cselect_b32 s63, s63, 0x7fffff00
    s_mov_b32 s99, 1
    v_mov_b32 v11, 1
    s_mov_b64 exec, 1
    buffer_atomic_add v11, off, s[12:15], s63
    s_mov_b64 exec, -1
    s_add_u32 m0, s48, 0
    s_mov_b32 s46, 0x280000
    buffer_load_dwordx4 v4, s[16:19], s46 offen lds
    v_perm_b32 v8, v121, v120, s37
    v_accvgpr_write_b32 a80, v8
    v_perm_b32 v9, v121, v120, s38
    v_accvgpr_write_b32 a84, v9
    v_perm_b32 v8, v123, v122, s37
    v_accvgpr_write_b32 a88, v8
    v_perm_b32 v9, v123, v122, s38
    v_accvgpr_write_b32 a92, v9
    s_add_u32 m0, s48, 1024
    s_mov_b32 s46, 0x284000
    buffer_load_dwordx4 v4, s[16:19], s46 offen lds
    v_perm_b32 v8, v125, v124, s37
    v_accvgpr_write_b32 a81, v8
    v_perm_b32 v9, v125, v124, s38
    v_accvgpr_write_b32 a85, v9
    v_perm_b32 v8, v127, v126, s37
    v_accvgpr_write_b32 a89, v8
    v_perm_b32 v9, v127, v126, s38
    v_accvgpr_write_b32 a93, v9
    s_add_u32 m0, s48, 2048
    s_mov_b32 s46, 0x288000
    buffer_load_dwordx4 v4, s[16:19], s46 offen lds
    v_perm_b32 v8, v129, v128, s37
    v_accvgpr_write_b32 a82, v8
    v_perm_b32 v9, v129, v128, s38
    v_accvgpr_write_b32 a86, v9
    v_perm_b32 v8, v131, v130, s37
    v_accvgpr_write_b32 a90, v8
    v_perm_b32 v9, v131, v130, s38
    v_accvgpr_write_b32 a94, v9
    s_add_u32 m0, s48, 3072
    s_mov_b32 s46, 0x28c000
    buffer_load_dwordx4 v4, s[16:19], s46 offen lds
    v_perm_b32 v8, v133, v132, s37
    v_accvgpr_write_b32 a83, v8
    v_perm_b32 v9, v133, v132, s38
    v_accvgpr_write_b32 a87, v9
    v_perm_b32 v8, v135, v134, s37
    v_accvgpr_write_b32 a91, v8
    v_perm_b32 v9, v135, v134, s38
    v_accvgpr_write_b32 a95, v9
    s_waitcnt vmcnt(12) lgkmcnt(0)
    ds_read2st64_b32 v[120:121], v6 offset0:32 offset1:34
    ds_read2st64_b32 v[122:123], v7 offset0:32 offset1:34
    ds_read2st64_b32 v[124:125], v6 offset0:36 offset1:38
    ds_read2st64_b32 v[126:127], v7 offset0:36 offset1:38
    ds_read2st64_b32 v[128:129], v6 offset0:40 offset1:42
    ds_read2st64_b32 v[130:131], v7 offset0:40 offset1:42
    ds_read2st64_b32 v[132:133], v6 offset0:44 offset1:46
    ds_read2st64_b32 v[134:135], v7 offset0:44 offset1:46
    s_add_u32 m0, s48, 4096
    s_mov_b32 s46, 0x2c0000
    buffer_load_dwordx4 v4, s[16:19], s46 offen lds
    v_perm_b32 v8, v105, v104, s37
    v_accvgpr_write_b32 a96, v8
    v_perm_b32 v9, v105, v104, s38
    v_accvgpr_write_b32 a100, v9
    v_perm_b32 v8, v107, v106, s37
    v_accvgpr_write_b32 a104, v8
    v_perm_b32 v9, v107, v106, s38
    v_accvgpr_write_b32 a108, v9
    s_add_u32 m0, s48, 5120
    s_mov_b32 s46, 0x2c4000
    buffer_load_dwordx4 v4, s[16:19], s46 offen lds
    v_perm_b32 v8, v109, v108, s37
    v_accvgpr_write_b32 a97, v8
    v_perm_b32 v9, v109, v108, s38
    v_accvgpr_write_b32 a101, v9
    v_perm_b32 v8, v111, v110, s37
    v_accvgpr_write_b32 a105, v8
    v_perm_b32 v9, v111, v110, s38
    v_accvgpr_write_b32 a109, v9
    s_add_u32 m0, s48, 6144
    s_mov_b32 s46, 0x2c8000
    buffer_load_dwordx4 v4, s[16:19], s46 offen lds
    v_perm_b32 v8, v113, v112, s37
    v_accvgpr_write_b32 a98, v8
    v_perm_b32 v9, v113, v112, s38
    v_accvgpr_write_b32 a102, v9
    v_perm_b32 v8, v115, v114, s37
    v_accvgpr_write_b32 a106, v8
    v_perm_b32 v9, v115, v114, s38
    v_accvgpr_write_b32 a110, v9
    s_add_u32 m0, s48, 7168
    s_mov_b32 s46, 0x2cc000
    buffer_load_dwordx4 v4, s[16:19], s46 offen lds
    v_perm_b32 v8, v117, v116, s37
    v_accvgpr_write_b32 a99, v8
    v_perm_b32 v9, v117, v116, s38
    v_accvgpr_write_b32 a103, v9
    v_perm_b32 v8, v119, v118, s37
    v_accvgpr_write_b32 a107, v8
    v_perm_b32 v9, v119, v118, s38
    v_accvgpr_write_b32 a111, v9
    s_waitcnt vmcnt(12) lgkmcnt(0)
    ds_read2st64_b32 v[104:105], v6 offset0:48 offset1:50
    ds_read2st64_b32 v[106:107], v7 offset0:48 offset1:50
    ds_read2st64_b32 v[108:109], v6 offset0:52 offset1:54
    ds_read2st64_b32 v[110:111], v7 offset0:52 offset1:54
    ds_read2st64_b32 v[112:113], v6 offset0:56 offset1:58
    ds_read2st64_b32 v[114:115], v7 offset0:56 offset1:58
    ds_read2st64_b32 v[116:117], v6 offset0:60 offset1:62
    ds_read2st64_b32 v[118:119], v7 offset0:60 offset1:62
    s_add_u32 m0, s48, 8192
    s_mov_b32 s46, 0x300000
    buffer_load_dwordx4 v4, s[16:19], s46 offen lds
    v_perm_b32 v8, v121, v120, s37
    v_accvgpr_write_b32 a112, v8
    v_perm_b32 v9, v121, v120, s38
    v_accvgpr_write_b32 a116, v9
    v_perm_b32 v8, v123, v122, s37
    v_accvgpr_write_b32 a120, v8
    v_perm_b32 v9, v123, v122, s38
    v_accvgpr_write_b32 a124, v9
    s_add_u32 m0, s48, 9216
    s_mov_b32 s46, 0x304000
    buffer_load_dwordx4 v4, s[16:19], s46 offen lds
    v_perm_b32 v8, v125, v124, s37
    v_accvgpr_write_b32 a113, v8
    v_perm_b32 v9, v125, v124, s38
    v_accvgpr_write_b32 a117, v9
    v_perm_b32 v8, v127, v126, s37
    v_accvgpr_write_b32 a121, v8
    v_perm_b32 v9, v127, v126, s38
    v_accvgpr_write_b32 a125, v9
    s_add_u32 m0, s48, 10240
    s_mov_b32 s46, 0x308000
    buffer_load_dwordx4 v4, s[16:19], s46 offen lds
    v_perm_b32 v8, v129, v128, s37
    v_accvgpr_write_b32 a114, v8
    v_perm_b32 v9, v129, v128, s38
    v_accvgpr_write_b32 a118, v9
    v_perm_b32 v8, v131, v130, s37
    v_accvgpr_write_b32 a122, v8
    v_perm_b32 v9, v131, v130, s38
    v_accvgpr_write_b32 a126, v9
    s_add_u32 m0, s48, 11264
    s_mov_b32 s46, 0x30c000
    buffer_load_dwordx4 v4, s[16:19], s46 offen lds
    v_perm_b32 v8, v133, v132, s37
    v_accvgpr_write_b32 a115, v8
    v_perm_b32 v9, v133, v132, s38
    v_accvgpr_write_b32 a119, v9
    v_perm_b32 v8, v135, v134, s37
    v_accvgpr_write_b32 a123, v8
    v_perm_b32 v9, v135, v134, s38
    v_accvgpr_write_b32 a127, v9
    s_waitcnt vmcnt(12) lgkmcnt(0)
    ds_read2st64_b32 v[120:121], v6 offset0:64 offset1:66
    ds_read2st64_b32 v[122:123], v7 offset0:64 offset1:66
    ds_read2st64_b32 v[124:125], v6 offset0:68 offset1:70
    ds_read2st64_b32 v[126:127], v7 offset0:68 offset1:70
    ds_read2st64_b32 v[128:129], v6 offset0:72 offset1:74
    ds_read2st64_b32 v[130:131], v7 offset0:72 offset1:74
    ds_read2st64_b32 v[132:133], v6 offset0:76 offset1:78
    ds_read2st64_b32 v[134:135], v7 offset0:76 offset1:78
    s_add_u32 m0, s48, 12288
    s_mov_b32 s46, 0x340000
    buffer_load_dwordx4 v4, s[16:19], s46 offen lds
    v_perm_b32 v8, v105, v104, s37
    v_accvgpr_write_b32 a128, v8
    v_perm_b32 v9, v105, v104, s38
    v_accvgpr_write_b32 a132, v9
    v_perm_b32 v8, v107, v106, s37
    v_accvgpr_write_b32 a136, v8
    v_perm_b32 v9, v107, v106, s38
    v_accvgpr_write_b32 a140, v9
    s_add_u32 m0, s48, 13312
    s_mov_b32 s46, 0x344000
    buffer_load_dwordx4 v4, s[16:19], s46 offen lds
    v_perm_b32 v8, v109, v108, s37
    v_accvgpr_write_b32 a129, v8
    v_perm_b32 v9, v109, v108, s38
    v_accvgpr_write_b32 a133, v9
    v_perm_b32 v8, v111, v110, s37
    v_accvgpr_write_b32 a137, v8
    v_perm_b32 v9, v111, v110, s38
    v_accvgpr_write_b32 a141, v9
    s_add_u32 m0, s48, 14336
    s_mov_b32 s46, 0x348000
    buffer_load_dwordx4 v4, s[16:19], s46 offen lds
    v_perm_b32 v8, v113, v112, s37
    v_accvgpr_write_b32 a130, v8
    v_perm_b32 v9, v113, v112, s38
    v_accvgpr_write_b32 a134, v9
    v_perm_b32 v8, v115, v114, s37
    v_accvgpr_write_b32 a138, v8
    v_perm_b32 v9, v115, v114, s38
    v_accvgpr_write_b32 a142, v9
    s_add_u32 m0, s48, 15360
    s_mov_b32 s46, 0x34c000
    buffer_load_dwordx4 v4, s[16:19], s46 offen lds
    v_perm_b32 v8, v117, v116, s37
    v_accvgpr_write_b32 a131, v8
    v_perm_b32 v9, v117, v116, s38
    v_accvgpr_write_b32 a135, v9
    v_perm_b32 v8, v119, v118, s37
    v_accvgpr_write_b32 a139, v8
    v_perm_b32 v9, v119, v118, s38
    v_accvgpr_write_b32 a143, v9
    s_waitcnt vmcnt(12) lgkmcnt(0)
    ds_read2st64_b32 v[104:105], v6 offset0:0 offset1:2
    ds_read2st64_b32 v[106:107], v7 offset0:0 offset1:2
    ds_read2st64_b32 v[108:109], v6 offset0:4 offset1:6
    ds_read2st64_b32 v[110:111], v7 offset0:4 offset1:6
    ds_read2st64_b32 v[112:113], v6 offset0:8 offset1:10
    ds_read2st64_b32 v[114:115], v7 offset0:8 offset1:10
    ds_read2st64_b32 v[116:117], v6 offset0:12 offset1:14
    ds_read2st64_b32 v[118:119], v7 offset0:12 offset1:14
    s_add_u32 m0, s48, 16384
    s_mov_b32 s46, 0x380000
    buffer_load_dwordx4 v4, s[16:19], s46 offen lds
    v_perm_b32 v8, v121, v120, s37
    v_accvgpr_write_b32 a144, v8
    v_perm_b32 v9, v121, v120, s38
    v_accvgpr_write_b32 a148, v9
    v_perm_b32 v8, v123, v122, s37
    v_accvgpr_write_b32 a152, v8
    v_perm_b32 v9, v123, v122, s38
    v_accvgpr_write_b32 a156, v9
    s_add_u32 m0, s48, 17408
    s_mov_b32 s46, 0x384000
    buffer_load_dwordx4 v4, s[16:19], s46 offen lds
    v_perm_b32 v8, v125, v124, s37
    v_accvgpr_write_b32 a145, v8
    v_perm_b32 v9, v125, v124, s38
    v_accvgpr_write_b32 a149, v9
    v_perm_b32 v8, v127, v126, s37
    v_accvgpr_write_b32 a153, v8
    v_perm_b32 v9, v127, v126, s38
    v_accvgpr_write_b32 a157, v9
    s_add_u32 m0, s48, 18432
    s_mov_b32 s46, 0x388000
    buffer_load_dwordx4 v4, s[16:19], s46 offen lds
    v_perm_b32 v8, v129, v128, s37
    v_accvgpr_write_b32 a146, v8
    v_perm_b32 v9, v129, v128, s38
    v_accvgpr_write_b32 a150, v9
    v_perm_b32 v8, v131, v130, s37
    v_accvgpr_write_b32 a154, v8
    v_perm_b32 v9, v131, v130, s38
    v_accvgpr_write_b32 a158, v9
    s_add_u32 m0, s48, 19456
    s_mov_b32 s46, 0x38c000
    buffer_load_dwordx4 v4, s[16:19], s46 offen lds
    v_perm_b32 v8, v133, v132, s37
    v_accvgpr_write_b32 a147, v8
    v_perm_b32 v9, v133, v132, s38
    v_accvgpr_write_b32 a151, v9
    v_perm_b32 v8, v135, v134, s37
    v_accvgpr_write_b32 a155, v8
    v_perm_b32 v9, v135, v134, s38
    v_accvgpr_write_b32 a159, v9
    s_waitcnt vmcnt(12) lgkmcnt(0)
    ds_read2st64_b32 v[120:121], v6 offset0:16 offset1:18
    ds_read2st64_b32 v[122:123], v7 offset0:16 offset1:18
    ds_read2st64_b32 v[124:125], v6 offset0:20 offset1:22
    ds_read2st64_b32 v[126:127], v7 offset0:20 offset1:22
    ds_read2st64_b32 v[128:129], v6 offset0:24 offset1:26
    ds_read2st64_b32 v[130:131], v7 offset0:24 offset1:26
    ds_read2st64_b32 v[132:133], v6 offset0:28 offset1:30
    ds_read2st64_b32 v[134:135], v7 offset0:28 offset1:30
    s_add_u32 m0, s48, 0
    s_mov_b32 s46, 0x3c0000
    buffer_load_dwordx4 v4, s[16:19], s46 offen lds
    v_perm_b32 v8, v105, v104, s37
    v_accvgpr_write_b32 a160, v8
    v_perm_b32 v9, v105, v104, s38
    v_accvgpr_write_b32 a164, v9
    v_perm_b32 v8, v107, v106, s37
    v_accvgpr_write_b32 a168, v8
    v_perm_b32 v9, v107, v106, s38
    v_accvgpr_write_b32 a172, v9
    s_add_u32 m0, s48, 1024
    s_mov_b32 s46, 0x3c4000
    buffer_load_dwordx4 v4, s[16:19], s46 offen lds
    v_perm_b32 v8, v109, v108, s37
    v_accvgpr_write_b32 a161, v8
    v_perm_b32 v9, v109, v108, s38
    v_accvgpr_write_b32 a165, v9
    v_perm_b32 v8, v111, v110, s37
    v_accvgpr_write_b32 a169, v8
    v_perm_b32 v9, v111, v110, s38
    v_accvgpr_write_b32 a173, v9
    s_add_u32 m0, s48, 2048
    s_mov_b32 s46, 0x3c8000
    buffer_load_dwordx4 v4, s[16:19], s46 offen lds
    v_perm_b32 v8, v113, v112, s37
    v_accvgpr_write_b32 a162, v8
    v_perm_b32 v9, v113, v112, s38
    v_accvgpr_write_b32 a166, v9
    v_perm_b32 v8, v115, v114, s37
    v_accvgpr_write_b32 a170, v8
    v_perm_b32 v9, v115, v114, s38
    v_accvgpr_write_b32 a174, v9
    s_add_u32 m0, s48, 3072
    s_mov_b32 s46, 0x3cc000
    buffer_load_dwordx4 v4, s[16:19], s46 offen lds
    v_perm_b32 v8, v117, v116, s37
    v_accvgpr_write_b32 a163, v8
    v_perm_b32 v9, v117, v116, s38
    v_accvgpr_write_b32 a167, v9
    v_perm_b32 v8, v119, v118, s37
    v_accvgpr_write_b32 a171, v8
    v_perm_b32 v9, v119, v118, s38
    v_accvgpr_write_b32 a175, v9
    s_waitcnt vmcnt(12) lgkmcnt(0)
    ds_read2st64_b32 v[104:105], v6 offset0:32 offset1:34
    ds_read2st64_b32 v[106:107], v7 offset0:32 offset1:34
    ds_read2st64_b32 v[108:109], v6 offset0:36 offset1:38
    ds_read2st64_b32 v[110:111], v7 offset0:36 offset1:38
    ds_read2st64_b32 v[112:113], v6 offset0:40 offset1:42
    ds_read2st64_b32 v[114:115], v7 offset0:40 offset1:42
    ds_read2st64_b32 v[116:117], v6 offset0:44 offset1:46
    ds_read2st64_b32 v[118:119], v7 offset0:44 offset1:46
    v_perm_b32 v8, v121, v120, s37
    v_accvgpr_write_b32 a176, v8
    v_perm_b32 v9, v121, v120, s38
    v_accvgpr_write_b32 a180, v9
    v_perm_b32 v8, v123, v122, s37
    v_accvgpr_write_b32 a184, v8
    v_perm_b32 v9, v123, v122, s38
    v_accvgpr_write_b32 a188, v9
    v_perm_b32 v8, v125, v124, s37
    v_accvgpr_write_b32 a177, v8
    v_perm_b32 v9, v125, v124, s38
    v_accvgpr_write_b32 a181, v9
    v_perm_b32 v8, v127, v126, s37
    v_accvgpr_write_b32 a185, v8
    v_perm_b32 v9, v127, v126, s38
    v_accvgpr_write_b32 a189, v9
    v_perm_b32 v8, v129, v128, s37
    v_accvgpr_write_b32 a178, v8
    v_perm_b32 v9, v129, v128, s38
    v_accvgpr_write_b32 a182, v9
    v_perm_b32 v8, v131, v130, s37
    v_accvgpr_write_b32 a186, v8
    v_perm_b32 v9, v131, v130, s38
    v_accvgpr_write_b32 a190, v9
    v_perm_b32 v8, v133, v132, s37
    v_accvgpr_write_b32 a179, v8
    v_perm_b32 v9, v133, v132, s38
    v_accvgpr_write_b32 a183, v9
    v_perm_b32 v8, v135, v134, s37
    v_accvgpr_write_b32 a187, v8
    v_perm_b32 v9, v135, v134, s38
    v_accvgpr_write_b32 a191, v9
    s_waitcnt vmcnt(8) lgkmcnt(0)
    ds_read2st64_b32 v[120:121], v6 offset0:48 offset1:50
    ds_read2st64_b32 v[122:123], v7 offset0:48 offset1:50
    ds_read2st64_b32 v[124:125], v6 offset0:52 offset1:54
    ds_read2st64_b32 v[126:127], v7 offset0:52 offset1:54
    ds_read2st64_b32 v[128:129], v6 offset0:56 offset1:58
    ds_read2st64_b32 v[130:131], v7 offset0:56 offset1:58
    ds_read2st64_b32 v[132:133], v6 offset0:60 offset1:62
    ds_read2st64_b32 v[134:135], v7 offset0:60 offset1:62
    v_perm_b32 v8, v105, v104, s37
    v_accvgpr_write_b32 a192, v8
    v_perm_b32 v9, v105, v104, s38
    v_accvgpr_write_b32 a196, v9
    v_perm_b32 v8, v107, v106, s37
    v_accvgpr_write_b32 a200, v8
    v_perm_b32 v9, v107, v106, s38
    v_accvgpr_write_b32 a204, v9
    v_perm_b32 v8, v109, v108, s37
    v_accvgpr_write_b32 a193, v8
    v_perm_b32 v9, v109, v108, s38
    v_accvgpr_write_b32 a197, v9
    v_perm_b32 v8, v111, v110, s37
    v_accvgpr_write_b32 a201, v8
    v_perm_b32 v9, v111, v110, s38
    v_accvgpr_write_b32 a205, v9
    v_perm_b32 v8, v113, v112, s37
    v_accvgpr_write_b32 a194, v8
    v_perm_b32 v9, v113, v112, s38
    v_accvgpr_write_b32 a198, v9
    v_perm_b32 v8, v115, v114, s37
    v_accvgpr_write_b32 a202, v8
    v_perm_b32 v9, v115, v114, s38
    v_accvgpr_write_b32 a206, v9
    v_perm_b32 v8, v117, v116, s37
    v_accvgpr_write_b32 a195, v8
    v_perm_b32 v9, v117, v116, s38
    v_accvgpr_write_b32 a199, v9
    v_perm_b32 v8, v119, v118, s37
    v_accvgpr_write_b32 a203, v8
    v_perm_b32 v9, v119, v118, s38
    v_accvgpr_write_b32 a207, v9
    s_waitcnt vmcnt(4) lgkmcnt(0)
    ds_read2st64_b32 v[104:105], v6 offset0:64 offset1:66
    ds_read2st64_b32 v[106:107], v7 offset0:64 offset1:66
    ds_read2st64_b32 v[108:109], v6 offset0:68 offset1:70
    ds_read2st64_b32 v[110:111], v7 offset0:68 offset1:70
    ds_read2st64_b32 v[112:113], v6 offset0:72 offset1:74
    ds_read2st64_b32 v[114:115], v7 offset0:72 offset1:74
    ds_read2st64_b32 v[116:117], v6 offset0:76 offset1:78
    ds_read2st64_b32 v[118:119], v7 offset0:76 offset1:78
    v_perm_b32 v8, v121, v120, s37
    v_accvgpr_write_b32 a208, v8
    v_perm_b32 v9, v121, v120, s38
    v_accvgpr_write_b32 a212, v9
    v_perm_b32 v8, v123, v122, s37
    v_accvgpr_write_b32 a216, v8
    v_perm_b32 v9, v123, v122, s38
    v_accvgpr_write_b32 a220, v9
    v_perm_b32 v8, v125, v124, s37
    v_accvgpr_write_b32 a209, v8
    v_perm_b32 v9, v125, v124, s38
    v_accvgpr_write_b32 a213, v9
    v_perm_b32 v8, v127, v126, s37
    v_accvgpr_write_b32 a217, v8
    v_perm_b32 v9, v127, v126, s38
    v_accvgpr_write_b32 a221, v9
    v_perm_b32 v8, v129, v128, s37
    v_accvgpr_write_b32 a210, v8
    v_perm_b32 v9, v129, v128, s38
    v_accvgpr_write_b32 a214, v9
    v_perm_b32 v8, v131, v130, s37
    v_accvgpr_write_b32 a218, v8
    v_perm_b32 v9, v131, v130, s38
    v_accvgpr_write_b32 a222, v9
    v_perm_b32 v8, v133, v132, s37
    v_accvgpr_write_b32 a211, v8
    v_perm_b32 v9, v133, v132, s38
    v_accvgpr_write_b32 a215, v9
    v_perm_b32 v8, v135, v134, s37
    v_accvgpr_write_b32 a219, v8
    v_perm_b32 v9, v135, v134, s38
    v_accvgpr_write_b32 a223, v9
    s_waitcnt vmcnt(0) lgkmcnt(0)
    ds_read2st64_b32 v[120:121], v6 offset0:0 offset1:2
    ds_read2st64_b32 v[122:123], v7 offset0:0 offset1:2
    ds_read2st64_b32 v[124:125], v6 offset0:4 offset1:6
    ds_read2st64_b32 v[126:127], v7 offset0:4 offset1:6
    ds_read2st64_b32 v[128:129], v6 offset0:8 offset1:10
    ds_read2st64_b32 v[130:131], v7 offset0:8 offset1:10
    ds_read2st64_b32 v[132:133], v6 offset0:12 offset1:14
    ds_read2st64_b32 v[134:135], v7 offset0:12 offset1:14
    v_perm_b32 v8, v105, v104, s37
    v_accvgpr_write_b32 a224, v8
    v_perm_b32 v9, v105, v104, s38
    v_accvgpr_write_b32 a228, v9
    v_perm_b32 v8, v107, v106, s37
    v_accvgpr_write_b32 a232, v8
    v_perm_b32 v9, v107, v106, s38
    v_accvgpr_write_b32 a236, v9
    v_perm_b32 v8, v109, v108, s37
    v_accvgpr_write_b32 a225, v8
    v_perm_b32 v9, v109, v108, s38
    v_accvgpr_write_b32 a229, v9
    v_perm_b32 v8, v111, v110, s37
    v_accvgpr_write_b32 a233, v8
    v_perm_b32 v9, v111, v110, s38
    v_accvgpr_write_b32 a237, v9
    v_perm_b32 v8, v113, v112, s37
    v_accvgpr_write_b32 a226, v8
    v_perm_b32 v9, v113, v112, s38
    v_accvgpr_write_b32 a230, v9
    v_perm_b32 v8, v115, v114, s37
    v_accvgpr_write_b32 a234, v8
    v_perm_b32 v9, v115, v114, s38
    v_accvgpr_write_b32 a238, v9
    v_perm_b32 v8, v117, v116, s37
    v_accvgpr_write_b32 a227, v8
    v_perm_b32 v9, v117, v116, s38
    v_accvgpr_write_b32 a231, v9
    v_perm_b32 v8, v119, v118, s37
    v_accvgpr_write_b32 a235, v8
    v_perm_b32 v9, v119, v118, s38
    v_accvgpr_write_b32 a239, v9
    s_waitcnt vmcnt(0) lgkmcnt(0)
    v_perm_b32 v8, v121, v120, s37
    v_accvgpr_write_b32 a240, v8
    v_perm_b32 v9, v121, v120, s38
    v_accvgpr_write_b32 a244, v9
    v_perm_b32 v8, v123, v122, s37
    v_accvgpr_write_b32 a248, v8
    v_perm_b32 v9, v123, v122, s38
    v_accvgpr_write_b32 a252, v9
    v_perm_b32 v8, v125, v124, s37
    v_accvgpr_write_b32 a241, v8
    v_perm_b32 v9, v125, v124, s38
    v_accvgpr_write_b32 a245, v9
    v_perm_b32 v8, v127, v126, s37
    v_accvgpr_write_b32 a249, v8
    v_perm_b32 v9, v127, v126, s38
    v_accvgpr_write_b32 a253, v9
    v_perm_b32 v8, v129, v128, s37
    v_accvgpr_write_b32 a242, v8
    v_perm_b32 v9, v129, v128, s38
    v_accvgpr_write_b32 a246, v9
    v_perm_b32 v8, v131, v130, s37
    v_accvgpr_write_b32 a250, v8
    v_perm_b32 v9, v131, v130, s38
    v_accvgpr_write_b32 a254, v9
    v_perm_b32 v8, v133, v132, s37
    v_accvgpr_write_b32 a243, v8
    v_perm_b32 v9, v133, v132, s38
    v_accvgpr_write_b32 a247, v9
    v_perm_b32 v8, v135, v134, s37
    v_accvgpr_write_b32 a251, v8
    v_perm_b32 v9, v135, v134, s38
    v_accvgpr_write_b32 a255, v9
    s_barrier
    s_mov_b32 s42, 33792
    s_lshl_b32 s44, s50, 15
    s_lshl_b32 s45, s4, 13
    s_add_u32 s44, s44, s45
    s_add_u32 s45, s42, s49
    s_add_u32 m0, s45, 0
    s_nop 0
    buffer_load_dwordx4 v0, s[24:27], s44 offen lds
    s_add_u32 m0, s45, 1056
    s_add_u32 s44, s44, 1024
    buffer_load_dwordx4 v0, s[24:27], s44 offen lds
    s_add_u32 m0, s45, 2112
    s_add_u32 s44, s44, 1024
    buffer_load_dwordx4 v0, s[24:27], s44 offen lds
    s_add_u32 m0, s45, 3168
    s_add_u32 s44, s44, 1024
    buffer_load_dwordx4 v0, s[24:27], s44 offen lds
    s_add_u32 m0, s45, 4224
    s_add_u32 s44, s44, 1024
    buffer_load_dwordx4 v0, s[24:27], s44 offen lds
    s_add_u32 m0, s45, 5280
    s_add_u32 s44, s44, 1024
    buffer_load_dwordx4 v0, s[24:27], s44 offen lds
    s_add_u32 m0, s45, 6336
    s_add_u32 s44, s44, 1024
    buffer_load_dwordx4 v0, s[24:27], s44 offen lds
    s_add_u32 m0, s45, 7392
    s_add_u32 s44, s44, 1024
    buffer_load_dwordx4 v0, s[24:27], s44 offen lds
    s_add_u32 s50, s50, s41
    s_mov_b32 s42, 67584
    s_lshl_b32 s44, s50, 15
    s_lshl_b32 s45, s4, 13
    s_add_u32 s44, s44, s45
    s_add_u32 s45, s42, s49
    s_add_u32 m0, s45, 0
    s_nop 0
    buffer_load_dwordx4 v0, s[24:27], s44 offen lds
    s_add_u32 m0, s45, 1056
    s_add_u32 s44, s44, 1024
    buffer_load_dwordx4 v0, s[24:27], s44 offen lds
    s_add_u32 m0, s45, 2112
    s_add_u32 s44, s44, 1024
    buffer_load_dwordx4 v0, s[24:27], s44 offen lds
    s_add_u32 m0, s45, 3168
    s_add_u32 s44, s44, 1024
    buffer_load_dwordx4 v0, s[24:27], s44 offen lds
    s_add_u32 m0, s45, 4224
    s_add_u32 s44, s44, 1024
    buffer_load_dwordx4 v0, s[24:27], s44 offen lds
    s_add_u32 m0, s45, 5280
    s_add_u32 s44, s44, 1024
    buffer_load_dwordx4 v0, s[24:27], s44 offen lds
    s_add_u32 m0, s45, 6336
    s_add_u32 s44, s44, 1024
    buffer_load_dwordx4 v0, s[24:27], s44 offen lds
    s_add_u32 m0, s45, 7392
    s_add_u32 s44, s44, 1024
    buffer_load_dwordx4 v0, s[24:27], s44 offen lds
    s_add_u32 s50, s50, s41
    s_mov_b32 s42, 0
    s_branch GV_in
GV_loop:
    s_cmp_lg_u32 s57, s54
    s_cbranch_scc1 GV_nd
    s_waitcnt vmcnt(0)
    s_cmp_lg_u32 s4, 0
    s_cbranch_scc1 W_rdy2_e
    v_mov_b32 v8, 128
    s_mov_b32 s60, 0
W_rdy2:
    s_sleep 4
    buffer_load_dword v9, v8, s[12:15], 0 offen sc1
    s_waitcnt vmcnt(0)
    v_readfirstlane_b32 s63, v9
    s_add_u32 s60, s60, 1
    s_cmp_ge_u32 s60, 3000000
    s_cbranch_scc1 L_fail
    s_cmp_lt_u32 s63, 256
    s_cbranch_scc1 W_rdy2
W_rdy2_e:
GV_nd:
    s_waitcnt vmcnt(13)
    s_barrier
    s_sub_u32 s59, s57, 1
    s_min_i32 s44, s57, 1
    s_max_i32 s59, s59, s44
    v_mov_b32 v8, s59
    buffer_store_dword v8, off, s[8:11], s56 sc1
GV_in:
    s_add_u32 s57, s57, 1
    v_add_u32 v72, s42, v3
    ds_read_b128 v[48:51], v72 offset:0
    ds_read_b128 v[52:55], v72 offset:16896
    ds_read_b128 v[56:59], v72 offset:64
    ds_read_b128 v[60:63], v72 offset:16960
    s_add_u32 s46, s42, 101376
    s_cmp_ge_u32 s46, 135168
    s_cselect_b32 s48, 135168, 0
    s_sub_u32 s46, s46, s48
    s_lshl_b32 s44, s50, 15
    s_lshl_b32 s45, s4, 13
    s_add_u32 s44, s44, s45
    s_add_u32 s45, s46, s49
    s_add_u32 s50, s50, s41
    s_waitcnt lgkmcnt(3)
    v_mfma_f32_16x16x32_bf16 v[16:19], v[48:51], a[0:3], 0
    v_mfma_f32_16x16x32_bf16 v[20:23], v[48:51], a[4:7], 0
    ds_read_b128 v[64:67], v72 offset:128
    v_mfma_f32_16x16x32_bf16 v[24:27], v[48:51], a[8:11], 0
    v_mfma_f32_16x16x32_bf16 v[28:31], v[48:51], a[12:15], 0
    ds_read_b128 v[68:71], v72 offset:17024
    s_waitcnt lgkmcnt(4)
    v_mfma_f32_16x16x32_bf16 v[32:35], v[52:55], a[0:3], 0
    v_mfma_f32_16x16x32_bf16 v[36:39], v[52:55], a[4:7], 0
    v_mfma_f32_16x16x32_bf16 v[40:43], v[52:55], a[8:11], 0
    v_mfma_f32_16x16x32_bf16 v[44:47], v[52:55], a[12:15], 0
    s_waitcnt lgkmcnt(3)
    v_mfma_f32_16x16x32_bf16 v[16:19], v[56:59], a[16:19], v[16:19]
    v_mfma_f32_16x16x32_bf16 v[20:23], v[56:59], a[20:23], v[20:23]
    ds_read_b128 v[48:51], v72 offset:192
    v_mfma_f32_16x16x32_bf16 v[24:27], v[56:59], a[24:27], v[24:27]
    v_mfma_f32_16x16x32_bf16 v[28:31], v[56:59], a[28:31], v[28:31]
    ds_read_b128 v[52:55], v72 offset:17088
    s_waitcnt lgkmcnt(4)
    v_mfma_f32_16x16x32_bf16 v[32:35], v[60:63], a[16:19], v[32:35]
    v_mfma_f32_16x16x32_bf16 v[36:39], v[60:63], a[20:23], v[36:39]
    s_add_u32 m0, s45, 0
    v_mfma_f32_16x16x32_bf16 v[40:43], v[60:63], a[24:27], v[40:43]
    buffer_load_dwordx4 v0, s[24:27], s44 offen lds
    v_mfma_f32_16x16x32_bf16 v[44:47], v[60:63], a[28:31], v[44:47]
    s_waitcnt lgkmcnt(3)
    v_mfma_f32_16x16x32_bf16 v[16:19], v[64:67], a[32:35], v[16:19]
    v_mfma_f32_16x16x32_bf16 v[20:23], v[64:67], a[36:39], v[20:23]
    ds_read_b128 v[56:59], v72 offset:256
    v_mfma_f32_16x16x32_bf16 v[24:27], v[64:67], a[40:43], v[24:27]
    v_mfma_f32_16x16x32_bf16 v[28:31], v[64:67], a[44:47], v[28:31]
    ds_read_b128 v[60:63], v72 offset:17152
    s_waitcnt lgkmcnt(4)
    v_mfma_f32_16x16x32_bf16 v[32:35], v[68:71], a[32:35], v[32:35]
    v_mfma_f32_16x16x32_bf16 v[36:39], v[68:71], a[36:39], v[36:39]
    s_add_u32 m0, s45, 1056
    s_add_u32 s44, s44, 1024
    v_mfma_f32_16x16x32_bf16 v[40:43], v[68:71], a[40:43], v[40:43]
    buffer_load_dwordx4 v0, s[24:27], s44 offen lds
    v_mfma_f32_16x16x32_bf16 v[44:47], v[68:71], a[44:47], v[44:47]
    s_waitcnt lgkmcnt(3)
    v_mfma_f32_16x16x32_bf16 v[16:19], v[48:51], a[48:51], v[16:19]
    v_mfma_f32_16x16x32_bf16 v[20:23], v[48:51], a[52:55], v[20:23]
    ds_read_b128 v[64:67], v72 offset:320
    v_mfma_f32_16x16x32_bf16 v[24:27], v[48:51], a[56:59], v[24:27]
    v_mfma_f32_16x16x32_bf16 v[28:31], v[48:51], a[60:63], v[28:31]
    ds_read_b128 v[68:71], v72 offset:17216
    s_waitcnt lgkmcnt(4)
    v_mfma_f32_16x16x32_bf16 v[32:35], v[52:55], a[48:51], v[32:35]
    v_mfma_f32_16x16x32_bf16 v[36:39], v[52:55], a[52:55], v[36:39]
    s_add_u32 m0, s45, 2112
    s_add_u32 s44, s44, 1024
    v_mfma_f32_16x16x32_bf16 v[40:43], v[52:55], a[56:59], v[40:43]
    buffer_load_dwordx4 v0, s[24:27], s44 offen lds
    v_mfma_f32_16x16x32_bf16 v[44:47], v[52:55], a[60:63], v[44:47]
    s_waitcnt lgkmcnt(3)
    v_mfma_f32_16x16x32_bf16 v[16:19], v[56:59], a[64:67], v[16:19]
    v_mfma_f32_16x16x32_bf16 v[20:23], v[56:59], a[68:71], v[20:23]
    ds_read_b128 v[48:51], v72 offset:384
    v_mfma_f32_16x16x32_bf16 v[24:27], v[56:59], a[72:75], v[24:27]
    v_mfma_f32_16x16x32_bf16 v[28:31], v[56:59], a[76:79], v[28:31]
    ds_read_b128 v[52:55], v72 offset:17280
    s_waitcnt lgkmcnt(4)
    v_mfma_f32_16x16x32_bf16 v[32:35], v[60:63], a[64:67], v[32:35]
    v_mfma_f32_16x16x32_bf16 v[36:39], v[60:63], a[68:71], v[36:39]
    s_add_u32 m0, s45, 3168
    s_add_u32 s44, s44, 1024
    v_mfma_f32_16x16x32_bf16 v[40:43], v[60:63], a[72:75], v[40:43]
    buffer_load_dwordx4 v0, s[24:27], s44 offen lds
    v_mfma_f32_16x16x32_bf16 v[44:47], v[60:63], a[76:79], v[44:47]
    s_waitcnt lgkmcnt(3)
    v_mfma_f32_16x16x32_bf16 v[16:19], v[64:67], a[80:83], v[16:19]
    v_mfma_f32_16x16x32_bf16 v[20:23], v[64:67], a[84:87], v[20:23]
    ds_read_b128 v[56:59], v72 offset:448
    v_mfma_f32_16x16x32_bf16 v[24:27], v[64:67], a[88:91], v[24:27]
    v_mfma_f32_16x16x32_bf16 v[28:31], v[64:67], a[92:95], v[28:31]
    ds_read_b128 v[60:63], v72 offset:17344
    s_waitcnt lgkmcnt(4)
    v_mfma_f32_16x16x32_bf16 v[32:35], v[68:71], a[80:83], v[32:35]
    v_mfma_f32_16x16x32_bf16 v[36:39], v[68:71], a[84:87], v[36:39]
    s_add_u32 m0, s45, 4224
    s_add_u32 s44, s44, 1024
    v_mfma_f32_16x16x32_bf16 v[40:43], v[68:71], a[88:91], v[40:43]
    buffer_load_dwordx4 v0, s[24:27], s44 offen lds
    v_mfma_f32_16x16x32_bf16 v[44:47], v[68:71], a[92:95], v[44:47]
    s_waitcnt lgkmcnt(3)
    v_mfma_f32_16x16x32_bf16 v[16:19], v[48:51], a[96:99], v[16:19]
    v_mfma_f32_16x16x32_bf16 v[20:23], v[48:51], a[100:103], v[20:23]
    ds_read_b128 v[64:67], v72 offset:512
    v_mfma_f32_16x16x32_bf16 v[24:27], v[48:51], a[104:107], v[24:27]
    v_mfma_f32_16x16x32_bf16 v[28:31], v[48:51], a[108:111], v[28:31]
    ds_read_b128 v[68:71], v72 offset:17408
    s_waitcnt lgkmcnt(4)
    v_mfma_f32_16x16x32_bf16 v[32:35], v[52:55], a[96:99], v[32:35]
    v_mfma_f32_16x16x32_bf16 v[36:39], v[52:55], a[100:103], v[36:39]
    s_add_u32 m0, s45, 5280
    s_add_u32 s44, s44, 1024
    v_mfma_f32_16x16x32_bf16 v[40:43], v[52:55], a[104:107], v[40:43]
    buffer_load_dwordx4 v0, s[24:27], s44 offen lds
    v_mfma_f32_16x16x32_bf16 v[44:47], v[52:55], a[108:111], v[44:47]
    s_waitcnt lgkmcnt(3)
    v_mfma_f32_16x16x32_bf16 v[16:19], v[56:59], a[112:115], v[16:19]
    v_mfma_f32_16x16x32_bf16 v[20:23], v[56:59], a[116:119], v[20:23]
    ds_read_b128 v[48:51], v72 offset:576
    v_mfma_f32_16x16x32_bf16 v[24:27], v[56:59], a[120:123], v[24:27]
    v_mfma_f32_16x16x32_bf16 v[28:31], v[56:59], a[124:127], v[28:31]
    ds_read_b128 v[52:55], v72 offset:17472
    s_waitcnt lgkmcnt(4)
    v_mfma_f32_16x16x32_bf16 v[32:35], v[60:63], a[112:115], v[32:35]
    v_mfma_f32_16x16x32_bf16 v[36:39], v[60:63], a[116:119], v[36:39]
    s_add_u32 m0, s45, 6336
    s_add_u32 s44, s44, 1024
    v_mfma_f32_16x16x32_bf16 v[40:43], v[60:63], a[120:123], v[40:43]
    buffer_load_dwordx4 v0, s[24:27], s44 offen lds
    v_mfma_f32_16x16x32_bf16 v[44:47], v[60:63], a[124:127], v[44:47]
    s_waitcnt lgkmcnt(3)
    v_mfma_f32_16x16x32_bf16 v[16:19], v[64:67], a[128:131], v[16:19]
    v_mfma_f32_16x16x32_bf16 v[20:23], v[64:67], a[132:135], v[20:23]
    ds_read_b128 v[56:59], v72 offset:640
    v_mfma_f32_16x16x32_bf16 v[24:27], v[64:67], a[136:139], v[24:27]
    v_mfma_f32_16x16x32_bf16 v[28:31], v[64:67], a[140:143], v[28:31]
    ds_read_b128 v[60:63], v72 offset:17536
    s_waitcnt lgkmcnt(4)
    v_mfma_f32_16x16x32_bf16 v[32:35], v[68:71], a[128:131], v[32:35]
    v_mfma_f32_16x16x32_bf16 v[36:39], v[68:71], a[132:135], v[36:39]
    s_add_u32 m0, s45, 7392
    s_add_u32 s44, s44, 1024
    v_mfma_f32_16x16x32_bf16 v[40:43], v[68:71], a[136:139], v[40:43]
    buffer_load_dwordx4 v0, s[24:27], s44 offen lds
    v_mfma_f32_16x16x32_bf16 v[44:47], v[68:71], a[140:143], v[44:47]
    s_waitcnt lgkmcnt(3)
    v_mfma_f32_16x16x32_bf16 v[16:19], v[48:51], a[144:147], v[16:19]
    v_mfma_f32_16x16x32_bf16 v[20:23], v[48:51], a[148:151], v[20:23]
    ds_read_b128 v[64:67], v72 offset:704
    v_mfma_f32_16x16x32_bf16 v[24:27], v[48:51], a[152:155], v[24:27]
    v_mfma_f32_16x16x32_bf16 v[28:31], v[48:51], a[156:159], v[28:31]
    ds_read_b128 v[68:71], v72 offset:17600
    s_waitcnt lgkmcnt(4)
    v_mfma_f32_16x16x32_bf16 v[32:35], v[52:55], a[144:147], v[32:35]
    v_mfma_f32_16x16x32_bf16 v[36:39], v[52:55], a[148:151], v[36:39]
    v_mfma_f32_16x16x32_bf16 v[40:43], v[52:55], a[152:155], v[40:43]
    v_mfma_f32_16x16x32_bf16 v[44:47], v[52:55], a[156:159], v[44:47]
    s_waitcnt lgkmcnt(3)
    v_mfma_f32_16x16x32_bf16 v[16:19], v[56:59], a[160:163], v[16:19]
    v_mfma_f32_16x16x32_bf16 v[20:23], v[56:59], a[164:167], v[20:23]
    ds_read_b128 v[48:51], v72 offset:768
    v_mfma_f32_16x16x32_bf16 v[24:27], v[56:59], a[168:171], v[24:27]
    v_mfma_f32_16x16x32_bf16 v[28:31], v[56:59], a[172:175], v[28:31]
    ds_read_b128 v[52:55], v72 offset:17664
    s_waitcnt lgkmcnt(4)
    v_mfma_f32_16x16x32_bf16 v[32:35], v[60:63], a[160:163], v[32:35]
    v_mfma_f32_16x16x32_bf16 v[36:39], v[60:63], a[164:167], v[36:39]
    v_mfma_f32_16x16x32_bf16 v[40:43], v[60:63], a[168:171], v[40:43]
    v_mfma_f32_16x16x32_bf16 v[44:47], v[60:63], a[172:175], v[44:47]
    s_waitcnt lgkmcnt(3)
    v_mfma_f32_16x16x32_bf16 v[16:19], v[64:67], a[176:179], v[16:19]
    v_mfma_f32_16x16x32_bf16 v[20:23], v[64:67], a[180:183], v[20:23]
    ds_read_b128 v[56:59], v72 offset:832
    v_mfma_f32_16x16x32_bf16 v[24:27], v[64:67], a[184:187], v[24:27]
    v_mfma_f32_16x16x32_bf16 v[28:31], v[64:67], a[188:191], v[28:31]
    ds_read_b128 v[60:63], v72 offset:17728
    s_waitcnt lgkmcnt(4)
    v_mfma_f32_16x16x32_bf16 v[32:35], v[68:71], a[176:179], v[32:35]
    v_mfma_f32_16x16x32_bf16 v[36:39], v[68:71], a[180:183], v[36:39]
    v_mfma_f32_16x16x32_bf16 v[40:43], v[68:71], a[184:187], v[40:43]
    v_mfma_f32_16x16x32_bf16 v[44:47], v[68:71], a[188:191], v[44:47]
    s_waitcnt lgkmcnt(3)
    v_mfma_f32_16x16x32_bf16 v[16:19], v[48:51], a[192:195], v[16:19]
    v_mfma_f32_16x16x32_bf16 v[20:23], v[48:51], a[196:199], v[20:23]
    ds_read_b128 v[64:67], v72 offset:896
    v_mfma_f32_16x16x32_bf16 v[24:27], v[48:51], a[200:203], v[24:27]
    v_mfma_f32_16x16x32_bf16 v[28:31], v[48:51], a[204:207], v[28:31]
    ds_read_b128 v[68:71], v72 offset:17792
    s_waitcnt lgkmcnt(4)
    v_mfma_f32_16x16x32_bf16 v[32:35], v[52:55], a[192:195], v[32:35]
    v_mfma_f32_16x16x32_bf16 v[36:39], v[52:55], a[196:199], v[36:39]
    v_mfma_f32_16x16x32_bf16 v[40:43], v[52:55], a[200:203], v[40:43]
    v_mfma_f32_16x16x32_bf16 v[44:47], v[52:55], a[204:207], v[44:47]
    s_waitcnt lgkmcnt(3)
    v_mfma_f32_16x16x32_bf16 v[16:19], v[56:59], a[208:211], v[16:19]
    v_mfma_f32_16x16x32_bf16 v[20:23], v[56:59], a[212:215], v[20:23]
    ds_read_b128 v[48:51], v72 offset:960
    v_mfma_f32_16x16x32_bf16 v[24:27], v[56:59], a[216:219], v[24:27]
    v_mfma_f32_16x16x32_bf16 v[28:31], v[56:59], a[220:223], v[28:31]
    ds_read_b128 v[52:55], v72 offset:17856
    s_waitcnt lgkmcnt(4)
    v_mfma_f32_16x16x32_bf16 v[32:35], v[60:63], a[208:211], v[32:35]
    v_mfma_f32_16x16x32_bf16 v[36:39], v[60:63], a[212:215], v[36:39]
    v_mfma_f32_16x16x32_bf16 v[40:43], v[60:63], a[216:219], v[40:43]
    v_mfma_f32_16x16x32_bf16 v[44:47], v[60:63], a[220:223], v[44:47]
    s_waitcnt lgkmcnt(3)
    v_mfma_f32_16x16x32_bf16 v[16:19], v[64:67], a[224:227], v[16:19]
    v_mfma_f32_16x16x32_bf16 v[20:23], v[64:67], a[228:231], v[20:23]
    v_mfma_f32_16x16x32_bf16 v[24:27], v[64:67], a[232:235], v[24:27]
    v_mfma_f32_16x16x32_bf16 v[28:31], v[64:67], a[236:239], v[28:31]
    s_waitcnt lgkmcnt(2)
    v_mfma_f32_16x16x32_bf16 v[32:35], v[68:71], a[224:227], v[32:35]
    v_mfma_f32_16x16x32_bf16 v[36:39], v[68:71], a[228:231], v[36:39]
    v_mfma_f32_16x16x32_bf16 v[40:43], v[68:71], a[232:235], v[40:43]
    v_mfma_f32_16x16x32_bf16 v[44:47], v[68:71], a[236:239], v[44:47]
    s_waitcnt lgkmcnt(1)
    v_mfma_f32_16x16x32_bf16 v[16:19], v[48:51], a[240:243], v[16:19]
    v_mfma_f32_16x16x32_bf16 v[20:23], v[48:51], a[244:247], v[20:23]
    v_mfma_f32_16x16x32_bf16 v[24:27], v[48:51], a[248:251], v[24:27]
    v_mfma_f32_16x16x32_bf16 v[28:31], v[48:51], a[252:255], v[28:31]
    s_waitcnt lgkmcnt(0)
    v_mfma_f32_16x16x32_bf16 v[32:35], v[52:55], a[240:243], v[32:35]
    v_mfma_f32_16x16x32_bf16 v[36:39], v[52:55], a[244:247], v[36:39]
    v_mfma_f32_16x16x32_bf16 v[40:43], v[52:55], a[248:251], v[40:43]
    v_mfma_f32_16x16x32_bf16 v[44:47], v[52:55], a[252:255], v[44:47]
    s_cmp_lg_u32 s57, s98
    s_cbranch_scc1 GV_np
    s_load_dwordx2 s[20:21], s[0:1], 80
    s_mov_b32 s22, 0x158000
    s_mov_b32 s23, 0x20000
    s_and_b32 s44, s6, 15
    s_lshl_b32 s44, s44, 6
    v_lshlrev_b32 v4, 13, v2
    v_lshl_add_u32 v4, v1, 2, v4
    v_add_u32 v4, s44, v4
    v_add_u32 v5, 1024, v4
    s_mul_i32 s45, s4, 0x58000
    s_waitcnt lgkmcnt(0)
    s_add_u32 s46, s45, 0x0
    buffer_load_dword v104, v4, s[20:23], s46 offen
    buffer_load_dword v105, v5, s[20:23], s46 offen
    s_add_u32 s46, s45, 0x800
    buffer_load_dword v106, v4, s[20:23], s46 offen
    buffer_load_dword v107, v5, s[20:23], s46 offen
    s_add_u32 s46, s45, 0x1000
    buffer_load_dword v108, v4, s[20:23], s46 offen
    buffer_load_dword v109, v5, s[20:23], s46 offen
    s_add_u32 s46, s45, 0x1800
    buffer_load_dword v110, v4, s[20:23], s46 offen
    buffer_load_dword v111, v5, s[20:23], s46 offen
    s_add_u32 s46, s45, 0x8000
    buffer_load_dword v112, v4, s[20:23], s46 offen
    buffer_load_dword v113, v5, s[20:23], s46 offen
    s_add_u32 s46, s45, 0x8800
    buffer_load_dword v114, v4, s[20:23], s46 offen
    buffer_load_dword v115, v5, s[20:23], s46 offen
    s_add_u32 s46, s45, 0x9000
    buffer_load_dword v116, v4, s[20:23], s46 offen
    buffer_load_dword v117, v5, s[20:23], s46 offen
    s_add_u32 s46, s45, 0x9800
    buffer_load_dword v118, v4, s[20:23], s46 offen
    buffer_load_dword v119, v5, s[20:23], s46 offen
    s_add_u32 s46, s45, 0x10000
    buffer_load_dword v120, v4, s[20:23], s46 offen
    buffer_load_dword v121, v5, s[20:23], s46 offen
    s_add_u32 s46, s45, 0x10800
    buffer_load_dword v122, v4, s[20:23], s46 offen
    buffer_load_dword v123, v5, s[20:23], s46 offen
    s_add_u32 s46, s45, 0x11000
    buffer_load_dword v124, v4, s[20:23], s46 offen
    buffer_load_dword v125, v5, s[20:23], s46 offen
    s_add_u32 s46, s45, 0x11800
    buffer_load_dword v126, v4, s[20:23], s46 offen
    buffer_load_dword v127, v5, s[20:23], s46 offen
    s_add_u32 s46, s45, 0x18000
    buffer_load_dword v128, v4, s[20:23], s46 offen
    buffer_load_dword v129, v5, s[20:23], s46 offen
    s_add_u32 s46, s45, 0x18800
    buffer_load_dword v130, v4, s[20:23], s46 offen
    buffer_load_dword v131, v5, s[20:23], s46 offen
    s_add_u32 s46, s45, 0x19000
    buffer_load_dword v132, v4, s[20:23], s46 offen
    buffer_load_dword v133, v5, s[20:23], s46 offen
    s_add_u32 s46, s45, 0x19800
    buffer_load_dword v134, v4, s[20:23], s46 offen
    buffer_load_dword v135, v5, s[20:23], s46 offen
    s_add_u32 s46, s45, 0x20000
    buffer_load_dword v136, v4, s[20:23], s46 offen
    buffer_load_dword v137, v5, s[20:23], s46 offen
    s_add_u32 s46, s45, 0x20800
    buffer_load_dword v138, v4, s[20:23], s46 offen
    buffer_load_dword v139, v5, s[20:23], s46 offen
    s_add_u32 s46, s45, 0x21000
    buffer_load_dword v140, v4, s[20:23], s46 offen
    buffer_load_dword v141, v5, s[20:23], s46 offen
    s_add_u32 s46, s45, 0x21800
    buffer_load_dword v142, v4, s[20:23], s46 offen
    buffer_load_dword v143, v5, s[20:23], s46 offen
    s_add_u32 s46, s45, 0x28000
    buffer_load_dword v144, v4, s[20:23], s46 offen
    buffer_load_dword v145, v5, s[20:23], s46 offen
    s_add_u32 s46, s45, 0x28800
    buffer_load_dword v146, v4, s[20:23], s46 offen
    buffer_load_dword v147, v5, s[20:23], s46 offen
    s_add_u32 s46, s45, 0x29000
    buffer_load_dword v148, v4, s[20:23], s46 offen
    buffer_load_dword v149, v5, s[20:23], s46 offen
    s_add_u32 s46, s45, 0x29800
    buffer_load_dword v150, v4, s[20:23], s46 offen
    buffer_load_dword v151, v5, s[20:23], s46 offen
    s_waitcnt vmcnt(46)
    v_perm_b32 v168, v105, v104, s37
    v_perm_b32 v172, v105, v104, s38
    s_add_u32 s46, s45, 0x30000
    buffer_load_dword v152, v4, s[20:23], s46 offen
    buffer_load_dword v153, v5, s[20:23], s46 offen
    s_add_u32 s46, s45, 0x30800
    buffer_load_dword v154, v4, s[20:23], s46 offen
    buffer_load_dword v155, v5, s[20:23], s46 offen
    s_add_u32 s46, s45, 0x31000
    buffer_load_dword v156, v4, s[20:23], s46 offen
    buffer_load_dword v157, v5, s[20:23], s46 offen
    s_add_u32 s46, s45, 0x31800
    buffer_load_dword v158, v4, s[20:23], s46 offen
    buffer_load_dword v159, v5, s[20:23], s46 offen
    s_add_u32 s46, s45, 0x38000
    buffer_load_dword v160, v4, s[20:23], s46 offen
    buffer_load_dword v161, v5, s[20:23], s46 offen
    s_add_u32 s46, s45, 0x38800
    buffer_load_dword v162, v4, s[20:23], s46 offen
    buffer_load_dword v163, v5, s[20:23], s46 offen
    s_add_u32 s46, s45, 0x39000
    buffer_load_dword v164, v4, s[20:23], s46 offen
    buffer_load_dword v165, v5, s[20:23], s46 offen
    s_waitcnt vmcnt(58)
    v_perm_b32 v169, v107, v106, s37
    v_perm_b32 v173, v107, v106, s38
    s_add_u32 s46, s45, 0x39800
    buffer_load_dword v166, v4, s[20:23], s46 offen
    buffer_load_dword v167, v5, s[20:23], s46 offen
    s_waitcnt vmcnt(58)
    v_perm_b32 v170, v109, v108, s37
    v_perm_b32 v174, v109, v108, s38
    s_add_u32 s46, s45, 0x40000
    buffer_load_dword v104, v4, s[20:23], s46 offen
    buffer_load_dword v105, v5, s[20:23], s46 offen
    s_waitcnt vmcnt(58)
    v_perm_b32 v171, v111, v110, s37
    v_perm_b32 v175, v111, v110, s38
    s_add_u32 s46, s45, 0x40800
    buffer_load_dword v106, v4, s[20:23], s46 offen
    buffer_load_dword v107, v5, s[20:23], s46 offen
    s_waitcnt vmcnt(58)
    v_perm_b32 v176, v113, v112, s37
    v_perm_b32 v180, v113, v112, s38
    s_add_u32 s46, s45, 0x41000
    buffer_load_dword v108, v4, s[20:23], s46 offen
    buffer_load_dword v109, v5, s[20:23], s46 offen
    s_waitcnt vmcnt(58)
    v_perm_b32 v177, v115, v114, s37
    v_perm_b32 v181, v115, v114, s38
    s_add_u32 s46, s45, 0x41800
    buffer_load_dword v110, v4, s[20:23], s46 offen
    buffer_load_dword v111, v5, s[20:23], s46 offen
    s_waitcnt vmcnt(58)
    v_perm_b32 v178, v117, v116, s37
    v_perm_b32 v182, v117, v116, s38
    s_add_u32 s46, s45, 0x48000
    buffer_load_dword v112, v4, s[20:23], s46 offen
    buffer_load_dword v113, v5, s[20:23], s46 offen
    s_waitcnt vmcnt(58)
    v_perm_b32 v179, v119, v118, s37
    v_perm_b32 v183, v119, v118, s38
    s_add_u32 s46, s45, 0x48800
    buffer_load_dword v114, v4, s[20:23], s46 offen
    buffer_load_dword v115, v5, s[20:23], s46 offen
    s_waitcnt vmcnt(58)
    v_perm_b32 v184, v121, v120, s37
    v_perm_b32 v188, v121, v120, s38
    s_add_u32 s46, s45, 0x49000
    buffer_load_dword v116, v4, s[20:23], s46 offen
    buffer_load_dword v117, v5, s[20:23], s46 offen
    s_waitcnt vmcnt(58)
    v_perm_b32 v185, v123, v122, s37
    v_perm_b32 v189, v123, v122, s38
    s_add_u32 s46, s45, 0x49800
    buffer_load_dword v118, v4, s[20:23], s46 offen
    buffer_load_dword v119, v5, s[20:23], s46 offen
    s_waitcnt vmcnt(58)
    v_perm_b32 v186, v125, v124, s37
    v_perm_b32 v190, v125, v124, s38
    s_add_u32 s46, s45, 0x50000
    buffer_load_dword v120, v4, s[20:23], s46 offen
    buffer_load_dword v121, v5, s[20:23], s46 offen
    s_waitcnt vmcnt(58)
    v_perm_b32 v187, v127, v126, s37
    v_perm_b32 v191, v127, v126, s38
    s_add_u32 s46, s45, 0x50800
    buffer_load_dword v122, v4, s[20:23], s46 offen
    buffer_load_dword v123, v5, s[20:23], s46 offen
    s_waitcnt vmcnt(58)
    v_perm_b32 v192, v129, v128, s37
    v_perm_b32 v196, v129, v128, s38
    s_add_u32 s46, s45, 0x51000
    buffer_load_dword v124, v4, s[20:23], s46 offen
    buffer_load_dword v125, v5, s[20:23], s46 offen
    s_waitcnt vmcnt(58)
    v_perm_b32 v193, v131, v130, s37
    v_perm_b32 v197, v131, v130, s38
    s_add_u32 s46, s45, 0x51800
    buffer_load_dword v126, v4, s[20:23], s46 offen
    buffer_load_dword v127, v5, s[20:23], s46 offen
    s_waitcnt vmcnt(58)
    v_perm_b32 v194, v133, v132, s37
    v_perm_b32 v198, v133, v132, s38
    s_waitcnt vmcnt(56)
    v_perm_b32 v195, v135, v134, s37
    v_perm_b32 v199, v135, v134, s38
    s_waitcnt vmcnt(54)
    v_perm_b32 v200, v137, v136, s37
    v_perm_b32 v204, v137, v136, s38
    s_waitcnt vmcnt(52)
    v_perm_b32 v201, v139, v138, s37
    v_perm_b32 v205, v139, v138, s38
    s_waitcnt vmcnt(50)
    v_perm_b32 v202, v141, v140, s37
    v_perm_b32 v206, v141, v140, s38
    s_waitcnt vmcnt(48)
    v_perm_b32 v203, v143, v142, s37
    v_perm_b32 v207, v143, v142, s38
    s_waitcnt vmcnt(46)
    v_perm_b32 v208, v145, v144, s37
    v_perm_b32 v212, v145, v144, s38
    s_waitcnt vmcnt(44)
    v_perm_b32 v209, v147, v146, s37
    v_perm_b32 v213, v147, v146, s38
    s_waitcnt vmcnt(42)
    v_perm_b32 v210, v149, v148, s37
    v_perm_b32 v214, v149, v148, s38
    s_waitcnt vmcnt(40)
    v_perm_b32 v211, v151, v150, s37
    v_perm_b32 v215, v151, v150, s38
    s_waitcnt vmcnt(38)
    v_perm_b32 v216, v153, v152, s37
    v_perm_b32 v220, v153, v152, s38
    s_waitcnt vmcnt(36)
    v_perm_b32 v217, v155, v154, s37
    v_perm_b32 v221, v155, v154, s38
    s_waitcnt vmcnt(34)
    v_perm_b32 v218, v157, v156, s37
    v_perm_b32 v222, v157, v156, s38
    s_waitcnt vmcnt(32)
    v_perm_b32 v219, v159, v158, s37
    v_perm_b32 v223, v159, v158, s38
    s_waitcnt vmcnt(30)
    v_perm_b32 v224, v161, v160, s37
    v_perm_b32 v228, v161, v160, s38
    s_waitcnt vmcnt(28)
    v_perm_b32 v225, v163, v162, s37
    v_perm_b32 v229, v163, v162, s38
    s_waitcnt vmcnt(26)
    v_perm_b32 v226, v165, v164, s37
    v_perm_b32 v230, v165, v164, s38
    s_waitcnt vmcnt(24)
    v_perm_b32 v227, v167, v166, s37
    v_perm_b32 v231, v167, v166, s38
    s_waitcnt vmcnt(22)
    v_perm_b32 v232, v105, v104, s37
    v_perm_b32 v236, v105, v104, s38
    s_waitcnt vmcnt(20)
    v_perm_b32 v233, v107, v106, s37
    v_perm_b32 v237, v107, v106, s38
    s_waitcnt vmcnt(18)
    v_perm_b32 v234, v109, v108, s37
    v_perm_b32 v238, v109, v108, s38
    s_waitcnt vmcnt(16)
    v_perm_b32 v235, v111, v110, s37
    v_perm_b32 v239, v111, v110, s38
    s_waitcnt vmcnt(14)
    v_perm_b32 v240, v113, v112, s37
    v_perm_b32 v244, v113, v112, s38
    s_waitcnt vmcnt(12)
    v_perm_b32 v241, v115, v114, s37
    v_perm_b32 v245, v115, v114, s38
    s_waitcnt vmcnt(10)
    v_perm_b32 v242, v117, v116, s37
    v_perm_b32 v246, v117, v116, s38
    s_waitcnt vmcnt(8)
    v_perm_b32 v243, v119, v118, s37
    v_perm_b32 v247, v119, v118, s38
    s_waitcnt vmcnt(6)
    v_perm_b32 v248, v121, v120, s37
    v_perm_b32 v252, v121, v120, s38
    s_waitcnt vmcnt(4)
    v_perm_b32 v249, v123, v122, s37
    v_perm_b32 v253, v123, v122, s38
    s_waitcnt vmcnt(2)
    v_perm_b32 v250, v125, v124, s37
    v_perm_b32 v254, v125, v124, s38
    s_waitcnt vmcnt(0)
    v_perm_b32 v251, v127, v126, s37
    v_perm_b32 v255, v127, v126, s38
    s_cmp_lg_u32 s4, 0
    s_cbranch_scc1 GV_pz_e
    v_and_b32 v8, 0x1f0, v0
    v_lshrrev_b32 v8, 2, v8
    s_mov_b32 s62, 0
GV_pz:
    buffer_load_dword v9, v8, s[8:11], 0 offen offset:2048 sc1
    s_waitcnt vmcnt(0)
    v_cmp_gt_i32 vcc, 1, v9
    s_cbranch_vccz GV_pz_ok
    s_sleep 8
    s_add_u32 s62, s62, 1
    s_cmp_lt_u32 s62, 3000000
    s_cbranch_scc1 GV_pz
    s_branch L_fail
GV_pz_ok:
GV_pz_e:
    s_barrier
GV_np:
    s_mul_i32 s44, s40, s51
    s_add_u32 s44, s44, s43
    v_cvt_pk_bf16_f32 v76, v16, v17
    v_cvt_pk_bf16_f32 v77, v18, v19
    v_cvt_pk_bf16_f32 v78, v32, v33
    v_cvt_pk_bf16_f32 v79, v34, v35
    buffer_store_dwordx4 v[76:79], v0, s[8:11], s44 offen offset:0 sc1
    v_cvt_pk_bf16_f32 v80, v20, v21
    v_cvt_pk_bf16_f32 v81, v22, v23
    v_cvt_pk_bf16_f32 v82, v36, v37
    v_cvt_pk_bf16_f32 v83, v38, v39
    buffer_store_dwordx4 v[80:83], v0, s[8:11], s44 offen offset:1024 sc1
    v_cvt_pk_bf16_f32 v84, v24, v25
    v_cvt_pk_bf16_f32 v85, v26, v27
    v_cvt_pk_bf16_f32 v86, v40, v41
    v_cvt_pk_bf16_f32 v87, v42, v43
    buffer_store_dwordx4 v[84:87], v0, s[8:11], s44 offen offset:2048 sc1
    v_cvt_pk_bf16_f32 v88, v28, v29
    v_cvt_pk_bf16_f32 v89, v30, v31
    v_cvt_pk_bf16_f32 v90, v44, v45
    v_cvt_pk_bf16_f32 v91, v46, v47
    buffer_store_dwordx4 v[88:91], v0, s[8:11], s44 offen offset:3072 sc1
    s_add_u32 s42, s42, 33792
    s_cmp_ge_u32 s42, 135168
    s_cselect_b32 s42, 0, s42
    s_add_u32 s40, s40, s41
    s_cmp_lt_u32 s40, 64
    s_cbranch_scc1 GV_loop
W_r1done:
    s_waitcnt vmcnt(0)
    s_barrier
    v_mov_b32 v8, 100
    buffer_store_dword v8, off, s[8:11], s56 sc1
    s_mov_b32 s98, -1
    s_mov_b32 s56, 0x7fffff00
    s_mov_b32 s58, 0x70000000
    s_mov_b32 s54, 99
    s_mov_b32 s95, 64
    s_cmp_ge_u32 s6, 184
    s_cbranch_scc1 W_r2done
    s_cmp_ge_u32 s6, 96
    s_cbranch_scc1 W_ffn
    s_mul_i32 s44, s52, 6
    s_sub_u32 s40, s6, s44
    s_load_dwordx2 s[16:17], s[0:1], 16
    s_mov_b32 s18, 0x400000
    s_mov_b32 s19, 0x20000
    s_load_dwordx2 s[20:21], s[0:1], 16
    s_mov_b32 s22, 0x400000
    s_mov_b32 s23, 0x20000
    s_lshl_b32 s44, s52, 9
    s_lshl_b32 s45, s4, 7
    s_add_u32 s44, s44, s45
    s_mov_b32 s55, s44
    v_mul_u32_u24 v4, 65536, v2
    v_lshl_add_u32 v4, v1, 2, v4
    v_add_u32 v4, s44, v4
    v_add_u32 v5, 8192, v4
    v_mov_b32 v6, v4
    v_mov_b32 v7, v5
    s_lshl_b32 s43, s52, 14
    s_lshr_b32 s45, s4, 1
    s_lshl_b32 s45, s45, 13
    s_add_u32 s43, s43, s45
    s_and_b32 s45, s4, 1
    s_lshl_b32 s45, s45, 11
    s_add_u32 s43, s43, s45
    s_add_u32 s43, s43, 0x1000000
    s_mov_b32 s51, 0x40000
    s_waitcnt lgkmcnt(0)
    s_branch W_kq
W_ffn:
    s_load_dwordx2 s[16:17], s[0:1], 64
    s_mov_b32 s18, 0x158000
    s_mov_b32 s19, 0x20000
    s_load_dwordx2 s[20:21], s[0:1], 72
    s_mov_b32 s22, 0x158000
    s_mov_b32 s23, 0x20000
    s_and_b32 s40, s6, 7
    s_mov_b32 s41, 8
    s_sub_u32 s53, s6, 96
    s_lshr_b32 s53, s53, 3
    s_lshl_b32 s53, s53, 2
    s_add_u32 s53, s53, s4
    s_min_u32 s53, s53, 42
    s_lshl_b32 s44, s53, 6
    s_mov_b32 s55, s44
    v_mul_u32_u24 v4, 22016, v2
    v_lshl_add_u32 v4, v1, 2, v4
    v_add_u32 v4, s44, v4
    v_add_u32 v5, 2752, v4
    v_mov_b32 v6, v4
    v_mov_b32 v7, v5
    s_lshl_b32 s43, s53, 10
    s_add_u32 s43, s43, 0x5000000
    s_mov_b32 s51, 0x15800
    s_waitcnt lgkmcnt(0)
    v_lshrrev_b32 v10, 4, v0
    v_mul_u32_u24 v10, 2752, v10
    v_add_u32 v10, s55, v10
    s_mul_i32 s46, s40, 0x2b000
    s_mov_b32 s45, 0x12d000
    buffer_load_dword v11, v10, s[16:19], s46 offen
    buffer_load_dword v11, v10, s[16:19], s45 offen
    buffer_load_dword v11, v10, s[20:23], s46 offen
    buffer_load_dword v11, v10, s[20:23], s45 offen
    s_barrier
    s_mov_b32 s50, s40
    s_mov_b32 s57, 0
    s_mov_b32 s42, 0
    s_lshl_b32 s44, s50, 15
    s_lshl_b32 s45, s4, 13
    s_add_u32 s44, s44, s45
    s_add_u32 s45, s42, s49
    s_add_u32 m0, s45, 0
    s_nop 0
    buffer_load_dwordx4 v0, s[24:27], s44 offen lds
    s_add_u32 m0, s45, 1056
    s_add_u32 s44, s44, 1024
    buffer_load_dwordx4 v0, s[24:27], s44 offen lds
    s_add_u32 m0, s45, 2112
    s_add_u32 s44, s44, 1024
    buffer_load_dwordx4 v0, s[24:27], s44 offen lds
    s_add_u32 m0, s45, 3168
    s_add_u32 s44, s44, 1024
    buffer_load_dwordx4 v0, s[24:27], s44 offen lds
    s_add_u32 m0, s45, 4224
    s_add_u32 s44, s44, 1024
    buffer_load_dwordx4 v0, s[24:27], s44 offen lds
    s_add_u32 m0, s45, 5280
    s_add_u32 s44, s44, 1024
    buffer_load_dwordx4 v0, s[24:27], s44 offen lds
    s_add_u32 m0, s45, 6336
    s_add_u32 s44, s44, 1024
    buffer_load_dwordx4 v0, s[24:27], s44 offen lds
    s_add_u32 m0, s45, 7392
    s_add_u32 s44, s44, 1024
    buffer_load_dwordx4 v0, s[24:27], s44 offen lds
    s_add_u32 s50, s50, s41
    s_mov_b32 s42, 33792
    s_lshl_b32 s44, s50, 15
    s_lshl_b32 s45, s4, 13
    s_add_u32 s44, s44, s45
    s_add_u32 s45, s42, s49
    s_add_u32 m0, s45, 0
    s_nop 0
    buffer_load_dwordx4 v0, s[24:27], s44 offen lds
    s_add_u32 m0, s45, 1056
    s_add_u32 s44, s44, 1024
    buffer_load_dwordx4 v0, s[24:27], s44 offen lds
    s_add_u32 m0, s45, 2112
    s_add_u32 s44, s44, 1024
    buffer_load_dwordx4 v0, s[24:27], s44 offen lds
    s_add_u32 m0, s45, 3168
    s_add_u32 s44, s44, 1024
    buffer_load_dwordx4 v0, s[24:27], s44 offen lds
    s_add_u32 m0, s45, 4224
    s_add_u32 s44, s44, 1024
    buffer_load_dwordx4 v0, s[24:27], s44 offen lds
    s_add_u32 m0, s45, 5280
    s_add_u32 s44, s44, 1024
    buffer_load_dwordx4 v0, s[24:27], s44 offen lds
    s_add_u32 m0, s45, 6336
    s_add_u32 s44, s44, 1024
    buffer_load_dwordx4 v0, s[24:27], s44 offen lds
    s_add_u32 m0, s45, 7392
    s_add_u32 s44, s44, 1024
    buffer_load_dwordx4 v0, s[24:27], s44 offen lds
    s_add_u32 s50, s50, s41
    s_mov_b32 s42, 67584
    s_lshl_b32 s44, s50, 15
    s_lshl_b32 s45, s4, 13
    s_add_u32 s44, s44, s45
    s_add_u32 s45, s42, s49
    s_add_u32 m0, s45, 0
    s_nop 0
    buffer_load_dwordx4 v0, s[24:27], s44 offen lds
    s_add_u32 m0, s45, 1056
    s_add_u32 s44, s44, 1024
    buffer_load_dwordx4 v0, s[24:27], s44 offen lds
    s_add_u32 m0, s45, 2112
    s_add_u32 s44, s44, 1024
    buffer_load_dwordx4 v0, s[24:27], s44 offen lds
    s_add_u32 m0, s45, 3168
    s_add_u32 s44, s44, 1024
    buffer_load_dwordx4 v0, s[24:27], s44 offen lds
    s_add_u32 m0, s45, 4224
    s_add_u32 s44, s44, 1024
    buffer_load_dwordx4 v0, s[24:27], s44 offen lds
    s_add_u32 m0, s45, 5280
    s_add_u32 s44, s44, 1024
    buffer_load_dwordx4 v0, s[24:27], s44 offen lds
    s_add_u32 m0, s45, 6336
    s_add_u32 s44, s44, 1024
    buffer_load_dwordx4 v0, s[24:27], s44 offen lds
    s_add_u32 m0, s45, 7392
    s_add_u32 s44, s44, 1024
    buffer_load_dwordx4 v0, s[24:27], s44 offen lds
    s_add_u32 s50, s50, s41
    s_add_u32 s46, s47, 0x0
    buffer_load_dword v104, v4, s[16:19], s46 offen
    buffer_load_dword v105, v5, s[16:19], s46 offen
    buffer_load_dword v106, v6, s[20:23], s46 offen offset:0
    buffer_load_dword v107, v7, s[20:23], s46 offen offset:0
    s_add_u32 s46, s47, 0x1580
    buffer_load_dword v108, v4, s[16:19], s46 offen
    buffer_load_dword v109, v5, s[16:19], s46 offen
    buffer_load_dword v110, v6, s[20:23], s46 offen offset:0
    buffer_load_dword v111, v7, s[20:23], s46 offen offset:0
    s_add_u32 s46, s47, 0x2b00
    buffer_load_dword v112, v4, s[16:19], s46 offen
    buffer_load_dword v113, v5, s[16:19], s46 offen
    buffer_load_dword v114, v6, s[20:23], s46 offen offset:0
    buffer_load_dword v115, v7, s[20:23], s46 offen offset:0
    s_add_u32 s46, s47, 0x4080
    buffer_load_dword v116, v4, s[16:19], s46 offen
    buffer_load_dword v117, v5, s[16:19], s46 offen
    buffer_load_dword v118, v6, s[20:23], s46 offen offset:0
    buffer_load_dword v119, v7, s[20:23], s46 offen offset:0
    s_add_u32 s46, s47, 0x15800
    buffer_load_dword v120, v4, s[16:19], s46 offen
    buffer_load_dword v121, v5, s[16:19], s46 offen
    buffer_load_dword v122, v6, s[20:23], s46 offen offset:0
    buffer_load_dword v123, v7, s[20:23], s46 offen offset:0
    s_waitcnt vmcnt(16)
    v_perm_b32 v8, v105, v104, s37
    v_accvgpr_write_b32 a0, v8
    v_perm_b32 v9, v105, v104, s38
    v_accvgpr_write_b32 a4, v9
    v_perm_b32 v8, v107, v106, s37
    v_accvgpr_write_b32 a8, v8
    v_perm_b32 v9, v107, v106, s38
    v_accvgpr_write_b32 a12, v9
    s_add_u32 s46, s47, 0x16d80
    buffer_load_dword v124, v4, s[16:19], s46 offen
    buffer_load_dword v125, v5, s[16:19], s46 offen
    buffer_load_dword v126, v6, s[20:23], s46 offen offset:0
    buffer_load_dword v127, v7, s[20:23], s46 offen offset:0
    s_add_u32 s46, s47, 0x18300
    buffer_load_dword v128, v4, s[16:19], s46 offen
    buffer_load_dword v129, v5, s[16:19], s46 offen
    buffer_load_dword v130, v6, s[20:23], s46 offen offset:0
    buffer_load_dword v131, v7, s[20:23], s46 offen offset:0
    s_add_u32 s46, s47, 0x19880
    buffer_load_dword v132, v4, s[16:19], s46 offen
    buffer_load_dword v133, v5, s[16:19], s46 offen
    buffer_load_dword v134, v6, s[20:23], s46 offen offset:0
    buffer_load_dword v135, v7, s[20:23], s46 offen offset:0
    s_add_u32 s46, s47, 0x2b000
    buffer_load_dword v136, v4, s[16:19], s46 offen
    buffer_load_dword v137, v5, s[16:19], s46 offen
    buffer_load_dword v138, v6, s[20:23], s46 offen offset:0
    buffer_load_dword v139, v7, s[20:23], s46 offen offset:0
    s_add_u32 s46, s47, 0x2c580
    buffer_load_dword v140, v4, s[16:19], s46 offen
    buffer_load_dword v141, v5, s[16:19], s46 offen
    buffer_load_dword v142, v6, s[20:23], s46 offen offset:0
    buffer_load_dword v143, v7, s[20:23], s46 offen offset:0
    s_add_u32 s46, s47, 0x2db00
    buffer_load_dword v144, v4, s[16:19], s46 offen
    buffer_load_dword v145, v5, s[16:19], s46 offen
    buffer_load_dword v146, v6, s[20:23], s46 offen offset:0
    buffer_load_dword v147, v7, s[20:23], s46 offen offset:0
    s_add_u32 s46, s47, 0x2f080
    buffer_load_dword v148, v4, s[16:19], s46 offen
    buffer_load_dword v149, v5, s[16:19], s46 offen
    buffer_load_dword v150, v6, s[20:23], s46 offen offset:0
    buffer_load_dword v151, v7, s[20:23], s46 offen offset:0
    s_add_u32 s46, s47, 0x40800
    buffer_load_dword v152, v4, s[16:19], s46 offen
    buffer_load_dword v153, v5, s[16:19], s46 offen
    buffer_load_dword v154, v6, s[20:23], s46 offen offset:0
    buffer_load_dword v155, v7, s[20:23], s46 offen offset:0
    s_add_u32 s46, s47, 0x41d80
    buffer_load_dword v156, v4, s[16:19], s46 offen
    buffer_load_dword v157, v5, s[16:19], s46 offen
    buffer_load_dword v158, v6, s[20:23], s46 offen offset:0
    buffer_load_dword v159, v7, s[20:23], s46 offen offset:0
    s_add_u32 s46, s47, 0x43300
    buffer_load_dword v160, v4, s[16:19], s46 offen
    buffer_load_dword v161, v5, s[16:19], s46 offen
    buffer_load_dword v162, v6, s[20:23], s46 offen offset:0
    buffer_load_dword v163, v7, s[20:23], s46 offen offset:0
    s_add_u32 s46, s47, 0x44880
    buffer_load_dword v164, v4, s[16:19], s46 offen
    buffer_load_dword v165, v5, s[16:19], s46 offen
    buffer_load_dword v166, v6, s[20:23], s46 offen offset:0
    buffer_load_dword v167, v7, s[20:23], s46 offen offset:0
    s_waitcnt vmcnt(56)
    v_perm_b32 v8, v109, v108, s37
    v_accvgpr_write_b32 a1, v8
    v_perm_b32 v9, v109, v108, s38
    v_accvgpr_write_b32 a5, v9
    v_perm_b32 v8, v111, v110, s37
    v_accvgpr_write_b32 a9, v8
    v_perm_b32 v9, v111, v110, s38
    v_accvgpr_write_b32 a13, v9
    s_add_u32 s46, s47, 0x56000
    buffer_load_dword v104, v4, s[16:19], s46 offen
    buffer_load_dword v105, v5, s[16:19], s46 offen
    buffer_load_dword v106, v6, s[20:23], s46 offen offset:0
    buffer_load_dword v107, v7, s[20:23], s46 offen offset:0
    s_waitcnt vmcnt(56)
    v_perm_b32 v8, v113, v112, s37
    v_accvgpr_write_b32 a2, v8
    v_perm_b32 v9, v113, v112, s38
    v_accvgpr_write_b32 a6, v9
    v_perm_b32 v8, v115, v114, s37
    v_accvgpr_write_b32 a10, v8
    v_perm_b32 v9, v115, v114, s38
    v_accvgpr_write_b32 a14, v9
    s_add_u32 s46, s47, 0x57580
    buffer_load_dword v108, v4, s[16:19], s46 offen
    buffer_load_dword v109, v5, s[16:19], s46 offen
    buffer_load_dword v110, v6, s[20:23], s46 offen offset:0
    buffer_load_dword v111, v7, s[20:23], s46 offen offset:0
    s_waitcnt vmcnt(56)
    v_perm_b32 v8, v117, v116, s37
    v_accvgpr_write_b32 a3, v8
    v_perm_b32 v9, v117, v116, s38
    v_accvgpr_write_b32 a7, v9
    v_perm_b32 v8, v119, v118, s37
    v_accvgpr_write_b32 a11, v8
    v_perm_b32 v9, v119, v118, s38
    v_accvgpr_write_b32 a15, v9
    s_add_u32 s46, s47, 0x58b00
    buffer_load_dword v112, v4, s[16:19], s46 offen
    buffer_load_dword v113, v5, s[16:19], s46 offen
    buffer_load_dword v114, v6, s[20:23], s46 offen offset:0
    buffer_load_dword v115, v7, s[20:23], s46 offen offset:0
    s_waitcnt vmcnt(56)
    v_perm_b32 v8, v121, v120, s37
    v_accvgpr_write_b32 a16, v8
    v_perm_b32 v9, v121, v120, s38
    v_accvgpr_write_b32 a20, v9
    v_perm_b32 v8, v123, v122, s37
    v_accvgpr_write_b32 a24, v8
    v_perm_b32 v9, v123, v122, s38
    v_accvgpr_write_b32 a28, v9
    s_add_u32 s46, s47, 0x5a080
    buffer_load_dword v116, v4, s[16:19], s46 offen
    buffer_load_dword v117, v5, s[16:19], s46 offen
    buffer_load_dword v118, v6, s[20:23], s46 offen offset:0
    buffer_load_dword v119, v7, s[20:23], s46 offen offset:0
    s_waitcnt vmcnt(56)
    v_perm_b32 v8, v125, v124, s37
    v_accvgpr_write_b32 a17, v8
    v_perm_b32 v9, v125, v124, s38
    v_accvgpr_write_b32 a21, v9
    v_perm_b32 v8, v127, v126, s37
    v_accvgpr_write_b32 a25, v8
    v_perm_b32 v9, v127, v126, s38
    v_accvgpr_write_b32 a29, v9
    s_add_u32 s46, s47, 0x6b800
    buffer_load_dword v120, v4, s[16:19], s46 offen
    buffer_load_dword v121, v5, s[16:19], s46 offen
    buffer_load_dword v122, v6, s[20:23], s46 offen offset:0
    buffer_load_dword v123, v7, s[20:23], s46 offen offset:0
    s_waitcnt vmcnt(56)
    v_perm_b32 v8, v129, v128, s37
    v_accvgpr_write_b32 a18, v8
    v_perm_b32 v9, v129, v128, s38
    v_accvgpr_write_b32 a22, v9
    v_perm_b32 v8, v131, v130, s37
    v_accvgpr_write_b32 a26, v8
    v_perm_b32 v9, v131, v130, s38
    v_accvgpr_write_b32 a30, v9
    s_add_u32 s46, s47, 0x6cd80
    buffer_load_dword v124, v4, s[16:19], s46 offen
    buffer_load_dword v125, v5, s[16:19], s46 offen
    buffer_load_dword v126, v6, s[20:23], s46 offen offset:0
    buffer_load_dword v127, v7, s[20:23], s46 offen offset:0
    s_waitcnt vmcnt(56)
    v_perm_b32 v8, v133, v132, s37
    v_accvgpr_write_b32 a19, v8
    v_perm_b32 v9, v133, v132, s38
    v_accvgpr_write_b32 a23, v9
    v_perm_b32 v8, v135, v134, s37
    v_accvgpr_write_b32 a27, v8
    v_perm_b32 v9, v135, v134, s38
    v_accvgpr_write_b32 a31, v9
    s_add_u32 s46, s47, 0x6e300
    buffer_load_dword v128, v4, s[16:19], s46 offen
    buffer_load_dword v129, v5, s[16:19], s46 offen
    buffer_load_dword v130, v6, s[20:23], s46 offen offset:0
    buffer_load_dword v131, v7, s[20:23], s46 offen offset:0
    s_waitcnt vmcnt(56)
    v_perm_b32 v8, v137, v136, s37
    v_accvgpr_write_b32 a32, v8
    v_perm_b32 v9, v137, v136, s38
    v_accvgpr_write_b32 a36, v9
    v_perm_b32 v8, v139, v138, s37
    v_accvgpr_write_b32 a40, v8
    v_perm_b32 v9, v139, v138, s38
    v_accvgpr_write_b32 a44, v9
    s_add_u32 s46, s47, 0x6f880
    buffer_load_dword v132, v4, s[16:19], s46 offen
    buffer_load_dword v133, v5, s[16:19], s46 offen
    buffer_load_dword v134, v6, s[20:23], s46 offen offset:0
    buffer_load_dword v135, v7, s[20:23], s46 offen offset:0
    s_waitcnt vmcnt(56)
    v_perm_b32 v8, v141, v140, s37
    v_accvgpr_write_b32 a33, v8
    v_perm_b32 v9, v141, v140, s38
    v_accvgpr_write_b32 a37, v9
    v_perm_b32 v8, v143, v142, s37
    v_accvgpr_write_b32 a41, v8
    v_perm_b32 v9, v143, v142, s38
    v_accvgpr_write_b32 a45, v9
    s_add_u32 s46, s47, 0x81000
    buffer_load_dword v136, v4, s[16:19], s46 offen
    buffer_load_dword v137, v5, s[16:19], s46 offen
    buffer_load_dword v138, v6, s[20:23], s46 offen offset:0
    buffer_load_dword v139, v7, s[20:23], s46 offen offset:0
    s_waitcnt vmcnt(56)
    v_perm_b32 v8, v145, v144, s37
    v_accvgpr_write_b32 a34, v8
    v_perm_b32 v9, v145, v144, s38
    v_accvgpr_write_b32 a38, v9
    v_perm_b32 v8, v147, v146, s37
    v_accvgpr_write_b32 a42, v8
    v_perm_b32 v9, v147, v146, s38
    v_accvgpr_write_b32 a46, v9
    s_add_u32 s46, s47, 0x82580
    buffer_load_dword v140, v4, s[16:19], s46 offen
    buffer_load_dword v141, v5, s[16:19], s46 offen
    buffer_load_dword v142, v6, s[20:23], s46 offen offset:0
    buffer_load_dword v143, v7, s[20:23], s46 offen offset:0
    s_waitcnt vmcnt(56)
    v_perm_b32 v8, v149, v148, s37
    v_accvgpr_write_b32 a35, v8
    v_perm_b32 v9, v149, v148, s38
    v_accvgpr_write_b32 a39, v9
    v_perm_b32 v8, v151, v150, s37
    v_accvgpr_write_b32 a43, v8
    v_perm_b32 v9, v151, v150, s38
    v_accvgpr_write_b32 a47, v9
    s_add_u32 s46, s47, 0x83b00
    buffer_load_dword v144, v4, s[16:19], s46 offen
    buffer_load_dword v145, v5, s[16:19], s46 offen
    buffer_load_dword v146, v6, s[20:23], s46 offen offset:0
    buffer_load_dword v147, v7, s[20:23], s46 offen offset:0
    s_waitcnt vmcnt(56)
    v_perm_b32 v8, v153, v152, s37
    v_accvgpr_write_b32 a48, v8
    v_perm_b32 v9, v153, v152, s38
    v_accvgpr_write_b32 a52, v9
    v_perm_b32 v8, v155, v154, s37
    v_accvgpr_write_b32 a56, v8
    v_perm_b32 v9, v155, v154, s38
    v_accvgpr_write_b32 a60, v9
    s_add_u32 s46, s47, 0x85080
    buffer_load_dword v148, v4, s[16:19], s46 offen
    buffer_load_dword v149, v5, s[16:19], s46 offen
    buffer_load_dword v150, v6, s[20:23], s46 offen offset:0
    buffer_load_dword v151, v7, s[20:23], s46 offen offset:0
    s_waitcnt vmcnt(56)
    v_perm_b32 v8, v157, v156, s37
    v_accvgpr_write_b32 a49, v8
    v_perm_b32 v9, v157, v156, s38
    v_accvgpr_write_b32 a53, v9
    v_perm_b32 v8, v159, v158, s37
    v_accvgpr_write_b32 a57, v8
    v_perm_b32 v9, v159, v158, s38
    v_accvgpr_write_b32 a61, v9
    s_add_u32 s46, s47, 0x96800
    buffer_load_dword v152, v4, s[16:19], s46 offen
    buffer_load_dword v153, v5, s[16:19], s46 offen
    buffer_load_dword v154, v6, s[20:23], s46 offen offset:0
    buffer_load_dword v155, v7, s[20:23], s46 offen offset:0
    s_waitcnt vmcnt(56)
    v_perm_b32 v8, v161, v160, s37
    v_accvgpr_write_b32 a50, v8
    v_perm_b32 v9, v161, v160, s38
    v_accvgpr_write_b32 a54, v9
    v_perm_b32 v8, v163, v162, s37
    v_accvgpr_write_b32 a58, v8
    v_perm_b32 v9, v163, v162, s38
    v_accvgpr_write_b32 a62, v9
    s_add_u32 s46, s47, 0x97d80
    buffer_load_dword v156, v4, s[16:19], s46 offen
    buffer_load_dword v157, v5, s[16:19], s46 offen
    buffer_load_dword v158, v6, s[20:23], s46 offen offset:0
    buffer_load_dword v159, v7, s[20:23], s46 offen offset:0
    s_waitcnt vmcnt(56)
    v_perm_b32 v8, v165, v164, s37
    v_accvgpr_write_b32 a51, v8
    v_perm_b32 v9, v165, v164, s38
    v_accvgpr_write_b32 a55, v9
    v_perm_b32 v8, v167, v166, s37
    v_accvgpr_write_b32 a59, v8
    v_perm_b32 v9, v167, v166, s38
    v_accvgpr_write_b32 a63, v9
    s_add_u32 s46, s47, 0x99300
    buffer_load_dword v160, v4, s[16:19], s46 offen
    buffer_load_dword v161, v5, s[16:19], s46 offen
    buffer_load_dword v162, v6, s[20:23], s46 offen offset:0
    buffer_load_dword v163, v7, s[20:23], s46 offen offset:0
    s_waitcnt vmcnt(56)
    v_perm_b32 v8, v105, v104, s37
    v_accvgpr_write_b32 a64, v8
    v_perm_b32 v9, v105, v104, s38
    v_accvgpr_write_b32 a68, v9
    v_perm_b32 v8, v107, v106, s37
    v_accvgpr_write_b32 a72, v8
    v_perm_b32 v9, v107, v106, s38
    v_accvgpr_write_b32 a76, v9
    s_add_u32 s46, s47, 0x9a880
    buffer_load_dword v164, v4, s[16:19], s46 offen
    buffer_load_dword v165, v5, s[16:19], s46 offen
    buffer_load_dword v166, v6, s[20:23], s46 offen offset:0
    buffer_load_dword v167, v7, s[20:23], s46 offen offset:0
    s_waitcnt vmcnt(56)
    v_perm_b32 v8, v109, v108, s37
    v_accvgpr_write_b32 a65, v8
    v_perm_b32 v9, v109, v108, s38
    v_accvgpr_write_b32 a69, v9
    v_perm_b32 v8, v111, v110, s37
    v_accvgpr_write_b32 a73, v8
    v_perm_b32 v9, v111, v110, s38
    v_accvgpr_write_b32 a77, v9
    s_add_u32 s46, s47, 0xac000
    buffer_load_dword v104, v4, s[16:19], s46 offen
    buffer_load_dword v105, v5, s[16:19], s46 offen
    buffer_load_dword v106, v6, s[20:23], s46 offen offset:0
    buffer_load_dword v107, v7, s[20:23], s46 offen offset:0
    s_waitcnt vmcnt(56)
    v_perm_b32 v8, v113, v112, s37
    v_accvgpr_write_b32 a66, v8
    v_perm_b32 v9, v113, v112, s38
    v_accvgpr_write_b32 a70, v9
    v_perm_b32 v8, v115, v114, s37
    v_accvgpr_write_b32 a74, v8
    v_perm_b32 v9, v115, v114, s38
    v_accvgpr_write_b32 a78, v9
    s_add_u32 s46, s47, 0xad580
    buffer_load_dword v108, v4, s[16:19], s46 offen
    buffer_load_dword v109, v5, s[16:19], s46 offen
    buffer_load_dword v110, v6, s[20:23], s46 offen offset:0
    buffer_load_dword v111, v7, s[20:23], s46 offen offset:0
    s_waitcnt vmcnt(56)
    v_perm_b32 v8, v117, v116, s37
    v_accvgpr_write_b32 a67, v8
    v_perm_b32 v9, v117, v116, s38
    v_accvgpr_write_b32 a71, v9
    v_perm_b32 v8, v119, v118, s37
    v_accvgpr_write_b32 a75, v8
    v_perm_b32 v9, v119, v118, s38
    v_accvgpr_write_b32 a79, v9
    s_add_u32 s46, s47, 0xaeb00
    buffer_load_dword v112, v4, s[16:19], s46 offen
    buffer_load_dword v113, v5, s[16:19], s46 offen
    buffer_load_dword v114, v6, s[20:23], s46 offen offset:0
    buffer_load_dword v115, v7, s[20:23], s46 offen offset:0
    s_waitcnt vmcnt(56)
    v_perm_b32 v8, v121, v120, s37
    v_accvgpr_write_b32 a80, v8
    v_perm_b32 v9, v121, v120, s38
    v_accvgpr_write_b32 a84, v9
    v_perm_b32 v8, v123, v122, s37
    v_accvgpr_write_b32 a88, v8
    v_perm_b32 v9, v123, v122, s38
    v_accvgpr_write_b32 a92, v9
    s_add_u32 s46, s47, 0xb0080
    buffer_load_dword v116, v4, s[16:19], s46 offen
    buffer_load_dword v117, v5, s[16:19], s46 offen
    buffer_load_dword v118, v6, s[20:23], s46 offen offset:0
    buffer_load_dword v119, v7, s[20:23], s46 offen offset:0
    s_waitcnt vmcnt(56)
    v_perm_b32 v8, v125, v124, s37
    v_accvgpr_write_b32 a81, v8
    v_perm_b32 v9, v125, v124, s38
    v_accvgpr_write_b32 a85, v9
    v_perm_b32 v8, v127, v126, s37
    v_accvgpr_write_b32 a89, v8
    v_perm_b32 v9, v127, v126, s38
    v_accvgpr_write_b32 a93, v9
    s_add_u32 s46, s47, 0xc1800
    buffer_load_dword v120, v4, s[16:19], s46 offen
    buffer_load_dword v121, v5, s[16:19], s46 offen
    buffer_load_dword v122, v6, s[20:23], s46 offen offset:0
    buffer_load_dword v123, v7, s[20:23], s46 offen offset:0
    s_waitcnt vmcnt(56)
    v_perm_b32 v8, v129, v128, s37
    v_accvgpr_write_b32 a82, v8
    v_perm_b32 v9, v129, v128, s38
    v_accvgpr_write_b32 a86, v9
    v_perm_b32 v8, v131, v130, s37
    v_accvgpr_write_b32 a90, v8
    v_perm_b32 v9, v131, v130, s38
    v_accvgpr_write_b32 a94, v9
    s_add_u32 s46, s47, 0xc2d80
    buffer_load_dword v124, v4, s[16:19], s46 offen
    buffer_load_dword v125, v5, s[16:19], s46 offen
    buffer_load_dword v126, v6, s[20:23], s46 offen offset:0
    buffer_load_dword v127, v7, s[20:23], s46 offen offset:0
    s_waitcnt vmcnt(56)
    v_perm_b32 v8, v133, v132, s37
    v_accvgpr_write_b32 a83, v8
    v_perm_b32 v9, v133, v132, s38
    v_accvgpr_write_b32 a87, v9
    v_perm_b32 v8, v135, v134, s37
    v_accvgpr_write_b32 a91, v8
    v_perm_b32 v9, v135, v134, s38
    v_accvgpr_write_b32 a95, v9
    s_add_u32 s46, s47, 0xc4300
    buffer_load_dword v128, v4, s[16:19], s46 offen
    buffer_load_dword v129, v5, s[16:19], s46 offen
    buffer_load_dword v130, v6, s[20:23], s46 offen offset:0
    buffer_load_dword v131, v7, s[20:23], s46 offen offset:0
    s_waitcnt vmcnt(56)
    v_perm_b32 v8, v137, v136, s37
    v_accvgpr_write_b32 a96, v8
    v_perm_b32 v9, v137, v136, s38
    v_accvgpr_write_b32 a100, v9
    v_perm_b32 v8, v139, v138, s37
    v_accvgpr_write_b32 a104, v8
    v_perm_b32 v9, v139, v138, s38
    v_accvgpr_write_b32 a108, v9
    s_add_u32 s46, s47, 0xc5880
    buffer_load_dword v132, v4, s[16:19], s46 offen
    buffer_load_dword v133, v5, s[16:19], s46 offen
    buffer_load_dword v134, v6, s[20:23], s46 offen offset:0
    buffer_load_dword v135, v7, s[20:23], s46 offen offset:0
    s_waitcnt vmcnt(56)
    v_perm_b32 v8, v141, v140, s37
    v_accvgpr_write_b32 a97, v8
    v_perm_b32 v9, v141, v140, s38
    v_accvgpr_write_b32 a101, v9
    v_perm_b32 v8, v143, v142, s37
    v_accvgpr_write_b32 a105, v8
    v_perm_b32 v9, v143, v142, s38
    v_accvgpr_write_b32 a109, v9
    s_add_u32 s46, s47, 0xd7000
    buffer_load_dword v136, v4, s[16:19], s46 offen
    buffer_load_dword v137, v5, s[16:19], s46 offen
    buffer_load_dword v138, v6, s[20:23], s46 offen offset:0
    buffer_load_dword v139, v7, s[20:23], s46 offen offset:0
    s_waitcnt vmcnt(56)
    v_perm_b32 v8, v145, v144, s37
    v_accvgpr_write_b32 a98, v8
    v_perm_b32 v9, v145, v144, s38
    v_accvgpr_write_b32 a102, v9
    v_perm_b32 v8, v147, v146, s37
    v_accvgpr_write_b32 a106, v8
    v_perm_b32 v9, v147, v146, s38
    v_accvgpr_write_b32 a110, v9
    s_add_u32 s46, s47, 0xd8580
    buffer_load_dword v140, v4, s[16:19], s46 offen
    buffer_load_dword v141, v5, s[16:19], s46 offen
    buffer_load_dword v142, v6, s[20:23], s46 offen offset:0
    buffer_load_dword v143, v7, s[20:23], s46 offen offset:0
    s_waitcnt vmcnt(56)
    v_perm_b32 v8, v149, v148, s37
    v_accvgpr_write_b32 a99, v8
    v_perm_b32 v9, v149, v148, s38
    v_accvgpr_write_b32 a103, v9
    v_perm_b32 v8, v151, v150, s37
    v_accvgpr_write_b32 a107, v8
    v_perm_b32 v9, v151, v150, s38
    v_accvgpr_write_b32 a111, v9
    s_add_u32 s46, s47, 0xd9b00
    buffer_load_dword v144, v4, s[16:19], s46 offen
    buffer_load_dword v145, v5, s[16:19], s46 offen
    buffer_load_dword v146, v6, s[20:23], s46 offen offset:0
    buffer_load_dword v147, v7, s[20:23], s46 offen offset:0
    s_waitcnt vmcnt(56)
    v_perm_b32 v8, v153, v152, s37
    v_accvgpr_write_b32 a112, v8
    v_perm_b32 v9, v153, v152, s38
    v_accvgpr_write_b32 a116, v9
    v_perm_b32 v8, v155, v154, s37
    v_accvgpr_write_b32 a120, v8
    v_perm_b32 v9, v155, v154, s38
    v_accvgpr_write_b32 a124, v9
    s_add_u32 s46, s47, 0xdb080
    buffer_load_dword v148, v4, s[16:19], s46 offen
    buffer_load_dword v149, v5, s[16:19], s46 offen
    buffer_load_dword v150, v6, s[20:23], s46 offen offset:0
    buffer_load_dword v151, v7, s[20:23], s46 offen offset:0
    s_waitcnt vmcnt(56)
    v_perm_b32 v8, v157, v156, s37
    v_accvgpr_write_b32 a113, v8
    v_perm_b32 v9, v157, v156, s38
    v_accvgpr_write_b32 a117, v9
    v_perm_b32 v8, v159, v158, s37
    v_accvgpr_write_b32 a121, v8
    v_perm_b32 v9, v159, v158, s38
    v_accvgpr_write_b32 a125, v9
    s_add_u32 s46, s47, 0xec800
    buffer_load_dword v152, v4, s[16:19], s46 offen
    buffer_load_dword v153, v5, s[16:19], s46 offen
    buffer_load_dword v154, v6, s[20:23], s46 offen offset:0
    buffer_load_dword v155, v7, s[20:23], s46 offen offset:0
    s_waitcnt vmcnt(56)
    v_perm_b32 v8, v161, v160, s37
    v_accvgpr_write_b32 a114, v8
    v_perm_b32 v9, v161, v160, s38
    v_accvgpr_write_b32 a118, v9
    v_perm_b32 v8, v163, v162, s37
    v_accvgpr_write_b32 a122, v8
    v_perm_b32 v9, v163, v162, s38
    v_accvgpr_write_b32 a126, v9
    s_add_u32 s46, s47, 0xedd80
    buffer_load_dword v156, v4, s[16:19], s46 offen
    buffer_load_dword v157, v5, s[16:19], s46 offen
    buffer_load_dword v158, v6, s[20:23], s46 offen offset:0
    buffer_load_dword v159, v7, s[20:23], s46 offen offset:0
    s_waitcnt vmcnt(56)
    v_perm_b32 v8, v165, v164, s37
    v_accvgpr_write_b32 a115, v8
    v_perm_b32 v9, v165, v164, s38
    v_accvgpr_write_b32 a119, v9
    v_perm_b32 v8, v167, v166, s37
    v_accvgpr_write_b32 a123, v8
    v_perm_b32 v9, v167, v166, s38
    v_accvgpr_write_b32 a127, v9
    s_add_u32 s46, s47, 0xef300
    buffer_load_dword v160, v4, s[16:19], s46 offen
    buffer_load_dword v161, v5, s[16:19], s46 offen
    buffer_load_dword v162, v6, s[20:23], s46 offen offset:0
    buffer_load_dword v163, v7, s[20:23], s46 offen offset:0
    s_waitcnt vmcnt(56)
    v_perm_b32 v8, v105, v104, s37
    v_accvgpr_write_b32 a128, v8
    v_perm_b32 v9, v105, v104, s38
    v_accvgpr_write_b32 a132, v9
    v_perm_b32 v8, v107, v106, s37
    v_accvgpr_write_b32 a136, v8
    v_perm_b32 v9, v107, v106, s38
    v_accvgpr_write_b32 a140, v9
    s_add_u32 s46, s47, 0xf0880
    buffer_load_dword v164, v4, s[16:19], s46 offen
    buffer_load_dword v165, v5, s[16:19], s46 offen
    buffer_load_dword v166, v6, s[20:23], s46 offen offset:0
    buffer_load_dword v167, v7, s[20:23], s46 offen offset:0
    s_waitcnt vmcnt(56)
    v_perm_b32 v8, v109, v108, s37
    v_accvgpr_write_b32 a129, v8
    v_perm_b32 v9, v109, v108, s38
    v_accvgpr_write_b32 a133, v9
    v_perm_b32 v8, v111, v110, s37
    v_accvgpr_write_b32 a137, v8
    v_perm_b32 v9, v111, v110, s38
    v_accvgpr_write_b32 a141, v9
    s_add_u32 s46, s47, 0x102000
    buffer_load_dword v104, v4, s[16:19], s46 offen
    buffer_load_dword v105, v5, s[16:19], s46 offen
    buffer_load_dword v106, v6, s[20:23], s46 offen offset:0
    buffer_load_dword v107, v7, s[20:23], s46 offen offset:0
    s_waitcnt vmcnt(56)
    v_perm_b32 v8, v113, v112, s37
    v_accvgpr_write_b32 a130, v8
    v_perm_b32 v9, v113, v112, s38
    v_accvgpr_write_b32 a134, v9
    v_perm_b32 v8, v115, v114, s37
    v_accvgpr_write_b32 a138, v8
    v_perm_b32 v9, v115, v114, s38
    v_accvgpr_write_b32 a142, v9
    s_add_u32 s46, s47, 0x103580
    buffer_load_dword v108, v4, s[16:19], s46 offen
    buffer_load_dword v109, v5, s[16:19], s46 offen
    buffer_load_dword v110, v6, s[20:23], s46 offen offset:0
    buffer_load_dword v111, v7, s[20:23], s46 offen offset:0
    s_waitcnt vmcnt(56)
    v_perm_b32 v8, v117, v116, s37
    v_accvgpr_write_b32 a131, v8
    v_perm_b32 v9, v117, v116, s38
    v_accvgpr_write_b32 a135, v9
    v_perm_b32 v8, v119, v118, s37
    v_accvgpr_write_b32 a139, v8
    v_perm_b32 v9, v119, v118, s38
    v_accvgpr_write_b32 a143, v9
    s_add_u32 s46, s47, 0x104b00
    buffer_load_dword v112, v4, s[16:19], s46 offen
    buffer_load_dword v113, v5, s[16:19], s46 offen
    buffer_load_dword v114, v6, s[20:23], s46 offen offset:0
    buffer_load_dword v115, v7, s[20:23], s46 offen offset:0
    s_waitcnt vmcnt(56)
    v_perm_b32 v8, v121, v120, s37
    v_accvgpr_write_b32 a144, v8
    v_perm_b32 v9, v121, v120, s38
    v_accvgpr_write_b32 a148, v9
    v_perm_b32 v8, v123, v122, s37
    v_accvgpr_write_b32 a152, v8
    v_perm_b32 v9, v123, v122, s38
    v_accvgpr_write_b32 a156, v9
    s_add_u32 s46, s47, 0x106080
    buffer_load_dword v116, v4, s[16:19], s46 offen
    buffer_load_dword v117, v5, s[16:19], s46 offen
    buffer_load_dword v118, v6, s[20:23], s46 offen offset:0
    buffer_load_dword v119, v7, s[20:23], s46 offen offset:0
    s_waitcnt vmcnt(56)
    v_perm_b32 v8, v125, v124, s37
    v_accvgpr_write_b32 a145, v8
    v_perm_b32 v9, v125, v124, s38
    v_accvgpr_write_b32 a149, v9
    v_perm_b32 v8, v127, v126, s37
    v_accvgpr_write_b32 a153, v8
    v_perm_b32 v9, v127, v126, s38
    v_accvgpr_write_b32 a157, v9
    s_add_u32 s46, s47, 0x117800
    buffer_load_dword v120, v4, s[16:19], s46 offen
    buffer_load_dword v121, v5, s[16:19], s46 offen
    buffer_load_dword v122, v6, s[20:23], s46 offen offset:0
    buffer_load_dword v123, v7, s[20:23], s46 offen offset:0
    s_waitcnt vmcnt(56)
    v_perm_b32 v8, v129, v128, s37
    v_accvgpr_write_b32 a146, v8
    v_perm_b32 v9, v129, v128, s38
    v_accvgpr_write_b32 a150, v9
    v_perm_b32 v8, v131, v130, s37
    v_accvgpr_write_b32 a154, v8
    v_perm_b32 v9, v131, v130, s38
    v_accvgpr_write_b32 a158, v9
    s_add_u32 s46, s47, 0x118d80
    buffer_load_dword v124, v4, s[16:19], s46 offen
    buffer_load_dword v125, v5, s[16:19], s46 offen
    buffer_load_dword v126, v6, s[20:23], s46 offen offset:0
    buffer_load_dword v127, v7, s[20:23], s46 offen offset:0
    s_waitcnt vmcnt(56)
    v_perm_b32 v8, v133, v132, s37
    v_accvgpr_write_b32 a147, v8
    v_perm_b32 v9, v133, v132, s38
    v_accvgpr_write_b32 a151, v9
    v_perm_b32 v8, v135, v134, s37
    v_accvgpr_write_b32 a155, v8
    v_perm_b32 v9, v135, v134, s38
    v_accvgpr_write_b32 a159, v9
    s_add_u32 s46, s47, 0x11a300
    buffer_load_dword v128, v4, s[16:19], s46 offen
    buffer_load_dword v129, v5, s[16:19], s46 offen
    buffer_load_dword v130, v6, s[20:23], s46 offen offset:0
    buffer_load_dword v131, v7, s[20:23], s46 offen offset:0
    s_waitcnt vmcnt(56)
    v_perm_b32 v8, v137, v136, s37
    v_accvgpr_write_b32 a160, v8
    v_perm_b32 v9, v137, v136, s38
    v_accvgpr_write_b32 a164, v9
    v_perm_b32 v8, v139, v138, s37
    v_accvgpr_write_b32 a168, v8
    v_perm_b32 v9, v139, v138, s38
    v_accvgpr_write_b32 a172, v9
    s_add_u32 s46, s47, 0x11b880
    buffer_load_dword v132, v4, s[16:19], s46 offen
    buffer_load_dword v133, v5, s[16:19], s46 offen
    buffer_load_dword v134, v6, s[20:23], s46 offen offset:0
    buffer_load_dword v135, v7, s[20:23], s46 offen offset:0
    s_waitcnt vmcnt(56)
    v_perm_b32 v8, v141, v140, s37
    v_accvgpr_write_b32 a161, v8
    v_perm_b32 v9, v141, v140, s38
    v_accvgpr_write_b32 a165, v9
    v_perm_b32 v8, v143, v142, s37
    v_accvgpr_write_b32 a169, v8
    v_perm_b32 v9, v143, v142, s38
    v_accvgpr_write_b32 a173, v9
    s_add_u32 s46, s47, 0x12d000
    buffer_load_dword v136, v4, s[16:19], s46 offen
    buffer_load_dword v137, v5, s[16:19], s46 offen
    buffer_load_dword v138, v6, s[20:23], s46 offen offset:0
    buffer_load_dword v139, v7, s[20:23], s46 offen offset:0
    s_waitcnt vmcnt(56)
    v_perm_b32 v8, v145, v144, s37
    v_accvgpr_write_b32 a162, v8
    v_perm_b32 v9, v145, v144, s38
    v_accvgpr_write_b32 a166, v9
    v_perm_b32 v8, v147, v146, s37
    v_accvgpr_write_b32 a170, v8
    v_perm_b32 v9, v147, v146, s38
    v_accvgpr_write_b32 a174, v9
    s_add_u32 s46, s47, 0x12e580
    buffer_load_dword v140, v4, s[16:19], s46 offen
    buffer_load_dword v141, v5, s[16:19], s46 offen
    buffer_load_dword v142, v6, s[20:23], s46 offen offset:0
    buffer_load_dword v143, v7, s[20:23], s46 offen offset:0
    s_waitcnt vmcnt(56)
    v_perm_b32 v8, v149, v148, s37
    v_accvgpr_write_b32 a163, v8
    v_perm_b32 v9, v149, v148, s38
    v_accvgpr_write_b32 a167, v9
    v_perm_b32 v8, v151, v150, s37
    v_accvgpr_write_b32 a171, v8
    v_perm_b32 v9, v151, v150, s38
    v_accvgpr_write_b32 a175, v9
    s_add_u32 s46, s47, 0x12fb00
    buffer_load_dword v144, v4, s[16:19], s46 offen
    buffer_load_dword v145, v5, s[16:19], s46 offen
    buffer_load_dword v146, v6, s[20:23], s46 offen offset:0
    buffer_load_dword v147, v7, s[20:23], s46 offen offset:0
    s_waitcnt vmcnt(56)
    v_perm_b32 v8, v153, v152, s37
    v_accvgpr_write_b32 a176, v8
    v_perm_b32 v9, v153, v152, s38
    v_accvgpr_write_b32 a180, v9
    v_perm_b32 v8, v155, v154, s37
    v_accvgpr_write_b32 a184, v8
    v_perm_b32 v9, v155, v154, s38
    v_accvgpr_write_b32 a188, v9
    s_add_u32 s46, s47, 0x131080
    buffer_load_dword v148, v4, s[16:19], s46 offen
    buffer_load_dword v149, v5, s[16:19], s46 offen
    buffer_load_dword v150, v6, s[20:23], s46 offen offset:0
    buffer_load_dword v151, v7, s[20:23], s46 offen offset:0
    s_waitcnt vmcnt(56)
    v_perm_b32 v8, v157, v156, s37
    v_accvgpr_write_b32 a177, v8
    v_perm_b32 v9, v157, v156, s38
    v_accvgpr_write_b32 a181, v9
    v_perm_b32 v8, v159, v158, s37
    v_accvgpr_write_b32 a185, v8
    v_perm_b32 v9, v159, v158, s38
    v_accvgpr_write_b32 a189, v9
    s_add_u32 s46, s47, 0x142800
    buffer_load_dword v152, v4, s[16:19], s46 offen
    buffer_load_dword v153, v5, s[16:19], s46 offen
    buffer_load_dword v154, v6, s[20:23], s46 offen offset:0
    buffer_load_dword v155, v7, s[20:23], s46 offen offset:0
    s_waitcnt vmcnt(56)
    v_perm_b32 v8, v161, v160, s37
    v_accvgpr_write_b32 a178, v8
    v_perm_b32 v9, v161, v160, s38
    v_accvgpr_write_b32 a182, v9
    v_perm_b32 v8, v163, v162, s37
    v_accvgpr_write_b32 a186, v8
    v_perm_b32 v9, v163, v162, s38
    v_accvgpr_write_b32 a190, v9
    s_add_u32 s46, s47, 0x143d80
    buffer_load_dword v156, v4, s[16:19], s46 offen
    buffer_load_dword v157, v5, s[16:19], s46 offen
    buffer_load_dword v158, v6, s[20:23], s46 offen offset:0
    buffer_load_dword v159, v7, s[20:23], s46 offen offset:0
    s_waitcnt vmcnt(56)
    v_perm_b32 v8, v165, v164, s37
    v_accvgpr_write_b32 a179, v8
    v_perm_b32 v9, v165, v164, s38
    v_accvgpr_write_b32 a183, v9
    v_perm_b32 v8, v167, v166, s37
    v_accvgpr_write_b32 a187, v8
    v_perm_b32 v9, v167, v166, s38
    v_accvgpr_write_b32 a191, v9
    s_add_u32 s46, s47, 0x145300
    buffer_load_dword v160, v4, s[16:19], s46 offen
    buffer_load_dword v161, v5, s[16:19], s46 offen
    buffer_load_dword v162, v6, s[20:23], s46 offen offset:0
    buffer_load_dword v163, v7, s[20:23], s46 offen offset:0
    s_waitcnt vmcnt(56)
    v_perm_b32 v8, v105, v104, s37
    v_accvgpr_write_b32 a192, v8
    v_perm_b32 v9, v105, v104, s38
    v_accvgpr_write_b32 a196, v9
    v_perm_b32 v8, v107, v106, s37
    v_accvgpr_write_b32 a200, v8
    v_perm_b32 v9, v107, v106, s38
    v_accvgpr_write_b32 a204, v9
    s_add_u32 s46, s47, 0x146880
    buffer_load_dword v164, v4, s[16:19], s46 offen
    buffer_load_dword v165, v5, s[16:19], s46 offen
    buffer_load_dword v166, v6, s[20:23], s46 offen offset:0
    buffer_load_dword v167, v7, s[20:23], s46 offen offset:0
    s_waitcnt vmcnt(56)
    v_perm_b32 v8, v109, v108, s37
    v_accvgpr_write_b32 a193, v8
    v_perm_b32 v9, v109, v108, s38
    v_accvgpr_write_b32 a197, v9
    v_perm_b32 v8, v111, v110, s37
    v_accvgpr_write_b32 a201, v8
    v_perm_b32 v9, v111, v110, s38
    v_accvgpr_write_b32 a205, v9
    s_waitcnt vmcnt(52)
    v_perm_b32 v8, v113, v112, s37
    v_accvgpr_write_b32 a194, v8
    v_perm_b32 v9, v113, v112, s38
    v_accvgpr_write_b32 a198, v9
    v_perm_b32 v8, v115, v114, s37
    v_accvgpr_write_b32 a202, v8
    v_perm_b32 v9, v115, v114, s38
    v_accvgpr_write_b32 a206, v9
    s_waitcnt vmcnt(48)
    v_perm_b32 v8, v117, v116, s37
    v_accvgpr_write_b32 a195, v8
    v_perm_b32 v9, v117, v116, s38
    v_accvgpr_write_b32 a199, v9
    v_perm_b32 v8, v119, v118, s37
    v_accvgpr_write_b32 a203, v8
    v_perm_b32 v9, v119, v118, s38
    v_accvgpr_write_b32 a207, v9
    s_waitcnt vmcnt(44)
    v_perm_b32 v8, v121, v120, s37
    v_accvgpr_write_b32 a208, v8
    v_perm_b32 v9, v121, v120, s38
    v_accvgpr_write_b32 a212, v9
    v_perm_b32 v8, v123, v122, s37
    v_accvgpr_write_b32 a216, v8
    v_perm_b32 v9, v123, v122, s38
    v_accvgpr_write_b32 a220, v9
    s_waitcnt vmcnt(40)
    v_perm_b32 v8, v125, v124, s37
    v_accvgpr_write_b32 a209, v8
    v_perm_b32 v9, v125, v124, s38
    v_accvgpr_write_b32 a213, v9
    v_perm_b32 v8, v127, v126, s37
    v_accvgpr_write_b32 a217, v8
    v_perm_b32 v9, v127, v126, s38
    v_accvgpr_write_b32 a221, v9
    s_waitcnt vmcnt(36)
    v_perm_b32 v8, v129, v128, s37
    v_accvgpr_write_b32 a210, v8
    v_perm_b32 v9, v129, v128, s38
    v_accvgpr_write_b32 a214, v9
    v_perm_b32 v8, v131, v130, s37
    v_accvgpr_write_b32 a218, v8
    v_perm_b32 v9, v131, v130, s38
    v_accvgpr_write_b32 a222, v9
    s_waitcnt vmcnt(32)
    v_perm_b32 v8, v133, v132, s37
    v_accvgpr_write_b32 a211, v8
    v_perm_b32 v9, v133, v132, s38
    v_accvgpr_write_b32 a215, v9
    v_perm_b32 v8, v135, v134, s37
    v_accvgpr_write_b32 a219, v8
    v_perm_b32 v9, v135, v134, s38
    v_accvgpr_write_b32 a223, v9
    s_waitcnt vmcnt(28)
    v_perm_b32 v8, v137, v136, s37
    v_accvgpr_write_b32 a224, v8
    v_perm_b32 v9, v137, v136, s38
    v_accvgpr_write_b32 a228, v9
    v_perm_b32 v8, v139, v138, s37
    v_accvgpr_write_b32 a232, v8
    v_perm_b32 v9, v139, v138, s38
    v_accvgpr_write_b32 a236, v9
    s_waitcnt vmcnt(24)
    v_perm_b32 v8, v141, v140, s37
    v_accvgpr_write_b32 a225, v8
    v_perm_b32 v9, v141, v140, s38
    v_accvgpr_write_b32 a229, v9
    v_perm_b32 v8, v143, v142, s37
    v_accvgpr_write_b32 a233, v8
    v_perm_b32 v9, v143, v142, s38
    v_accvgpr_write_b32 a237, v9
    s_waitcnt vmcnt(20)
    v_perm_b32 v8, v145, v144, s37
    v_accvgpr_write_b32 a226, v8
    v_perm_b32 v9, v145, v144, s38
    v_accvgpr_write_b32 a230, v9
    v_perm_b32 v8, v147, v146, s37
    v_accvgpr_write_b32 a234, v8
    v_perm_b32 v9, v147, v146, s38
    v_accvgpr_write_b32 a238, v9
    s_waitcnt vmcnt(16)
    v_perm_b32 v8, v149, v148, s37
    v_accvgpr_write_b32 a227, v8
    v_perm_b32 v9, v149, v148, s38
    v_accvgpr_write_b32 a231, v9
    v_perm_b32 v8, v151, v150, s37
    v_accvgpr_write_b32 a235, v8
    v_perm_b32 v9, v151, v150, s38
    v_accvgpr_write_b32 a239, v9
    s_waitcnt vmcnt(12)
    v_perm_b32 v8, v153, v152, s37
    v_accvgpr_write_b32 a240, v8
    v_perm_b32 v9, v153, v152, s38
    v_accvgpr_write_b32 a244, v9
    v_perm_b32 v8, v155, v154, s37
    v_accvgpr_write_b32 a248, v8
    v_perm_b32 v9, v155, v154, s38
    v_accvgpr_write_b32 a252, v9
    s_waitcnt vmcnt(8)
    v_perm_b32 v8, v157, v156, s37
    v_accvgpr_write_b32 a241, v8
    v_perm_b32 v9, v157, v156, s38
    v_accvgpr_write_b32 a245, v9
    v_perm_b32 v8, v159, v158, s37
    v_accvgpr_write_b32 a249, v8
    v_perm_b32 v9, v159, v158, s38
    v_accvgpr_write_b32 a253, v9
    s_waitcnt vmcnt(4)
    v_perm_b32 v8, v161, v160, s37
    v_accvgpr_write_b32 a242, v8
    v_perm_b32 v9, v161, v160, s38
    v_accvgpr_write_b32 a246, v9
    v_perm_b32 v8, v163, v162, s37
    v_accvgpr_write_b32 a250, v8
    v_perm_b32 v9, v163, v162, s38
    v_accvgpr_write_b32 a254, v9
    s_waitcnt vmcnt(0)
    v_perm_b32 v8, v165, v164, s37
    v_accvgpr_write_b32 a243, v8
    v_perm_b32 v9, v165, v164, s38
    v_accvgpr_write_b32 a247, v9
    v_perm_b32 v8, v167, v166, s37
    v_accvgpr_write_b32 a251, v8
    v_perm_b32 v9, v167, v166, s38
    v_accvgpr_write_b32 a255, v9
    s_mov_b32 s42, 0
GF_loop:
    s_waitcnt vmcnt(10)
    s_barrier
    v_add_u32 v72, s42, v3
    ds_read_b128 v[48:51], v72 offset:0
    ds_read_b128 v[52:55], v72 offset:16896
    ds_read_b128 v[56:59], v72 offset:64
    ds_read_b128 v[60:63], v72 offset:16960
    s_add_u32 s46, s42, 101376
    s_cmp_ge_u32 s46, 135168
    s_cselect_b32 s48, 135168, 0
    s_sub_u32 s46, s46, s48
    s_lshl_b32 s44, s50, 15
    s_lshl_b32 s45, s4, 13
    s_add_u32 s44, s44, s45
    s_add_u32 s45, s46, s49
    s_add_u32 s50, s50, s41
    s_waitcnt lgkmcnt(3)
    v_mfma_f32_16x16x32_bf16 v[16:19], a[0:3], v[48:51], 0
    v_mfma_f32_16x16x32_bf16 v[20:23], a[4:7], v[48:51], 0
    ds_read_b128 v[64:67], v72 offset:128
    v_mfma_f32_16x16x32_bf16 v[24:27], a[8:11], v[48:51], 0
    v_mfma_f32_16x16x32_bf16 v[28:31], a[12:15], v[48:51], 0
    ds_read_b128 v[68:71], v72 offset:17024
    s_waitcnt lgkmcnt(4)
    v_mfma_f32_16x16x32_bf16 v[32:35], a[0:3], v[52:55], 0
    v_mfma_f32_16x16x32_bf16 v[36:39], a[4:7], v[52:55], 0
    v_mfma_f32_16x16x32_bf16 v[40:43], a[8:11], v[52:55], 0
    v_mfma_f32_16x16x32_bf16 v[44:47], a[12:15], v[52:55], 0
    s_waitcnt lgkmcnt(3)
    v_mfma_f32_16x16x32_bf16 v[16:19], a[16:19], v[56:59], v[16:19]
    v_mfma_f32_16x16x32_bf16 v[20:23], a[20:23], v[56:59], v[20:23]
    ds_read_b128 v[48:51], v72 offset:192
    v_mfma_f32_16x16x32_bf16 v[24:27], a[24:27], v[56:59], v[24:27]
    v_mfma_f32_16x16x32_bf16 v[28:31], a[28:31], v[56:59], v[28:31]
    ds_read_b128 v[52:55], v72 offset:17088
    s_waitcnt lgkmcnt(4)
    v_mfma_f32_16x16x32_bf16 v[32:35], a[16:19], v[60:63], v[32:35]
    v_mfma_f32_16x16x32_bf16 v[36:39], a[20:23], v[60:63], v[36:39]
    s_add_u32 m0, s45, 0
    v_mfma_f32_16x16x32_bf16 v[40:43], a[24:27], v[60:63], v[40:43]
    buffer_load_dwordx4 v0, s[24:27], s44 offen lds
    v_mfma_f32_16x16x32_bf16 v[44:47], a[28:31], v[60:63], v[44:47]
    s_waitcnt lgkmcnt(3)
    v_mfma_f32_16x16x32_bf16 v[16:19], a[32:35], v[64:67], v[16:19]
    v_mfma_f32_16x16x32_bf16 v[20:23], a[36:39], v[64:67], v[20:23]
    ds_read_b128 v[56:59], v72 offset:256
    v_mfma_f32_16x16x32_bf16 v[24:27], a[40:43], v[64:67], v[24:27]
    v_mfma_f32_16x16x32_bf16 v[28:31], a[44:47], v[64:67], v[28:31]
    ds_read_b128 v[60:63], v72 offset:17152
    s_waitcnt lgkmcnt(4)
    v_mfma_f32_16x16x32_bf16 v[32:35], a[32:35], v[68:71], v[32:35]
    v_mfma_f32_16x16x32_bf16 v[36:39], a[36:39], v[68:71], v[36:39]
    s_add_u32 m0, s45, 1056
    s_add_u32 s44, s44, 1024
    v_mfma_f32_16x16x32_bf16 v[40:43], a[40:43], v[68:71], v[40:43]
    buffer_load_dwordx4 v0, s[24:27], s44 offen lds
    v_mfma_f32_16x16x32_bf16 v[44:47], a[44:47], v[68:71], v[44:47]
    s_waitcnt lgkmcnt(3)
    v_mfma_f32_16x16x32_bf16 v[16:19], a[48:51], v[48:51], v[16:19]
    v_mfma_f32_16x16x32_bf16 v[20:23], a[52:55], v[48:51], v[20:23]
    ds_read_b128 v[64:67], v72 offset:320
    v_mfma_f32_16x16x32_bf16 v[24:27], a[56:59], v[48:51], v[24:27]
    v_mfma_f32_16x16x32_bf16 v[28:31], a[60:63], v[48:51], v[28:31]
    ds_read_b128 v[68:71], v72 offset:17216
    s_waitcnt lgkmcnt(4)
    v_mfma_f32_16x16x32_bf16 v[32:35], a[48:51], v[52:55], v[32:35]
    v_mfma_f32_16x16x32_bf16 v[36:39], a[52:55], v[52:55], v[36:39]
    s_add_u32 m0, s45, 2112
    s_add_u32 s44, s44, 1024
    v_mfma_f32_16x16x32_bf16 v[40:43], a[56:59], v[52:55], v[40:43]
    buffer_load_dwordx4 v0, s[24:27], s44 offen lds
    v_mfma_f32_16x16x32_bf16 v[44:47], a[60:63], v[52:55], v[44:47]
    s_waitcnt lgkmcnt(3)
    v_mfma_f32_16x16x32_bf16 v[16:19], a[64:67], v[56:59], v[16:19]
    v_mfma_f32_16x16x32_bf16 v[20:23], a[68:71], v[56:59], v[20:23]
    ds_read_b128 v[48:51], v72 offset:384
    v_mfma_f32_16x16x32_bf16 v[24:27], a[72:75], v[56:59], v[24:27]
    v_mfma_f32_16x16x32_bf16 v[28:31], a[76:79], v[56:59], v[28:31]
    ds_read_b128 v[52:55], v72 offset:17280
    s_waitcnt lgkmcnt(4)
    v_mfma_f32_16x16x32_bf16 v[32:35], a[64:67], v[60:63], v[32:35]
    v_mfma_f32_16x16x32_bf16 v[36:39], a[68:71], v[60:63], v[36:39]
    s_add_u32 m0, s45, 3168
    s_add_u32 s44, s44, 1024
    v_mfma_f32_16x16x32_bf16 v[40:43], a[72:75], v[60:63], v[40:43]
    buffer_load_dwordx4 v0, s[24:27], s44 offen lds
    v_mfma_f32_16x16x32_bf16 v[44:47], a[76:79], v[60:63], v[44:47]
    s_waitcnt lgkmcnt(3)
    v_mfma_f32_16x16x32_bf16 v[16:19], a[80:83], v[64:67], v[16:19]
    v_mfma_f32_16x16x32_bf16 v[20:23], a[84:87], v[64:67], v[20:23]
    ds_read_b128 v[56:59], v72 offset:448
    v_mfma_f32_16x16x32_bf16 v[24:27], a[88:91], v[64:67], v[24:27]
    v_mfma_f32_16x16x32_bf16 v[28:31], a[92:95], v[64:67], v[28:31]
    ds_read_b128 v[60:63], v72 offset:17344
    s_waitcnt lgkmcnt(4)
    v_mfma_f32_16x16x32_bf16 v[32:35], a[80:83], v[68:71], v[32:35]
    v_mfma_f32_16x16x32_bf16 v[36:39], a[84:87], v[68:71], v[36:39]
    s_add_u32 m0, s45, 4224
    s_add_u32 s44, s44, 1024
    v_mfma_f32_16x16x32_bf16 v[40:43], a[88:91], v[68:71], v[40:43]
    buffer_load_dwordx4 v0, s[24:27], s44 offen lds
    v_mfma_f32_16x16x32_bf16 v[44:47], a[92:95], v[68:71], v[44:47]
    s_waitcnt lgkmcnt(3)
    v_mfma_f32_16x16x32_bf16 v[16:19], a[96:99], v[48:51], v[16:19]
    v_mfma_f32_16x16x32_bf16 v[20:23], a[100:103], v[48:51], v[20:23]
    ds_read_b128 v[64:67], v72 offset:512
    v_mfma_f32_16x16x32_bf16 v[24:27], a[104:107], v[48:51], v[24:27]
    v_mfma_f32_16x16x32_bf16 v[28:31], a[108:111], v[48:51], v[28:31]
    ds_read_b128 v[68:71], v72 offset:17408
    s_waitcnt lgkmcnt(4)
    v_mfma_f32_16x16x32_bf16 v[32:35], a[96:99], v[52:55], v[32:35]
    v_mfma_f32_16x16x32_bf16 v[36:39], a[100:103], v[52:55], v[36:39]
    s_add_u32 m0, s45, 5280
    s_add_u32 s44, s44, 1024
    v_mfma_f32_16x16x32_bf16 v[40:43], a[104:107], v[52:55], v[40:43]
    buffer_load_dwordx4 v0, s[24:27], s44 offen lds
    v_mfma_f32_16x16x32_bf16 v[44:47], a[108:111], v[52:55], v[44:47]
    s_waitcnt lgkmcnt(3)
    v_mfma_f32_16x16x32_bf16 v[16:19], a[112:115], v[56:59], v[16:19]
    v_mfma_f32_16x16x32_bf16 v[20:23], a[116:119], v[56:59], v[20:23]
    ds_read_b128 v[48:51], v72 offset:576
    v_mfma_f32_16x16x32_bf16 v[24:27], a[120:123], v[56:59], v[24:27]
    v_mfma_f32_16x16x32_bf16 v[28:31], a[124:127], v[56:59], v[28:31]
    ds_read_b128 v[52:55], v72 offset:17472
    s_waitcnt lgkmcnt(4)
    v_mfma_f32_16x16x32_bf16 v[32:35], a[112:115], v[60:63], v[32:35]
    v_mfma_f32_16x16x32_bf16 v[36:39], a[116:119], v[60:63], v[36:39]
    s_add_u32 m0, s45, 6336
    s_add_u32 s44, s44, 1024
    v_mfma_f32_16x16x32_bf16 v[40:43], a[120:123], v[60:63], v[40:43]
    buffer_load_dwordx4 v0, s[24:27], s44 offen lds
    v_mfma_f32_16x16x32_bf16 v[44:47], a[124:127], v[60:63], v[44:47]
    s_waitcnt lgkmcnt(3)
    v_mfma_f32_16x16x32_bf16 v[16:19], a[128:131], v[64:67], v[16:19]
    v_mfma_f32_16x16x32_bf16 v[20:23], a[132:135], v[64:67], v[20:23]
    ds_read_b128 v[56:59], v72 offset:640
    v_mfma_f32_16x16x32_bf16 v[24:27], a[136:139], v[64:67], v[24:27]
    v_mfma_f32_16x16x32_bf16 v[28:31], a[140:143], v[64:67], v[28:31]
    ds_read_b128 v[60:63], v72 offset:17536
    s_waitcnt lgkmcnt(4)
    v_mfma_f32_16x16x32_bf16 v[32:35], a[128:131], v[68:71], v[32:35]
    v_mfma_f32_16x16x32_bf16 v[36:39], a[132:135], v[68:71], v[36:39]
    s_add_u32 m0, s45, 7392
    s_add_u32 s44, s44, 1024
    v_mfma_f32_16x16x32_bf16 v[40:43], a[136:139], v[68:71], v[40:43]
    buffer_load_dwordx4 v0, s[24:27], s44 offen lds
    v_mfma_f32_16x16x32_bf16 v[44:47], a[140:143], v[68:71], v[44:47]
    s_waitcnt lgkmcnt(3)
    v_mfma_f32_16x16x32_bf16 v[16:19], a[144:147], v[48:51], v[16:19]
    v_mfma_f32_16x16x32_bf16 v[20:23], a[148:151], v[48:51], v[20:23]
    ds_read_b128 v[64:67], v72 offset:704
    v_mfma_f32_16x16x32_bf16 v[24:27], a[152:155], v[48:51], v[24:27]
    v_mfma_f32_16x16x32_bf16 v[28:31], a[156:159], v[48:51], v[28:31]
    ds_read_b128 v[68:71], v72 offset:17600
    s_waitcnt lgkmcnt(4)
    v_mfma_f32_16x16x32_bf16 v[32:35], a[144:147], v[52:55], v[32:35]
    v_mfma_f32_16x16x32_bf16 v[36:39], a[148:151], v[52:55], v[36:39]
    v_mfma_f32_16x16x32_bf16 v[40:43], a[152:155], v[52:55], v[40:43]
    v_mfma_f32_16x16x32_bf16 v[44:47], a[156:159], v[52:55], v[44:47]
    s_waitcnt lgkmcnt(3)
    v_mfma_f32_16x16x32_bf16 v[16:19], a[160:163], v[56:59], v[16:19]
    v_mfma_f32_16x16x32_bf16 v[20:23], a[164:167], v[56:59], v[20:23]
    ds_read_b128 v[48:51], v72 offset:768
    v_mfma_f32_16x16x32_bf16 v[24:27], a[168:171], v[56:59], v[24:27]
    v_mfma_f32_16x16x32_bf16 v[28:31], a[172:175], v[56:59], v[28:31]
    ds_read_b128 v[52:55], v72 offset:17664
    s_waitcnt lgkmcnt(4)
    v_mfma_f32_16x16x32_bf16 v[32:35], a[160:163], v[60:63], v[32:35]
    v_mfma_f32_16x16x32_bf16 v[36:39], a[164:167], v[60:63], v[36:39]
    v_mfma_f32_16x16x32_bf16 v[40:43], a[168:171], v[60:63], v[40:43]
    v_mfma_f32_16x16x32_bf16 v[44:47], a[172:175], v[60:63], v[44:47]
    s_waitcnt lgkmcnt(3)
    v_mfma_f32_16x16x32_bf16 v[16:19], a[176:179], v[64:67], v[16:19]
    v_mfma_f32_16x16x32_bf16 v[20:23], a[180:183], v[64:67], v[20:23]
    ds_read_b128 v[56:59], v72 offset:832
    v_mfma_f32_16x16x32_bf16 v[24:27], a[184:187], v[64:67], v[24:27]
    v_mfma_f32_16x16x32_bf16 v[28:31], a[188:191], v[64:67], v[28:31]
    ds_read_b128 v[60:63], v72 offset:17728
    s_waitcnt lgkmcnt(4)
    v_mfma_f32_16x16x32_bf16 v[32:35], a[176:179], v[68:71], v[32:35]
    v_mfma_f32_16x16x32_bf16 v[36:39], a[180:183], v[68:71], v[36:39]
    v_mfma_f32_16x16x32_bf16 v[40:43], a[184:187], v[68:71], v[40:43]
    v_mfma_f32_16x16x32_bf16 v[44:47], a[188:191], v[68:71], v[44:47]
    s_waitcnt lgkmcnt(3)
    v_mfma_f32_16x16x32_bf16 v[16:19], a[192:195], v[48:51], v[16:19]
    v_mfma_f32_16x16x32_bf16 v[20:23], a[196:199], v[48:51], v[20:23]
    ds_read_b128 v[64:67], v72 offset:896
    v_mfma_f32_16x16x32_bf16 v[24:27], a[200:203], v[48:51], v[24:27]
    v_mfma_f32_16x16x32_bf16 v[28:31], a[204:207], v[48:51], v[28:31]
    ds_read_b128 v[68:71], v72 offset:17792
    s_waitcnt lgkmcnt(4)
    v_mfma_f32_16x16x32_bf16 v[32:35], a[192:195], v[52:55], v[32:35]
    v_mfma_f32_16x16x32_bf16 v[36:39], a[196:199], v[52:55], v[36:39]
    v_mfma_f32_16x16x32_bf16 v[40:43], a[200:203], v[52:55], v[40:43]
    v_mfma_f32_16x16x32_bf16 v[44:47], a[204:207], v[52:55], v[44:47]
    s_waitcnt lgkmcnt(3)
    v_mfma_f32_16x16x32_bf16 v[16:19], a[208:211], v[56:59], v[16:19]
    v_mfma_f32_16x16x32_bf16 v[20:23], a[212:215], v[56:59], v[20:23]
    ds_read_b128 v[48:51], v72 offset:960
    v_mfma_f32_16x16x32_bf16 v[24:27], a[216:219], v[56:59], v[24:27]
    v_mfma_f32_16x16x32_bf16 v[28:31], a[220:223], v[56:59], v[28:31]
    ds_read_b128 v[52:55], v72 offset:17856
    s_waitcnt lgkmcnt(4)
    v_mfma_f32_16x16x32_bf16 v[32:35], a[208:211], v[60:63], v[32:35]
    v_mfma_f32_16x16x32_bf16 v[36:39], a[212:215], v[60:63], v[36:39]
    v_mfma_f32_16x16x32_bf16 v[40:43], a[216:219], v[60:63], v[40:43]
    v_mfma_f32_16x16x32_bf16 v[44:47], a[220:223], v[60:63], v[44:47]
    s_waitcnt lgkmcnt(3)
    v_mfma_f32_16x16x32_bf16 v[16:19], a[224:227], v[64:67], v[16:19]
    v_mfma_f32_16x16x32_bf16 v[20:23], a[228:231], v[64:67], v[20:23]
    v_mfma_f32_16x16x32_bf16 v[24:27], a[232:235], v[64:67], v[24:27]
    v_mfma_f32_16x16x32_bf16 v[28:31], a[236:239], v[64:67], v[28:31]
    s_waitcnt lgkmcnt(2)
    v_mfma_f32_16x16x32_bf16 v[32:35], a[224:227], v[68:71], v[32:35]
    v_mfma_f32_16x16x32_bf16 v[36:39], a[228:231], v[68:71], v[36:39]
    v_mfma_f32_16x16x32_bf16 v[40:43], a[232:235], v[68:71], v[40:43]
    v_mfma_f32_16x16x32_bf16 v[44:47], a[236:239], v[68:71], v[44:47]
    s_waitcnt lgkmcnt(1)
    v_mfma_f32_16x16x32_bf16 v[16:19], a[240:243], v[48:51], v[16:19]
    v_mfma_f32_16x16x32_bf16 v[20:23], a[244:247], v[48:51], v[20:23]
    v_mfma_f32_16x16x32_bf16 v[24:27], a[248:251], v[48:51], v[24:27]
    v_mfma_f32_16x16x32_bf16 v[28:31], a[252:255], v[48:51], v[28:31]
    s_waitcnt lgkmcnt(0)
    v_mfma_f32_16x16x32_bf16 v[32:35], a[240:243], v[52:55], v[32:35]
    v_mfma_f32_16x16x32_bf16 v[36:39], a[244:247], v[52:55], v[36:39]
    v_mfma_f32_16x16x32_bf16 v[40:43], a[248:251], v[52:55], v[40:43]
    v_mfma_f32_16x16x32_bf16 v[44:47], a[252:255], v[52:55], v[44:47]
    s_mul_i32 s44, s40, s51
    s_add_u32 s44, s44, s43
    s_add_u32 s45, s44, 44032
    s_mov_b32 s46, 0xbfb8aa3b
    v_cvt_pk_bf16_f32 v92, v16, v20
    v_cvt_pk_bf16_f32 v93, v17, v21
    v_cvt_pk_bf16_f32 v94, v18, v22
    v_cvt_pk_bf16_f32 v95, v19, v23
    v_lshlrev_b32 v16, 16, v92
    v_and_b32 v20, 0xffff0000, v92
    v_lshlrev_b32 v17, 16, v93
    v_and_b32 v21, 0xffff0000, v93
    v_lshlrev_b32 v18, 16, v94
    v_and_b32 v22, 0xffff0000, v94
    v_lshlrev_b32 v19, 16, v95
    v_and_b32 v23, 0xffff0000, v95
    v_cvt_pk_bf16_f32 v92, v24, v28
    v_cvt_pk_bf16_f32 v93, v25, v29
    v_cvt_pk_bf16_f32 v94, v26, v30
    v_cvt_pk_bf16_f32 v95, v27, v31
    v_lshlrev_b32 v24, 16, v92
    v_and_b32 v28, 0xffff0000, v92
    v_lshlrev_b32 v25, 16, v93
    v_and_b32 v29, 0xffff0000, v93
    v_lshlrev_b32 v26, 16, v94
    v_and_b32 v30, 0xffff0000, v94
    v_lshlrev_b32 v27, 16, v95
    v_and_b32 v31, 0xffff0000, v95
    v_mul_f32 v84, s46, v16
    v_mul_f32 v85, s46, v20
    v_mul_f32 v86, s46, v17
    v_mul_f32 v87, s46, v21
    v_mul_f32 v88, s46, v18
    v_mul_f32 v89, s46, v22
    v_mul_f32 v90, s46, v19
    v_mul_f32 v91, s46, v23
    v_exp_f32 v84, v84
    v_exp_f32 v85, v85
    v_exp_f32 v86, v86
    v_exp_f32 v87, v87
    v_exp_f32 v88, v88
    v_exp_f32 v89, v89
    v_exp_f32 v90, v90
    v_exp_f32 v91, v91
    v_add_f32 v84, 1.0, v84
    v_add_f32 v85, 1.0, v85
    v_add_f32 v86, 1.0, v86
    v_add_f32 v87, 1.0, v87
    v_add_f32 v88, 1.0, v88
    v_add_f32 v89, 1.0, v89
    v_add_f32 v90, 1.0, v90
    v_add_f32 v91, 1.0, v91
    v_rcp_f32 v84, v84
    v_rcp_f32 v85, v85
    v_rcp_f32 v86, v86
    v_rcp_f32 v87, v87
    v_rcp_f32 v88, v88
    v_rcp_f32 v89, v89
    v_rcp_f32 v90, v90
    v_rcp_f32 v91, v91
    v_mul_f32 v16, v16, v84
    v_mul_f32 v20, v20, v85
    v_mul_f32 v17, v17, v86
    v_mul_f32 v21, v21, v87
    v_mul_f32 v18, v18, v88
    v_mul_f32 v22, v22, v89
    v_mul_f32 v19, v19, v90
    v_mul_f32 v23, v23, v91
    v_cvt_pk_bf16_f32 v92, v16, v20
    v_cvt_pk_bf16_f32 v93, v17, v21
    v_cvt_pk_bf16_f32 v94, v18, v22
    v_cvt_pk_bf16_f32 v95, v19, v23
    v_lshlrev_b32 v16, 16, v92
    v_and_b32 v20, 0xffff0000, v92
    v_lshlrev_b32 v17, 16, v93
    v_and_b32 v21, 0xffff0000, v93
    v_lshlrev_b32 v18, 16, v94
    v_and_b32 v22, 0xffff0000, v94
    v_lshlrev_b32 v19, 16, v95
    v_and_b32 v23, 0xffff0000, v95
    v_mul_f32 v16, v16, v24
    v_mul_f32 v20, v20, v28
    v_mul_f32 v17, v17, v25
    v_mul_f32 v21, v21, v29
    v_mul_f32 v18, v18, v26
    v_mul_f32 v22, v22, v30
    v_mul_f32 v19, v19, v27
    v_mul_f32 v23, v23, v31
    v_cvt_pk_bf16_f32 v76, v16, v20
    v_cvt_pk_bf16_f32 v77, v17, v21
    v_cvt_pk_bf16_f32 v78, v18, v22
    v_cvt_pk_bf16_f32 v79, v19, v23
    buffer_store_dwordx4 v[76:79], v0, s[8:11], s44 offen sc1
    v_cvt_pk_bf16_f32 v92, v32, v36
    v_cvt_pk_bf16_f32 v93, v33, v37
    v_cvt_pk_bf16_f32 v94, v34, v38
    v_cvt_pk_bf16_f32 v95, v35, v39
    v_lshlrev_b32 v32, 16, v92
    v_and_b32 v36, 0xffff0000, v92
    v_lshlrev_b32 v33, 16, v93
    v_and_b32 v37, 0xffff0000, v93
    v_lshlrev_b32 v34, 16, v94
    v_and_b32 v38, 0xffff0000, v94
    v_lshlrev_b32 v35, 16, v95
    v_and_b32 v39, 0xffff0000, v95
    v_cvt_pk_bf16_f32 v92, v40, v44
    v_cvt_pk_bf16_f32 v93, v41, v45
    v_cvt_pk_bf16_f32 v94, v42, v46
    v_cvt_pk_bf16_f32 v95, v43, v47
    v_lshlrev_b32 v40, 16, v92
    v_and_b32 v44, 0xffff0000, v92
    v_lshlrev_b32 v41, 16, v93
    v_and_b32 v45, 0xffff0000, v93
    v_lshlrev_b32 v42, 16, v94
    v_and_b32 v46, 0xffff0000, v94
    v_lshlrev_b32 v43, 16, v95
    v_and_b32 v47, 0xffff0000, v95
    v_mul_f32 v84, s46, v32
    v_mul_f32 v85, s46, v36
    v_mul_f32 v86, s46, v33
    v_mul_f32 v87, s46, v37
    v_mul_f32 v88, s46, v34
    v_mul_f32 v89, s46, v38
    v_mul_f32 v90, s46, v35
    v_mul_f32 v91, s46, v39
    v_exp_f32 v84, v84
    v_exp_f32 v85, v85
    v_exp_f32 v86, v86
    v_exp_f32 v87, v87
    v_exp_f32 v88, v88
    v_exp_f32 v89, v89
    v_exp_f32 v90, v90
    v_exp_f32 v91, v91
    v_add_f32 v84, 1.0, v84
    v_add_f32 v85, 1.0, v85
    v_add_f32 v86, 1.0, v86
    v_add_f32 v87, 1.0, v87
    v_add_f32 v88, 1.0, v88
    v_add_f32 v89, 1.0, v89
    v_add_f32 v90, 1.0, v90
    v_add_f32 v91, 1.0, v91
    v_rcp_f32 v84, v84
    v_rcp_f32 v85, v85
    v_rcp_f32 v86, v86
    v_rcp_f32 v87, v87
    v_rcp_f32 v88, v88
    v_rcp_f32 v89, v89
    v_rcp_f32 v90, v90
    v_rcp_f32 v91, v91
    v_mul_f32 v32, v32, v84
    v_mul_f32 v36, v36, v85
    v_mul_f32 v33, v33, v86
    v_mul_f32 v37, v37, v87
    v_mul_f32 v34, v34, v88
    v_mul_f32 v38, v38, v89
    v_mul_f32 v35, v35, v90
    v_mul_f32 v39, v39, v91
    v_cvt_pk_bf16_f32 v92, v32, v36
    v_cvt_pk_bf16_f32 v93, v33, v37
    v_cvt_pk_bf16_f32 v94, v34, v38
    v_cvt_pk_bf16_f32 v95, v35, v39
    v_lshlrev_b32 v32, 16, v92
    v_and_b32 v36, 0xffff0000, v92
    v_lshlrev_b32 v33, 16, v93
    v_and_b32 v37, 0xffff0000, v93
    v_lshlrev_b32 v34, 16, v94
    v_and_b32 v38, 0xffff0000, v94
    v_lshlrev_b32 v35, 16, v95
    v_and_b32 v39, 0xffff0000, v95
    v_mul_f32 v32, v32, v40
    v_mul_f32 v36, v36, v44
    v_mul_f32 v33, v33, v41
    v_mul_f32 v37, v37, v45
    v_mul_f32 v34, v34, v42
    v_mul_f32 v38, v38, v46
    v_mul_f32 v35, v35, v43
    v_mul_f32 v39, v39, v47
    v_cvt_pk_bf16_f32 v80, v32, v36
    v_cvt_pk_bf16_f32 v81, v33, v37
    v_cvt_pk_bf16_f32 v82, v34, v38
    v_cvt_pk_bf16_f32 v83, v35, v39
    buffer_store_dwordx4 v[80:83], v0, s[8:11], s45 offen sc1
    s_add_u32 s42, s42, 33792
    s_cmp_ge_u32 s42, 135168
    s_cselect_b32 s42, 0, s42
    s_add_u32 s40, s40, s41
    s_cmp_lt_u32 s40, 64
    s_cbranch_scc1 GF_loop
W_r2done:
    s_waitcnt vmcnt(0)
    s_barrier
    s_cmp_lg_u32 s4, 0
    s_cbranch_scc1 W_f2
    s_lshl_b32 s44, s6, 2
    v_mov_b32 v8, 1
    buffer_store_dword v8, off, s[8:11], s44 offset:1024 sc1
W_f2:
    s_lshl_b32 s60, s3, 2
    s_add_u32 s60, s60, 128
    s_cmp_eq_u32 s3, 0
    s_cselect_b32 s60, 0, s60
    v_mov_b32 v8, s60
    buffer_load_dword v9, v8, s[12:15], 0 offen sc1
    s_waitcnt vmcnt(0)
    v_readfirstlane_b32 s7, v9
    s_nop 0
    s_cmp_ge_u32 s7, 32
    s_cselect_b32 s7, 1, 0
    s_load_dwordx2 s[16:17], s[0:1], 40
    s_mov_b32 s18, 0x400000
    s_mov_b32 s19, 0x20000
    s_load_dwordx2 s[20:21], s[0:1], 80
    s_mov_b32 s22, 0x158000
    s_mov_b32 s23, 0x20000
    s_load_dwordx2 s[28:29], s[0:1], 96
    s_mov_b32 s30, 0x200000
    s_mov_b32 s31, 0x20000
    s_lshr_b32 s63, s6, 4
    s_and_b32 s64, s6, 15
    s_lshl_b32 s44, s64, 6
    s_mov_b32 s55, s44
    v_mul_u32_u24 v4, 8192, v2
    v_lshl_add_u32 v4, v1, 2, v4
    v_add_u32 v4, s44, v4
    v_add_u32 v5, 1024, v4
    v_mov_b32 v6, v4
    v_mov_b32 v7, v5
    s_lshl_b32 s47, s4, 20
    s_mul_i32 s50, s4, 0x58000
    s_waitcnt lgkmcnt(0)
    s_add_u32 s46, s47, 0x0
    buffer_load_dword v100, v4, s[16:19], s46 offen
    buffer_load_dword v101, v5, s[16:19], s46 offen
    s_add_u32 s46, s47, 0x800
    buffer_load_dword v102, v4, s[16:19], s46 offen
    buffer_load_dword v103, v5, s[16:19], s46 offen
    s_add_u32 s46, s47, 0x1000
    buffer_load_dword v104, v4, s[16:19], s46 offen
    buffer_load_dword v105, v5, s[16:19], s46 offen
    s_add_u32 s46, s47, 0x1800
    buffer_load_dword v106, v4, s[16:19], s46 offen
    buffer_load_dword v107, v5, s[16:19], s46 offen
    s_add_u32 s46, s47, 0x8000
    buffer_load_dword v108, v4, s[16:19], s46 offen
    buffer_load_dword v109, v5, s[16:19], s46 offen
    s_add_u32 s46, s47, 0x8800
    buffer_load_dword v110, v4, s[16:19], s46 offen
    buffer_load_dword v111, v5, s[16:19], s46 offen
    s_add_u32 s46, s47, 0x9000
    buffer_load_dword v112, v4, s[16:19], s46 offen
    buffer_load_dword v113, v5, s[16:19], s46 offen
    s_add_u32 s46, s47, 0x9800
    buffer_load_dword v114, v4, s[16:19], s46 offen
    buffer_load_dword v115, v5, s[16:19], s46 offen
    s_add_u32 s46, s47, 0x10000
    buffer_load_dword v116, v4, s[16:19], s46 offen
    buffer_load_dword v117, v5, s[16:19], s46 offen
    s_add_u32 s46, s47, 0x10800
    buffer_load_dword v118, v4, s[16:19], s46 offen
    buffer_load_dword v119, v5, s[16:19], s46 offen
    s_add_u32 s46, s47, 0x11000
    buffer_load_dword v120, v4, s[16:19], s46 offen
    buffer_load_dword v121, v5, s[16:19], s46 offen
    s_add_u32 s46, s47, 0x11800
    buffer_load_dword v122, v4, s[16:19], s46 offen
    buffer_load_dword v123, v5, s[16:19], s46 offen
    s_add_u32 s46, s47, 0x18000
    buffer_load_dword v124, v4, s[16:19], s46 offen
    buffer_load_dword v125, v5, s[16:19], s46 offen
    s_add_u32 s46, s47, 0x18800
    buffer_load_dword v126, v4, s[16:19], s46 offen
    buffer_load_dword v127, v5, s[16:19], s46 offen
    s_add_u32 s46, s47, 0x19000
    buffer_load_dword v128, v4, s[16:19], s46 offen
    buffer_load_dword v129, v5, s[16:19], s46 offen
    s_add_u32 s46, s47, 0x19800
    buffer_load_dword v130, v4, s[16:19], s46 offen
    buffer_load_dword v131, v5, s[16:19], s46 offen
    s_add_u32 s46, s47, 0x20000
    buffer_load_dword v132, v4, s[16:19], s46 offen
    buffer_load_dword v133, v5, s[16:19], s46 offen
    s_add_u32 s46, s47, 0x20800
    buffer_load_dword v134, v4, s[16:19], s46 offen
    buffer_load_dword v135, v5, s[16:19], s46 offen
    s_add_u32 s46, s47, 0x21000
    buffer_load_dword v136, v4, s[16:19], s46 offen
    buffer_load_dword v137, v5, s[16:19], s46 offen
    s_add_u32 s46, s47, 0x21800
    buffer_load_dword v138, v4, s[16:19], s46 offen
    buffer_load_dword v139, v5, s[16:19], s46 offen
    s_add_u32 s46, s47, 0x28000
    buffer_load_dword v140, v4, s[16:19], s46 offen
    buffer_load_dword v141, v5, s[16:19], s46 offen
    s_add_u32 s46, s47, 0x28800
    buffer_load_dword v142, v4, s[16:19], s46 offen
    buffer_load_dword v143, v5, s[16:19], s46 offen
    s_add_u32 s46, s47, 0x29000
    buffer_load_dword v144, v4, s[16:19], s46 offen
    buffer_load_dword v145, v5, s[16:19], s46 offen
    s_add_u32 s46, s47, 0x29800
    buffer_load_dword v146, v4, s[16:19], s46 offen
    buffer_load_dword v147, v5, s[16:19], s46 offen
    s_add_u32 s46, s47, 0x30000
    buffer_load_dword v148, v4, s[16:19], s46 offen
    buffer_load_dword v149, v5, s[16:19], s46 offen
    s_add_u32 s46, s47, 0x30800
    buffer_load_dword v150, v4, s[16:19], s46 offen
    buffer_load_dword v151, v5, s[16:19], s46 offen
    s_add_u32 s46, s47, 0x31000
    buffer_load_dword v152, v4, s[16:19], s46 offen
    buffer_load_dword v153, v5, s[16:19], s46 offen
    s_add_u32 s46, s47, 0x31800
    buffer_load_dword v154, v4, s[16:19], s46 offen
    buffer_load_dword v155, v5, s[16:19], s46 offen
    s_add_u32 s46, s47, 0x38000
    buffer_load_dword v156, v4, s[16:19], s46 offen
    buffer_load_dword v157, v5, s[16:19], s46 offen
    s_waitcnt vmcnt(56)
    v_perm_b32 v8, v101, v100, s37
    v_accvgpr_write_b32 a0, v8
    v_perm_b32 v9, v101, v100, s38
    v_accvgpr_write_b32 a4, v9
    s_add_u32 s46, s47, 0x38800
    buffer_load_dword v158, v4, s[16:19], s46 offen
    buffer_load_dword v159, v5, s[16:19], s46 offen
    s_add_u32 s46, s47, 0x39000
    buffer_load_dword v160, v4, s[16:19], s46 offen
    buffer_load_dword v161, v5, s[16:19], s46 offen
    s_waitcnt vmcnt(58)
    v_perm_b32 v8, v103, v102, s37
    v_accvgpr_write_b32 a1, v8
    v_perm_b32 v9, v103, v102, s38
    v_accvgpr_write_b32 a5, v9
    s_add_u32 s46, s47, 0x39800
    buffer_load_dword v162, v4, s[16:19], s46 offen
    buffer_load_dword v163, v5, s[16:19], s46 offen
    s_waitcnt vmcnt(58)
    v_perm_b32 v8, v105, v104, s37
    v_accvgpr_write_b32 a2, v8
    v_perm_b32 v9, v105, v104, s38
    v_accvgpr_write_b32 a6, v9
    s_add_u32 s46, s47, 0x40000
    buffer_load_dword v100, v4, s[16:19], s46 offen
    buffer_load_dword v101, v5, s[16:19], s46 offen
    s_waitcnt vmcnt(58)
    v_perm_b32 v8, v107, v106, s37
    v_accvgpr_write_b32 a3, v8
    v_perm_b32 v9, v107, v106, s38
    v_accvgpr_write_b32 a7, v9
    s_add_u32 s46, s47, 0x40800
    buffer_load_dword v102, v4, s[16:19], s46 offen
    buffer_load_dword v103, v5, s[16:19], s46 offen
    s_waitcnt vmcnt(58)
    v_perm_b32 v8, v109, v108, s37
    v_accvgpr_write_b32 a8, v8
    v_perm_b32 v9, v109, v108, s38
    v_accvgpr_write_b32 a12, v9
    s_add_u32 s46, s47, 0x41000
    buffer_load_dword v104, v4, s[16:19], s46 offen
    buffer_load_dword v105, v5, s[16:19], s46 offen
    s_waitcnt vmcnt(58)
    v_perm_b32 v8, v111, v110, s37
    v_accvgpr_write_b32 a9, v8
    v_perm_b32 v9, v111, v110, s38
    v_accvgpr_write_b32 a13, v9
    s_add_u32 s46, s47, 0x41800
    buffer_load_dword v106, v4, s[16:19], s46 offen
    buffer_load_dword v107, v5, s[16:19], s46 offen
    s_waitcnt vmcnt(58)
    v_perm_b32 v8, v113, v112, s37
    v_accvgpr_write_b32 a10, v8
    v_perm_b32 v9, v113, v112, s38
    v_accvgpr_write_b32 a14, v9
    s_add_u32 s46, s47, 0x48000
    buffer_load_dword v108, v4, s[16:19], s46 offen
    buffer_load_dword v109, v5, s[16:19], s46 offen
    s_waitcnt vmcnt(58)
    v_perm_b32 v8, v115, v114, s37
    v_accvgpr_write_b32 a11, v8
    v_perm_b32 v9, v115, v114, s38
    v_accvgpr_write_b32 a15, v9
    s_add_u32 s46, s47, 0x48800
    buffer_load_dword v110, v4, s[16:19], s46 offen
    buffer_load_dword v111, v5, s[16:19], s46 offen
    s_waitcnt vmcnt(58)
    v_perm_b32 v8, v117, v116, s37
    v_accvgpr_write_b32 a16, v8
    v_perm_b32 v9, v117, v116, s38
    v_accvgpr_write_b32 a20, v9
    s_add_u32 s46, s47, 0x49000
    buffer_load_dword v112, v4, s[16:19], s46 offen
    buffer_load_dword v113, v5, s[16:19], s46 offen
    s_waitcnt vmcnt(58)
    v_perm_b32 v8, v119, v118, s37
    v_accvgpr_write_b32 a17, v8
    v_perm_b32 v9, v119, v118, s38
    v_accvgpr_write_b32 a21, v9
    s_add_u32 s46, s47, 0x49800
    buffer_load_dword v114, v4, s[16:19], s46 offen
    buffer_load_dword v115, v5, s[16:19], s46 offen
    s_waitcnt vmcnt(58)
    v_perm_b32 v8, v121, v120, s37
    v_accvgpr_write_b32 a18, v8
    v_perm_b32 v9, v121, v120, s38
    v_accvgpr_write_b32 a22, v9
    s_add_u32 s46, s47, 0x50000
    buffer_load_dword v116, v4, s[16:19], s46 offen
    buffer_load_dword v117, v5, s[16:19], s46 offen
    s_waitcnt vmcnt(58)
    v_perm_b32 v8, v123, v122, s37
    v_accvgpr_write_b32 a19, v8
    v_perm_b32 v9, v123, v122, s38
    v_accvgpr_write_b32 a23, v9
    s_add_u32 s46, s47, 0x50800
    buffer_load_dword v118, v4, s[16:19], s46 offen
    buffer_load_dword v119, v5, s[16:19], s46 offen
    s_waitcnt vmcnt(58)
    v_perm_b32 v8, v125, v124, s37
    v_accvgpr_write_b32 a24, v8
    v_perm_b32 v9, v125, v124, s38
    v_accvgpr_write_b32 a28, v9
    s_add_u32 s46, s47, 0x51000
    buffer_load_dword v120, v4, s[16:19], s46 offen
    buffer_load_dword v121, v5, s[16:19], s46 offen
    s_waitcnt vmcnt(58)
    v_perm_b32 v8, v127, v126, s37
    v_accvgpr_write_b32 a25, v8
    v_perm_b32 v9, v127, v126, s38
    v_accvgpr_write_b32 a29, v9
    s_add_u32 s46, s47, 0x51800
    buffer_load_dword v122, v4, s[16:19], s46 offen
    buffer_load_dword v123, v5, s[16:19], s46 offen
    s_waitcnt vmcnt(58)
    v_perm_b32 v8, v129, v128, s37
    v_accvgpr_write_b32 a26, v8
    v_perm_b32 v9, v129, v128, s38
    v_accvgpr_write_b32 a30, v9
    s_add_u32 s46, s47, 0x58000
    buffer_load_dword v124, v4, s[16:19], s46 offen
    buffer_load_dword v125, v5, s[16:19], s46 offen
    s_waitcnt vmcnt(58)
    v_perm_b32 v8, v131, v130, s37
    v_accvgpr_write_b32 a27, v8
    v_perm_b32 v9, v131, v130, s38
    v_accvgpr_write_b32 a31, v9
    s_add_u32 s46, s47, 0x58800
    buffer_load_dword v126, v4, s[16:19], s46 offen
    buffer_load_dword v127, v5, s[16:19], s46 offen
    s_waitcnt vmcnt(58)
    v_perm_b32 v8, v133, v132, s37
    v_accvgpr_write_b32 a32, v8
    v_perm_b32 v9, v133, v132, s38
    v_accvgpr_write_b32 a36, v9
    s_add_u32 s46, s47, 0x59000
    buffer_load_dword v128, v4, s[16:19], s46 offen
    buffer_load_dword v129, v5, s[16:19], s46 offen
    s_waitcnt vmcnt(58)
    v_perm_b32 v8, v135, v134, s37
    v_accvgpr_write_b32 a33, v8
    v_perm_b32 v9, v135, v134, s38
    v_accvgpr_write_b32 a37, v9
    s_add_u32 s46, s47, 0x59800
    buffer_load_dword v130, v4, s[16:19], s46 offen
    buffer_load_dword v131, v5, s[16:19], s46 offen
    s_waitcnt vmcnt(58)
    v_perm_b32 v8, v137, v136, s37
    v_accvgpr_write_b32 a34, v8
    v_perm_b32 v9, v137, v136, s38
    v_accvgpr_write_b32 a38, v9
    s_add_u32 s46, s47, 0x60000
    buffer_load_dword v132, v4, s[16:19], s46 offen
    buffer_load_dword v133, v5, s[16:19], s46 offen
    s_waitcnt vmcnt(58)
    v_perm_b32 v8, v139, v138, s37
    v_accvgpr_write_b32 a35, v8
    v_perm_b32 v9, v139, v138, s38
    v_accvgpr_write_b32 a39, v9
    s_add_u32 s46, s47, 0x60800
    buffer_load_dword v134, v4, s[16:19], s46 offen
    buffer_load_dword v135, v5, s[16:19], s46 offen
    s_waitcnt vmcnt(58)
    v_perm_b32 v8, v141, v140, s37
    v_accvgpr_write_b32 a40, v8
    v_perm_b32 v9, v141, v140, s38
    v_accvgpr_write_b32 a44, v9
    s_add_u32 s46, s47, 0x61000
    buffer_load_dword v136, v4, s[16:19], s46 offen
    buffer_load_dword v137, v5, s[16:19], s46 offen
    s_waitcnt vmcnt(58)
    v_perm_b32 v8, v143, v142, s37
    v_accvgpr_write_b32 a41, v8
    v_perm_b32 v9, v143, v142, s38
    v_accvgpr_write_b32 a45, v9
    s_add_u32 s46, s47, 0x61800
    buffer_load_dword v138, v4, s[16:19], s46 offen
    buffer_load_dword v139, v5, s[16:19], s46 offen
    s_waitcnt vmcnt(58)
    v_perm_b32 v8, v145, v144, s37
    v_accvgpr_write_b32 a42, v8
    v_perm_b32 v9, v145, v144, s38
    v_accvgpr_write_b32 a46, v9
    s_add_u32 s46, s47, 0x68000
    buffer_load_dword v140, v4, s[16:19], s46 offen
    buffer_load_dword v141, v5, s[16:19], s46 offen
    s_waitcnt vmcnt(58)
    v_perm_b32 v8, v147, v146, s37
    v_accvgpr_write_b32 a43, v8
    v_perm_b32 v9, v147, v146, s38
    v_accvgpr_write_b32 a47, v9
    s_add_u32 s46, s47, 0x68800
    buffer_load_dword v142, v4, s[16:19], s46 offen
    buffer_load_dword v143, v5, s[16:19], s46 offen
    s_waitcnt vmcnt(58)
    v_perm_b32 v8, v149, v148, s37
    v_accvgpr_write_b32 a48, v8
    v_perm_b32 v9, v149, v148, s38
    v_accvgpr_write_b32 a52, v9
    s_add_u32 s46, s47, 0x69000
    buffer_load_dword v144, v4, s[16:19], s46 offen
    buffer_load_dword v145, v5, s[16:19], s46 offen
    s_waitcnt vmcnt(58)
    v_perm_b32 v8, v151, v150, s37
    v_accvgpr_write_b32 a49, v8
    v_perm_b32 v9, v151, v150, s38
    v_accvgpr_write_b32 a53, v9
    s_add_u32 s46, s47, 0x69800
    buffer_load_dword v146, v4, s[16:19], s46 offen
    buffer_load_dword v147, v5, s[16:19], s46 offen
    s_waitcnt vmcnt(58)
    v_perm_b32 v8, v153, v152, s37
    v_accvgpr_write_b32 a50, v8
    v_perm_b32 v9, v153, v152, s38
    v_accvgpr_write_b32 a54, v9
    s_add_u32 s46, s47, 0x70000
    buffer_load_dword v148, v4, s[16:19], s46 offen
    buffer_load_dword v149, v5, s[16:19], s46 offen
    s_waitcnt vmcnt(58)
    v_perm_b32 v8, v155, v154, s37
    v_accvgpr_write_b32 a51, v8
    v_perm_b32 v9, v155, v154, s38
    v_accvgpr_write_b32 a55, v9
    s_add_u32 s46, s47, 0x70800
    buffer_load_dword v150, v4, s[16:19], s46 offen
    buffer_load_dword v151, v5, s[16:19], s46 offen
    s_waitcnt vmcnt(58)
    v_perm_b32 v8, v157, v156, s37
    v_accvgpr_write_b32 a56, v8
    v_perm_b32 v9, v157, v156, s38
    v_accvgpr_write_b32 a60, v9
    s_add_u32 s46, s47, 0x71000
    buffer_load_dword v152, v4, s[16:19], s46 offen
    buffer_load_dword v153, v5, s[16:19], s46 offen
    s_waitcnt vmcnt(58)
    v_perm_b32 v8, v159, v158, s37
    v_accvgpr_write_b32 a57, v8
    v_perm_b32 v9, v159, v158, s38
    v_accvgpr_write_b32 a61, v9
    s_add_u32 s46, s47, 0x71800
    buffer_load_dword v154, v4, s[16:19], s46 offen
    buffer_load_dword v155, v5, s[16:19], s46 offen
    s_waitcnt vmcnt(58)
    v_perm_b32 v8, v161, v160, s37
    v_accvgpr_write_b32 a58, v8
    v_perm_b32 v9, v161, v160, s38
    v_accvgpr_write_b32 a62, v9
    s_add_u32 s46, s47, 0x78000
    buffer_load_dword v156, v4, s[16:19], s46 offen
    buffer_load_dword v157, v5, s[16:19], s46 offen
    s_waitcnt vmcnt(58)
    v_perm_b32 v8, v163, v162, s37
    v_accvgpr_write_b32 a59, v8
    v_perm_b32 v9, v163, v162, s38
    v_accvgpr_write_b32 a63, v9
    s_add_u32 s46, s47, 0x78800
    buffer_load_dword v158, v4, s[16:19], s46 offen
    buffer_load_dword v159, v5, s[16:19], s46 offen
    s_waitcnt vmcnt(58)
    v_perm_b32 v8, v101, v100, s37
    v_accvgpr_write_b32 a64, v8
    v_perm_b32 v9, v101, v100, s38
    v_accvgpr_write_b32 a68, v9
    s_add_u32 s46, s47, 0x79000
    buffer_load_dword v160, v4, s[16:19], s46 offen
    buffer_load_dword v161, v5, s[16:19], s46 offen
    s_waitcnt vmcnt(58)
    v_perm_b32 v8, v103, v102, s37
    v_accvgpr_write_b32 a65, v8
    v_perm_b32 v9, v103, v102, s38
    v_accvgpr_write_b32 a69, v9
    s_add_u32 s46, s47, 0x79800
    buffer_load_dword v162, v4, s[16:19], s46 offen
    buffer_load_dword v163, v5, s[16:19], s46 offen
    s_waitcnt vmcnt(58)
    v_perm_b32 v8, v105, v104, s37
    v_accvgpr_write_b32 a66, v8
    v_perm_b32 v9, v105, v104, s38
    v_accvgpr_write_b32 a70, v9
    s_add_u32 s46, s47, 0x80000
    buffer_load_dword v100, v4, s[16:19], s46 offen
    buffer_load_dword v101, v5, s[16:19], s46 offen
    s_waitcnt vmcnt(58)
    v_perm_b32 v8, v107, v106, s37
    v_accvgpr_write_b32 a67, v8
    v_perm_b32 v9, v107, v106, s38
    v_accvgpr_write_b32 a71, v9
    s_add_u32 s46, s47, 0x80800
    buffer_load_dword v102, v4, s[16:19], s46 offen
    buffer_load_dword v103, v5, s[16:19], s46 offen
    s_waitcnt vmcnt(58)
    v_perm_b32 v8, v109, v108, s37
    v_accvgpr_write_b32 a72, v8
    v_perm_b32 v9, v109, v108, s38
    v_accvgpr_write_b32 a76, v9
    s_add_u32 s46, s47, 0x81000
    buffer_load_dword v104, v4, s[16:19], s46 offen
    buffer_load_dword v105, v5, s[16:19], s46 offen
    s_waitcnt vmcnt(58)
    v_perm_b32 v8, v111, v110, s37
    v_accvgpr_write_b32 a73, v8
    v_perm_b32 v9, v111, v110, s38
    v_accvgpr_write_b32 a77, v9
    s_add_u32 s46, s47, 0x81800
    buffer_load_dword v106, v4, s[16:19], s46 offen
    buffer_load_dword v107, v5, s[16:19], s46 offen
    s_waitcnt vmcnt(58)
    v_perm_b32 v8, v113, v112, s37
    v_accvgpr_write_b32 a74, v8
    v_perm_b32 v9, v113, v112, s38
    v_accvgpr_write_b32 a78, v9
    s_add_u32 s46, s47, 0x88000
    buffer_load_dword v108, v4, s[16:19], s46 offen
    buffer_load_dword v109, v5, s[16:19], s46 offen
    s_waitcnt vmcnt(58)
    v_perm_b32 v8, v115, v114, s37
    v_accvgpr_write_b32 a75, v8
    v_perm_b32 v9, v115, v114, s38
    v_accvgpr_write_b32 a79, v9
    s_add_u32 s46, s47, 0x88800
    buffer_load_dword v110, v4, s[16:19], s46 offen
    buffer_load_dword v111, v5, s[16:19], s46 offen
    s_waitcnt vmcnt(58)
    v_perm_b32 v8, v117, v116, s37
    v_accvgpr_write_b32 a80, v8
    v_perm_b32 v9, v117, v116, s38
    v_accvgpr_write_b32 a84, v9
    s_add_u32 s46, s47, 0x89000
    buffer_load_dword v112, v4, s[16:19], s46 offen
    buffer_load_dword v113, v5, s[16:19], s46 offen
    s_waitcnt vmcnt(58)
    v_perm_b32 v8, v119, v118, s37
    v_accvgpr_write_b32 a81, v8
    v_perm_b32 v9, v119, v118, s38
    v_accvgpr_write_b32 a85, v9
    s_add_u32 s46, s47, 0x89800
    buffer_load_dword v114, v4, s[16:19], s46 offen
    buffer_load_dword v115, v5, s[16:19], s46 offen
    s_waitcnt vmcnt(58)
    v_perm_b32 v8, v121, v120, s37
    v_accvgpr_write_b32 a82, v8
    v_perm_b32 v9, v121, v120, s38
    v_accvgpr_write_b32 a86, v9
    s_add_u32 s46, s47, 0x90000
    buffer_load_dword v116, v4, s[16:19], s46 offen
    buffer_load_dword v117, v5, s[16:19], s46 offen
    s_waitcnt vmcnt(58)
    v_perm_b32 v8, v123, v122, s37
    v_accvgpr_write_b32 a83, v8
    v_perm_b32 v9, v123, v122, s38
    v_accvgpr_write_b32 a87, v9
    s_add_u32 s46, s47, 0x90800
    buffer_load_dword v118, v4, s[16:19], s46 offen
    buffer_load_dword v119, v5, s[16:19], s46 offen
    s_waitcnt vmcnt(58)
    v_perm_b32 v8, v125, v124, s37
    v_accvgpr_write_b32 a88, v8
    v_perm_b32 v9, v125, v124, s38
    v_accvgpr_write_b32 a92, v9
    s_add_u32 s46, s47, 0x91000
    buffer_load_dword v120, v4, s[16:19], s46 offen
    buffer_load_dword v121, v5, s[16:19], s46 offen
    s_waitcnt vmcnt(58)
    v_perm_b32 v8, v127, v126, s37
    v_accvgpr_write_b32 a89, v8
    v_perm_b32 v9, v127, v126, s38
    v_accvgpr_write_b32 a93, v9
    s_add_u32 s46, s47, 0x91800
    buffer_load_dword v122, v4, s[16:19], s46 offen
    buffer_load_dword v123, v5, s[16:19], s46 offen
    s_waitcnt vmcnt(58)
    v_perm_b32 v8, v129, v128, s37
    v_accvgpr_write_b32 a90, v8
    v_perm_b32 v9, v129, v128, s38
    v_accvgpr_write_b32 a94, v9
    s_add_u32 s46, s47, 0x98000
    buffer_load_dword v124, v4, s[16:19], s46 offen
    buffer_load_dword v125, v5, s[16:19], s46 offen
    s_waitcnt vmcnt(58)
    v_perm_b32 v8, v131, v130, s37
    v_accvgpr_write_b32 a91, v8
    v_perm_b32 v9, v131, v130, s38
    v_accvgpr_write_b32 a95, v9
    s_add_u32 s46, s47, 0x98800
    buffer_load_dword v126, v4, s[16:19], s46 offen
    buffer_load_dword v127, v5, s[16:19], s46 offen
    s_waitcnt vmcnt(58)
    v_perm_b32 v8, v133, v132, s37
    v_accvgpr_write_b32 a96, v8
    v_perm_b32 v9, v133, v132, s38
    v_accvgpr_write_b32 a100, v9
    s_add_u32 s46, s47, 0x99000
    buffer_load_dword v128, v4, s[16:19], s46 offen
    buffer_load_dword v129, v5, s[16:19], s46 offen
    s_waitcnt vmcnt(58)
    v_perm_b32 v8, v135, v134, s37
    v_accvgpr_write_b32 a97, v8
    v_perm_b32 v9, v135, v134, s38
    v_accvgpr_write_b32 a101, v9
    s_add_u32 s46, s47, 0x99800
    buffer_load_dword v130, v4, s[16:19], s46 offen
    buffer_load_dword v131, v5, s[16:19], s46 offen
    s_waitcnt vmcnt(58)
    v_perm_b32 v8, v137, v136, s37
    v_accvgpr_write_b32 a98, v8
    v_perm_b32 v9, v137, v136, s38
    v_accvgpr_write_b32 a102, v9
    s_add_u32 s46, s47, 0xa0000
    buffer_load_dword v132, v4, s[16:19], s46 offen
    buffer_load_dword v133, v5, s[16:19], s46 offen
    s_waitcnt vmcnt(58)
    v_perm_b32 v8, v139, v138, s37
    v_accvgpr_write_b32 a99, v8
    v_perm_b32 v9, v139, v138, s38
    v_accvgpr_write_b32 a103, v9
    s_add_u32 s46, s47, 0xa0800
    buffer_load_dword v134, v4, s[16:19], s46 offen
    buffer_load_dword v135, v5, s[16:19], s46 offen
    s_waitcnt vmcnt(58)
    v_perm_b32 v8, v141, v140, s37
    v_accvgpr_write_b32 a104, v8
    v_perm_b32 v9, v141, v140, s38
    v_accvgpr_write_b32 a108, v9
    s_add_u32 s46, s47, 0xa1000
    buffer_load_dword v136, v4, s[16:19], s46 offen
    buffer_load_dword v137, v5, s[16:19], s46 offen
    s_waitcnt vmcnt(58)
    v_perm_b32 v8, v143, v142, s37
    v_accvgpr_write_b32 a105, v8
    v_perm_b32 v9, v143, v142, s38
    v_accvgpr_write_b32 a109, v9
    s_add_u32 s46, s47, 0xa1800
    buffer_load_dword v138, v4, s[16:19], s46 offen
    buffer_load_dword v139, v5, s[16:19], s46 offen
    s_waitcnt vmcnt(58)
    v_perm_b32 v8, v145, v144, s37
    v_accvgpr_write_b32 a106, v8
    v_perm_b32 v9, v145, v144, s38
    v_accvgpr_write_b32 a110, v9
    s_add_u32 s46, s47, 0xa8000
    buffer_load_dword v140, v4, s[16:19], s46 offen
    buffer_load_dword v141, v5, s[16:19], s46 offen
    s_waitcnt vmcnt(58)
    v_perm_b32 v8, v147, v146, s37
    v_accvgpr_write_b32 a107, v8
    v_perm_b32 v9, v147, v146, s38
    v_accvgpr_write_b32 a111, v9
    s_add_u32 s46, s47, 0xa8800
    buffer_load_dword v142, v4, s[16:19], s46 offen
    buffer_load_dword v143, v5, s[16:19], s46 offen
    s_waitcnt vmcnt(58)
    v_perm_b32 v8, v149, v148, s37
    v_accvgpr_write_b32 a112, v8
    v_perm_b32 v9, v149, v148, s38
    v_accvgpr_write_b32 a116, v9
    s_add_u32 s46, s47, 0xa9000
    buffer_load_dword v144, v4, s[16:19], s46 offen
    buffer_load_dword v145, v5, s[16:19], s46 offen
    s_waitcnt vmcnt(58)
    v_perm_b32 v8, v151, v150, s37
    v_accvgpr_write_b32 a113, v8
    v_perm_b32 v9, v151, v150, s38
    v_accvgpr_write_b32 a117, v9
    s_add_u32 s46, s47, 0xa9800
    buffer_load_dword v146, v4, s[16:19], s46 offen
    buffer_load_dword v147, v5, s[16:19], s46 offen
    s_waitcnt vmcnt(58)
    v_perm_b32 v8, v153, v152, s37
    v_accvgpr_write_b32 a114, v8
    v_perm_b32 v9, v153, v152, s38
    v_accvgpr_write_b32 a118, v9
    s_add_u32 s46, s47, 0xb0000
    buffer_load_dword v148, v4, s[16:19], s46 offen
    buffer_load_dword v149, v5, s[16:19], s46 offen
    s_waitcnt vmcnt(58)
    v_perm_b32 v8, v155, v154, s37
    v_accvgpr_write_b32 a115, v8
    v_perm_b32 v9, v155, v154, s38
    v_accvgpr_write_b32 a119, v9
    s_add_u32 s46, s47, 0xb0800
    buffer_load_dword v150, v4, s[16:19], s46 offen
    buffer_load_dword v151, v5, s[16:19], s46 offen
    s_waitcnt vmcnt(58)
    v_perm_b32 v8, v157, v156, s37
    v_accvgpr_write_b32 a120, v8
    v_perm_b32 v9, v157, v156, s38
    v_accvgpr_write_b32 a124, v9
    s_add_u32 s46, s47, 0xb1000
    buffer_load_dword v152, v4, s[16:19], s46 offen
    buffer_load_dword v153, v5, s[16:19], s46 offen
    s_waitcnt vmcnt(58)
    v_perm_b32 v8, v159, v158, s37
    v_accvgpr_write_b32 a121, v8
    v_perm_b32 v9, v159, v158, s38
    v_accvgpr_write_b32 a125, v9
    s_add_u32 s46, s47, 0xb1800
    buffer_load_dword v154, v4, s[16:19], s46 offen
    buffer_load_dword v155, v5, s[16:19], s46 offen
    s_waitcnt vmcnt(58)
    v_perm_b32 v8, v161, v160, s37
    v_accvgpr_write_b32 a122, v8
    v_perm_b32 v9, v161, v160, s38
    v_accvgpr_write_b32 a126, v9
    s_add_u32 s46, s47, 0xb8000
    buffer_load_dword v156, v4, s[16:19], s46 offen
    buffer_load_dword v157, v5, s[16:19], s46 offen
    s_waitcnt vmcnt(58)
    v_perm_b32 v8, v163, v162, s37
    v_accvgpr_write_b32 a123, v8
    v_perm_b32 v9, v163, v162, s38
    v_accvgpr_write_b32 a127, v9
    s_add_u32 s46, s47, 0xb8800
    buffer_load_dword v158, v4, s[16:19], s46 offen
    buffer_load_dword v159, v5, s[16:19], s46 offen
    s_waitcnt vmcnt(58)
    v_perm_b32 v8, v101, v100, s37
    v_accvgpr_write_b32 a128, v8
    v_perm_b32 v9, v101, v100, s38
    v_accvgpr_write_b32 a132, v9
    s_add_u32 s46, s47, 0xb9000
    buffer_load_dword v160, v4, s[16:19], s46 offen
    buffer_load_dword v161, v5, s[16:19], s46 offen
    s_waitcnt vmcnt(58)
    v_perm_b32 v8, v103, v102, s37
    v_accvgpr_write_b32 a129, v8
    v_perm_b32 v9, v103, v102, s38
    v_accvgpr_write_b32 a133, v9
    s_add_u32 s46, s47, 0xb9800
    buffer_load_dword v162, v4, s[16:19], s46 offen
    buffer_load_dword v163, v5, s[16:19], s46 offen
    s_waitcnt vmcnt(58)
    v_perm_b32 v8, v105, v104, s37
    v_accvgpr_write_b32 a130, v8
    v_perm_b32 v9, v105, v104, s38
    v_accvgpr_write_b32 a134, v9
    s_add_u32 s46, s47, 0xc0000
    buffer_load_dword v100, v4, s[16:19], s46 offen
    buffer_load_dword v101, v5, s[16:19], s46 offen
    s_waitcnt vmcnt(58)
    v_perm_b32 v8, v107, v106, s37
    v_accvgpr_write_b32 a131, v8
    v_perm_b32 v9, v107, v106, s38
    v_accvgpr_write_b32 a135, v9
    s_add_u32 s46, s47, 0xc0800
    buffer_load_dword v102, v4, s[16:19], s46 offen
    buffer_load_dword v103, v5, s[16:19], s46 offen
    s_waitcnt vmcnt(58)
    v_perm_b32 v8, v109, v108, s37
    v_accvgpr_write_b32 a136, v8
    v_perm_b32 v9, v109, v108, s38
    v_accvgpr_write_b32 a140, v9
    s_add_u32 s46, s47, 0xc1000
    buffer_load_dword v104, v4, s[16:19], s46 offen
    buffer_load_dword v105, v5, s[16:19], s46 offen
    s_waitcnt vmcnt(58)
    v_perm_b32 v8, v111, v110, s37
    v_accvgpr_write_b32 a137, v8
    v_perm_b32 v9, v111, v110, s38
    v_accvgpr_write_b32 a141, v9
    s_add_u32 s46, s47, 0xc1800
    buffer_load_dword v106, v4, s[16:19], s46 offen
    buffer_load_dword v107, v5, s[16:19], s46 offen
    s_waitcnt vmcnt(58)
    v_perm_b32 v8, v113, v112, s37
    v_accvgpr_write_b32 a138, v8
    v_perm_b32 v9, v113, v112, s38
    v_accvgpr_write_b32 a142, v9
    s_add_u32 s46, s47, 0xc8000
    buffer_load_dword v108, v4, s[16:19], s46 offen
    buffer_load_dword v109, v5, s[16:19], s46 offen
    s_waitcnt vmcnt(58)
    v_perm_b32 v8, v115, v114, s37
    v_accvgpr_write_b32 a139, v8
    v_perm_b32 v9, v115, v114, s38
    v_accvgpr_write_b32 a143, v9
    s_add_u32 s46, s47, 0xc8800
    buffer_load_dword v110, v4, s[16:19], s46 offen
    buffer_load_dword v111, v5, s[16:19], s46 offen
    s_waitcnt vmcnt(58)
    v_perm_b32 v8, v117, v116, s37
    v_accvgpr_write_b32 a144, v8
    v_perm_b32 v9, v117, v116, s38
    v_accvgpr_write_b32 a148, v9
    s_add_u32 s46, s47, 0xc9000
    buffer_load_dword v112, v4, s[16:19], s46 offen
    buffer_load_dword v113, v5, s[16:19], s46 offen
    s_waitcnt vmcnt(58)
    v_perm_b32 v8, v119, v118, s37
    v_accvgpr_write_b32 a145, v8
    v_perm_b32 v9, v119, v118, s38
    v_accvgpr_write_b32 a149, v9
    s_add_u32 s46, s47, 0xc9800
    buffer_load_dword v114, v4, s[16:19], s46 offen
    buffer_load_dword v115, v5, s[16:19], s46 offen
    s_waitcnt vmcnt(58)
    v_perm_b32 v8, v121, v120, s37
    v_accvgpr_write_b32 a146, v8
    v_perm_b32 v9, v121, v120, s38
    v_accvgpr_write_b32 a150, v9
    s_add_u32 s46, s47, 0xd0000
    buffer_load_dword v116, v4, s[16:19], s46 offen
    buffer_load_dword v117, v5, s[16:19], s46 offen
    s_waitcnt vmcnt(58)
    v_perm_b32 v8, v123, v122, s37
    v_accvgpr_write_b32 a147, v8
    v_perm_b32 v9, v123, v122, s38
    v_accvgpr_write_b32 a151, v9
    s_add_u32 s46, s47, 0xd0800
    buffer_load_dword v118, v4, s[16:19], s46 offen
    buffer_load_dword v119, v5, s[16:19], s46 offen
    s_waitcnt vmcnt(58)
    v_perm_b32 v8, v125, v124, s37
    v_accvgpr_write_b32 a152, v8
    v_perm_b32 v9, v125, v124, s38
    v_accvgpr_write_b32 a156, v9
    s_add_u32 s46, s47, 0xd1000
    buffer_load_dword v120, v4, s[16:19], s46 offen
    buffer_load_dword v121, v5, s[16:19], s46 offen
    s_waitcnt vmcnt(58)
    v_perm_b32 v8, v127, v126, s37
    v_accvgpr_write_b32 a153, v8
    v_perm_b32 v9, v127, v126, s38
    v_accvgpr_write_b32 a157, v9
    s_add_u32 s46, s47, 0xd1800
    buffer_load_dword v122, v4, s[16:19], s46 offen
    buffer_load_dword v123, v5, s[16:19], s46 offen
    s_waitcnt vmcnt(58)
    v_perm_b32 v8, v129, v128, s37
    v_accvgpr_write_b32 a154, v8
    v_perm_b32 v9, v129, v128, s38
    v_accvgpr_write_b32 a158, v9
    s_add_u32 s46, s47, 0xd8000
    buffer_load_dword v124, v4, s[16:19], s46 offen
    buffer_load_dword v125, v5, s[16:19], s46 offen
    s_waitcnt vmcnt(58)
    v_perm_b32 v8, v131, v130, s37
    v_accvgpr_write_b32 a155, v8
    v_perm_b32 v9, v131, v130, s38
    v_accvgpr_write_b32 a159, v9
    s_add_u32 s46, s47, 0xd8800
    buffer_load_dword v126, v4, s[16:19], s46 offen
    buffer_load_dword v127, v5, s[16:19], s46 offen
    s_waitcnt vmcnt(58)
    v_perm_b32 v8, v133, v132, s37
    v_accvgpr_write_b32 a160, v8
    v_perm_b32 v9, v133, v132, s38
    v_accvgpr_write_b32 a164, v9
    s_add_u32 s46, s47, 0xd9000
    buffer_load_dword v128, v4, s[16:19], s46 offen
    buffer_load_dword v129, v5, s[16:19], s46 offen
    s_waitcnt vmcnt(58)
    v_perm_b32 v8, v135, v134, s37
    v_accvgpr_write_b32 a161, v8
    v_perm_b32 v9, v135, v134, s38
    v_accvgpr_write_b32 a165, v9
    s_add_u32 s46, s47, 0xd9800
    buffer_load_dword v130, v4, s[16:19], s46 offen
    buffer_load_dword v131, v5, s[16:19], s46 offen
    s_waitcnt vmcnt(58)
    v_perm_b32 v8, v137, v136, s37
    v_accvgpr_write_b32 a162, v8
    v_perm_b32 v9, v137, v136, s38
    v_accvgpr_write_b32 a166, v9
    s_add_u32 s46, s47, 0xe0000
    buffer_load_dword v132, v4, s[16:19], s46 offen
    buffer_load_dword v133, v5, s[16:19], s46 offen
    s_waitcnt vmcnt(58)
    v_perm_b32 v8, v139, v138, s37
    v_accvgpr_write_b32 a163, v8
    v_perm_b32 v9, v139, v138, s38
    v_accvgpr_write_b32 a167, v9
    s_add_u32 s46, s47, 0xe0800
    buffer_load_dword v134, v4, s[16:19], s46 offen
    buffer_load_dword v135, v5, s[16:19], s46 offen
    s_waitcnt vmcnt(58)
    v_perm_b32 v8, v141, v140, s37
    v_accvgpr_write_b32 a168, v8
    v_perm_b32 v9, v141, v140, s38
    v_accvgpr_write_b32 a172, v9
    s_add_u32 s46, s47, 0xe1000
    buffer_load_dword v136, v4, s[16:19], s46 offen
    buffer_load_dword v137, v5, s[16:19], s46 offen
    s_waitcnt vmcnt(58)
    v_perm_b32 v8, v143, v142, s37
    v_accvgpr_write_b32 a169, v8
    v_perm_b32 v9, v143, v142, s38
    v_accvgpr_write_b32 a173, v9
    s_add_u32 s46, s47, 0xe1800
    buffer_load_dword v138, v4, s[16:19], s46 offen
    buffer_load_dword v139, v5, s[16:19], s46 offen
    s_waitcnt vmcnt(58)
    v_perm_b32 v8, v145, v144, s37
    v_accvgpr_write_b32 a170, v8
    v_perm_b32 v9, v145, v144, s38
    v_accvgpr_write_b32 a174, v9
    s_add_u32 s46, s47, 0xe8000
    buffer_load_dword v140, v4, s[16:19], s46 offen
    buffer_load_dword v141, v5, s[16:19], s46 offen
    s_waitcnt vmcnt(58)
    v_perm_b32 v8, v147, v146, s37
    v_accvgpr_write_b32 a171, v8
    v_perm_b32 v9, v147, v146, s38
    v_accvgpr_write_b32 a175, v9
    s_add_u32 s46, s47, 0xe8800
    buffer_load_dword v142, v4, s[16:19], s46 offen
    buffer_load_dword v143, v5, s[16:19], s46 offen
    s_waitcnt vmcnt(58)
    v_perm_b32 v8, v149, v148, s37
    v_accvgpr_write_b32 a176, v8
    v_perm_b32 v9, v149, v148, s38
    v_accvgpr_write_b32 a180, v9
    s_add_u32 s46, s47, 0xe9000
    buffer_load_dword v144, v4, s[16:19], s46 offen
    buffer_load_dword v145, v5, s[16:19], s46 offen
    s_waitcnt vmcnt(58)
    v_perm_b32 v8, v151, v150, s37
    v_accvgpr_write_b32 a177, v8
    v_perm_b32 v9, v151, v150, s38
    v_accvgpr_write_b32 a181, v9
    s_add_u32 s46, s47, 0xe9800
    buffer_load_dword v146, v4, s[16:19], s46 offen
    buffer_load_dword v147, v5, s[16:19], s46 offen
    s_waitcnt vmcnt(58)
    v_perm_b32 v8, v153, v152, s37
    v_accvgpr_write_b32 a178, v8
    v_perm_b32 v9, v153, v152, s38
    v_accvgpr_write_b32 a182, v9
    s_add_u32 s46, s47, 0xf0000
    buffer_load_dword v148, v4, s[16:19], s46 offen
    buffer_load_dword v149, v5, s[16:19], s46 offen
    s_waitcnt vmcnt(58)
    v_perm_b32 v8, v155, v154, s37
    v_accvgpr_write_b32 a179, v8
    v_perm_b32 v9, v155, v154, s38
    v_accvgpr_write_b32 a183, v9
    s_add_u32 s46, s47, 0xf0800
    buffer_load_dword v150, v4, s[16:19], s46 offen
    buffer_load_dword v151, v5, s[16:19], s46 offen
    s_waitcnt vmcnt(58)
    v_perm_b32 v8, v157, v156, s37
    v_accvgpr_write_b32 a184, v8
    v_perm_b32 v9, v157, v156, s38
    v_accvgpr_write_b32 a188, v9
    s_add_u32 s46, s47, 0xf1000
    buffer_load_dword v152, v4, s[16:19], s46 offen
    buffer_load_dword v153, v5, s[16:19], s46 offen
    s_waitcnt vmcnt(58)
    v_perm_b32 v8, v159, v158, s37
    v_accvgpr_write_b32 a185, v8
    v_perm_b32 v9, v159, v158, s38
    v_accvgpr_write_b32 a189, v9
    s_add_u32 s46, s47, 0xf1800
    buffer_load_dword v154, v4, s[16:19], s46 offen
    buffer_load_dword v155, v5, s[16:19], s46 offen
    s_waitcnt vmcnt(58)
    v_perm_b32 v8, v161, v160, s37
    v_accvgpr_write_b32 a186, v8
    v_perm_b32 v9, v161, v160, s38
    v_accvgpr_write_b32 a190, v9
    s_add_u32 s46, s47, 0xf8000
    buffer_load_dword v156, v4, s[16:19], s46 offen
    buffer_load_dword v157, v5, s[16:19], s46 offen
    s_waitcnt vmcnt(58)
    v_perm_b32 v8, v163, v162, s37
    v_accvgpr_write_b32 a187, v8
    v_perm_b32 v9, v163, v162, s38
    v_accvgpr_write_b32 a191, v9
    s_add_u32 s46, s47, 0xf8800
    buffer_load_dword v158, v4, s[16:19], s46 offen
    buffer_load_dword v159, v5, s[16:19], s46 offen
    s_waitcnt vmcnt(58)
    v_perm_b32 v8, v101, v100, s37
    v_accvgpr_write_b32 a192, v8
    v_perm_b32 v9, v101, v100, s38
    v_accvgpr_write_b32 a196, v9
    s_add_u32 s46, s47, 0xf9000
    buffer_load_dword v160, v4, s[16:19], s46 offen
    buffer_load_dword v161, v5, s[16:19], s46 offen
    s_waitcnt vmcnt(58)
    v_perm_b32 v8, v103, v102, s37
    v_accvgpr_write_b32 a193, v8
    v_perm_b32 v9, v103, v102, s38
    v_accvgpr_write_b32 a197, v9
    s_add_u32 s46, s47, 0xf9800
    buffer_load_dword v162, v4, s[16:19], s46 offen
    buffer_load_dword v163, v5, s[16:19], s46 offen
    s_waitcnt vmcnt(58)
    v_perm_b32 v8, v105, v104, s37
    v_accvgpr_write_b32 a194, v8
    v_perm_b32 v9, v105, v104, s38
    v_accvgpr_write_b32 a198, v9
    s_waitcnt vmcnt(56)
    v_perm_b32 v8, v107, v106, s37
    v_accvgpr_write_b32 a195, v8
    v_perm_b32 v9, v107, v106, s38
    v_accvgpr_write_b32 a199, v9
    s_waitcnt vmcnt(54)
    v_perm_b32 v8, v109, v108, s37
    v_accvgpr_write_b32 a200, v8
    v_perm_b32 v9, v109, v108, s38
    v_accvgpr_write_b32 a204, v9
    s_waitcnt vmcnt(52)
    v_perm_b32 v8, v111, v110, s37
    v_accvgpr_write_b32 a201, v8
    v_perm_b32 v9, v111, v110, s38
    v_accvgpr_write_b32 a205, v9
    s_waitcnt vmcnt(50)
    v_perm_b32 v8, v113, v112, s37
    v_accvgpr_write_b32 a202, v8
    v_perm_b32 v9, v113, v112, s38
    v_accvgpr_write_b32 a206, v9
    s_waitcnt vmcnt(48)
    v_perm_b32 v8, v115, v114, s37
    v_accvgpr_write_b32 a203, v8
    v_perm_b32 v9, v115, v114, s38
    v_accvgpr_write_b32 a207, v9
    s_waitcnt vmcnt(46)
    v_perm_b32 v8, v117, v116, s37
    v_accvgpr_write_b32 a208, v8
    v_perm_b32 v9, v117, v116, s38
    v_accvgpr_write_b32 a212, v9
    s_waitcnt vmcnt(44)
    v_perm_b32 v8, v119, v118, s37
    v_accvgpr_write_b32 a209, v8
    v_perm_b32 v9, v119, v118, s38
    v_accvgpr_write_b32 a213, v9
    s_waitcnt vmcnt(42)
    v_perm_b32 v8, v121, v120, s37
    v_accvgpr_write_b32 a210, v8
    v_perm_b32 v9, v121, v120, s38
    v_accvgpr_write_b32 a214, v9
    s_waitcnt vmcnt(40)
    v_perm_b32 v8, v123, v122, s37
    v_accvgpr_write_b32 a211, v8
    v_perm_b32 v9, v123, v122, s38
    v_accvgpr_write_b32 a215, v9
    s_waitcnt vmcnt(38)
    v_perm_b32 v8, v125, v124, s37
    v_accvgpr_write_b32 a216, v8
    v_perm_b32 v9, v125, v124, s38
    v_accvgpr_write_b32 a220, v9
    s_waitcnt vmcnt(36)
    v_perm_b32 v8, v127, v126, s37
    v_accvgpr_write_b32 a217, v8
    v_perm_b32 v9, v127, v126, s38
    v_accvgpr_write_b32 a221, v9
    s_waitcnt vmcnt(34)
    v_perm_b32 v8, v129, v128, s37
    v_accvgpr_write_b32 a218, v8
    v_perm_b32 v9, v129, v128, s38
    v_accvgpr_write_b32 a222, v9
    s_waitcnt vmcnt(32)
    v_perm_b32 v8, v131, v130, s37
    v_accvgpr_write_b32 a219, v8
    v_perm_b32 v9, v131, v130, s38
    v_accvgpr_write_b32 a223, v9
    s_waitcnt vmcnt(30)
    v_perm_b32 v8, v133, v132, s37
    v_accvgpr_write_b32 a224, v8
    v_perm_b32 v9, v133, v132, s38
    v_accvgpr_write_b32 a228, v9
    s_waitcnt vmcnt(28)
    v_perm_b32 v8, v135, v134, s37
    v_accvgpr_write_b32 a225, v8
    v_perm_b32 v9, v135, v134, s38
    v_accvgpr_write_b32 a229, v9
    s_waitcnt vmcnt(26)
    v_perm_b32 v8, v137, v136, s37
    v_accvgpr_write_b32 a226, v8
    v_perm_b32 v9, v137, v136, s38
    v_accvgpr_write_b32 a230, v9
    s_waitcnt vmcnt(24)
    v_perm_b32 v8, v139, v138, s37
    v_accvgpr_write_b32 a227, v8
    v_perm_b32 v9, v139, v138, s38
    v_accvgpr_write_b32 a231, v9
    s_waitcnt vmcnt(22)
    v_perm_b32 v8, v141, v140, s37
    v_accvgpr_write_b32 a232, v8
    v_perm_b32 v9, v141, v140, s38
    v_accvgpr_write_b32 a236, v9
    s_waitcnt vmcnt(20)
    v_perm_b32 v8, v143, v142, s37
    v_accvgpr_write_b32 a233, v8
    v_perm_b32 v9, v143, v142, s38
    v_accvgpr_write_b32 a237, v9
    s_waitcnt vmcnt(18)
    v_perm_b32 v8, v145, v144, s37
    v_accvgpr_write_b32 a234, v8
    v_perm_b32 v9, v145, v144, s38
    v_accvgpr_write_b32 a238, v9
    s_waitcnt vmcnt(16)
    v_perm_b32 v8, v147, v146, s37
    v_accvgpr_write_b32 a235, v8
    v_perm_b32 v9, v147, v146, s38
    v_accvgpr_write_b32 a239, v9
    s_waitcnt vmcnt(14)
    v_perm_b32 v8, v149, v148, s37
    v_accvgpr_write_b32 a240, v8
    v_perm_b32 v9, v149, v148, s38
    v_accvgpr_write_b32 a244, v9
    s_waitcnt vmcnt(12)
    v_perm_b32 v8, v151, v150, s37
    v_accvgpr_write_b32 a241, v8
    v_perm_b32 v9, v151, v150, s38
    v_accvgpr_write_b32 a245, v9
    s_waitcnt vmcnt(10)
    v_perm_b32 v8, v153, v152, s37
    v_accvgpr_write_b32 a242, v8
    v_perm_b32 v9, v153, v152, s38
    v_accvgpr_write_b32 a246, v9
    s_waitcnt vmcnt(8)
    v_perm_b32 v8, v155, v154, s37
    v_accvgpr_write_b32 a243, v8
    v_perm_b32 v9, v155, v154, s38
    v_accvgpr_write_b32 a247, v9
    s_waitcnt vmcnt(6)
    v_perm_b32 v8, v157, v156, s37
    v_accvgpr_write_b32 a248, v8
    v_perm_b32 v9, v157, v156, s38
    v_accvgpr_write_b32 a252, v9
    s_waitcnt vmcnt(4)
    v_perm_b32 v8, v159, v158, s37
    v_accvgpr_write_b32 a249, v8
    v_perm_b32 v9, v159, v158, s38
    v_accvgpr_write_b32 a253, v9
    s_waitcnt vmcnt(2)
    v_perm_b32 v8, v161, v160, s37
    v_accvgpr_write_b32 a250, v8
    v_perm_b32 v9, v161, v160, s38
    v_accvgpr_write_b32 a254, v9
    s_waitcnt vmcnt(0)
    v_perm_b32 v8, v163, v162, s37
    v_accvgpr_write_b32 a251, v8
    v_perm_b32 v9, v163, v162, s38
    v_accvgpr_write_b32 a255, v9
    s_lshr_b32 s44, s4, 1
    s_lshl_b32 s67, s64, 1
    s_add_u32 s67, s67, s44
    s_and_b32 s68, s63, 1
    s_and_b32 s71, s4, 1
    s_mov_b32 s70, 0x3e0293ee
    s_mov_b32 s74, 0xffbfffbf
    s_lshl_b32 s44, s68, 4
    v_add_u32 v18, s44, v1
    v_lshlrev_b32 v19, 2, v2
    v_sub_u32 v18, v18, v19
    v_mov_b32 v19, 0xff800000
    v_cmp_gt_i32 vcc, 0, v18
    s_nop 1
    v_cndmask_b32 v4, 0, v19, vcc
    v_cmp_gt_i32 vcc, 1, v18
    s_nop 1
    v_cndmask_b32 v5, 0, v19, vcc
    v_cmp_gt_i32 vcc, 2, v18
    s_nop 1
    v_cndmask_b32 v6, 0, v19, vcc
    v_cmp_gt_i32 vcc, 3, v18
    s_nop 1
    v_cndmask_b32 v7, 0, v19, vcc
    v_cmp_gt_i32 vcc, 16, v18
    s_nop 1
    v_cndmask_b32 v8, 0, v19, vcc
    v_cmp_gt_i32 vcc, 17, v18
    s_nop 1
    v_cndmask_b32 v9, 0, v19, vcc
    v_cmp_gt_i32 vcc, 18, v18
    s_nop 1
    v_cndmask_b32 v10, 0, v19, vcc
    v_cmp_gt_i32 vcc, 19, v18
    s_nop 1
    v_cndmask_b32 v11, 0, v19, vcc
    s_mul_i32 s44, s4, 2304
    v_mul_u32_u24 v12, 576, v2
    v_lshl_add_u32 v12, v1, 2, v12
    v_add_u32 v12, s44, v12
    s_lshl_b32 s45, s71, 7
    v_add_u32 v16, s45, v12
    s_xor_b32 s45, s45, 128
    v_add_u32 v12, s45, v12
    v_lshrrev_b32 v18, 2, v1
    v_and_b32 v19, 1, v1
    v_lshl_add_u32 v18, v18, 1, v19
    v_mul_u32_u24 v13, 288, v18
    v_lshl_add_u32 v13, v2, 4, v13
    v_add_u32 v13, s44, v13
    s_lshl_b32 s44, s4, 11
    s_add_u32 s44, s44, 16384
    v_add_u32 v14, s44, v0
    s_lshl_b32 s46, s4, 2
    s_add_u32 s45, s46, 16384
    v_add_u32 v15, s45, v0
    s_lshl_b32 s45, s64, 6
    s_add_u32 s45, s45, s46
    v_lshlrev_b32 v3, 10, v1
    v_lshl_add_u32 v3, v2, 4, v3
    v_add_u32 v3, s45, v3
    v_lshlrev_b32 v17, 2, v1
    s_lshl_b32 s69, s63, 8
    s_add_u32 s69, s69, 0x2000
    s_lshl_b32 s73, s63, 18
    s_add_u32 s73, s73, 0x4000000
    s_mov_b32 s65, s63
    s_mov_b32 s66, 1
    v_min_u32 v18, 880, v0
    s_mov_b32 s62, 0
P2_pf:
    buffer_load_dwordx4 v[20:23], v18, s[8:11], 0 offen offset:1024 sc1
    s_waitcnt vmcnt(0)
    v_min3_i32 v20, v20, v21, v22
    v_min_i32 v20, v20, v23
    v_cmp_gt_i32 vcc, 1, v20
    s_cbranch_vccz P2_pf_ok
    s_sleep 8
    s_add_u32 s62, s62, 1
    s_cmp_lt_u32 s62, 3000000
    s_cbranch_scc1 P2_pf
    s_branch L_fail
P2_pf_ok:
    s_mul_i32 s44, s65, 0xac00
    s_add_u32 s44, s44, 0x5000000
    s_mul_i32 s45, s4, 11
    s_add_u32 s46, s45, 0
    s_min_u32 s46, s46, 42
    s_lshl_b32 s46, s46, 10
    s_add_u32 s46, s46, s44
    buffer_load_dwordx4 v[112:115], v0, s[8:11], s46 offen sc1
    s_add_u32 s46, s45, 1
    s_min_u32 s46, s46, 42
    s_lshl_b32 s46, s46, 10
    s_add_u32 s46, s46, s44
    buffer_load_dwordx4 v[116:119], v0, s[8:11], s46 offen sc1
    s_add_u32 s46, s45, 2
    s_min_u32 s46, s46, 42
    s_lshl_b32 s46, s46, 10
    s_add_u32 s46, s46, s44
    buffer_load_dwordx4 v[120:123], v0, s[8:11], s46 offen sc1
    s_add_u32 s46, s45, 3
    s_min_u32 s46, s46, 42
    s_lshl_b32 s46, s46, 10
    s_add_u32 s46, s46, s44
    buffer_load_dwordx4 v[124:127], v0, s[8:11], s46 offen sc1
    s_add_u32 s46, s45, 4
    s_min_u32 s46, s46, 42
    s_lshl_b32 s46, s46, 10
    s_add_u32 s46, s46, s44
    buffer_load_dwordx4 v[128:131], v0, s[8:11], s46 offen sc1
    s_add_u32 s46, s45, 5
    s_min_u32 s46, s46, 42
    s_lshl_b32 s46, s46, 10
    s_add_u32 s46, s46, s44
    buffer_load_dwordx4 v[132:135], v0, s[8:11], s46 offen sc1
    s_add_u32 s46, s45, 6
    s_min_u32 s46, s46, 42
    s_lshl_b32 s46, s46, 10
    s_add_u32 s46, s46, s44
    buffer_load_dwordx4 v[136:139], v0, s[8:11], s46 offen sc1
    s_add_u32 s46, s45, 7
    s_min_u32 s46, s46, 42
    s_lshl_b32 s46, s46, 10
    s_add_u32 s46, s46, s44
    buffer_load_dwordx4 v[140:143], v0, s[8:11], s46 offen sc1
    s_add_u32 s46, s45, 8
    s_min_u32 s46, s46, 42
    s_lshl_b32 s46, s46, 10
    s_add_u32 s46, s46, s44
    buffer_load_dwordx4 v[144:147], v0, s[8:11], s46 offen sc1
    s_add_u32 s46, s45, 9
    s_min_u32 s46, s46, 42
    s_lshl_b32 s46, s46, 10
    s_add_u32 s46, s46, s44
    buffer_load_dwordx4 v[148:151], v0, s[8:11], s46 offen sc1
    s_add_u32 s46, s45, 10
    s_min_u32 s46, s46, 42
    s_lshl_b32 s46, s46, 10
    s_add_u32 s46, s46, s44
    buffer_load_dwordx4 v[152:155], v0, s[8:11], s46 offen sc1
    s_waitcnt vmcnt(0)
P2_loop:
    s_lshl_b32 s44, s65, 6
    s_add_u32 s44, s44, 0x10000
    buffer_load_dword v18, v17, s[8:11], s44 offen sc1
    v_mfma_f32_16x16x32_bf16 v[24:27], v[168:171], v[112:115], 0
    v_mfma_f32_16x16x32_bf16 v[28:31], v[172:175], v[112:115], 0
    s_lshr_b32 s44, s65, 1
    s_lshl_b32 s44, s44, 5
    s_add_u32 s44, s44, s67
    s_lshl_b32 s72, s44, 13
    s_lshl_b32 s44, s68, 12
    s_add_u32 s44, s44, s72
    s_add_u32 s44, s44, 0x1000000
    buffer_load_dwordx4 v[32:35], v0, s[8:11], s44 offen offset:0 sc1
    v_mfma_f32_16x16x32_bf16 v[24:27], v[176:179], v[116:119], v[24:27]
    v_mfma_f32_16x16x32_bf16 v[28:31], v[180:183], v[116:119], v[28:31]
    buffer_load_dwordx4 v[36:39], v0, s[8:11], s44 offen offset:1024 sc1
    v_mfma_f32_16x16x32_bf16 v[24:27], v[184:187], v[120:123], v[24:27]
    v_mfma_f32_16x16x32_bf16 v[28:31], v[188:191], v[120:123], v[28:31]
    buffer_load_dwordx4 v[40:43], v0, s[8:11], s44 offen offset:2048 sc1
    v_mfma_f32_16x16x32_bf16 v[24:27], v[192:195], v[124:127], v[24:27]
    v_mfma_f32_16x16x32_bf16 v[28:31], v[196:199], v[124:127], v[28:31]
    buffer_load_dwordx4 v[44:47], v0, s[8:11], s44 offen offset:3072 sc1
    v_mfma_f32_16x16x32_bf16 v[24:27], v[200:203], v[128:131], v[24:27]
    v_mfma_f32_16x16x32_bf16 v[28:31], v[204:207], v[128:131], v[28:31]
    s_add_u32 s44, s72, 0x2000000
    s_add_u32 s45, s44, 4096
    buffer_load_dwordx4 v[48:51], v0, s[8:11], s44 offen offset:0 sc1
    v_mfma_f32_16x16x32_bf16 v[24:27], v[208:211], v[132:135], v[24:27]
    v_mfma_f32_16x16x32_bf16 v[28:31], v[212:215], v[132:135], v[28:31]
    buffer_load_dwordx4 v[52:55], v0, s[8:11], s44 offen offset:1024 sc1
    v_mfma_f32_16x16x32_bf16 v[24:27], v[216:219], v[136:139], v[24:27]
    v_mfma_f32_16x16x32_bf16 v[28:31], v[220:223], v[136:139], v[28:31]
    buffer_load_dwordx4 v[56:59], v0, s[8:11], s44 offen offset:2048 sc1
    v_mfma_f32_16x16x32_bf16 v[24:27], v[224:227], v[140:143], v[24:27]
    v_mfma_f32_16x16x32_bf16 v[28:31], v[228:231], v[140:143], v[28:31]
    buffer_load_dwordx4 v[60:63], v0, s[8:11], s44 offen offset:3072 sc1
    v_mfma_f32_16x16x32_bf16 v[24:27], v[232:235], v[144:147], v[24:27]
    v_mfma_f32_16x16x32_bf16 v[28:31], v[236:239], v[144:147], v[28:31]
    buffer_load_dwordx4 v[64:67], v0, s[8:11], s45 offen offset:0 sc1
    v_mfma_f32_16x16x32_bf16 v[24:27], v[240:243], v[148:151], v[24:27]
    v_mfma_f32_16x16x32_bf16 v[28:31], v[244:247], v[148:151], v[28:31]
    buffer_load_dwordx4 v[68:71], v0, s[8:11], s45 offen offset:1024 sc1
    v_mfma_f32_16x16x32_bf16 v[24:27], v[248:251], v[152:155], v[24:27]
    v_mfma_f32_16x16x32_bf16 v[28:31], v[252:255], v[152:155], v[28:31]
    buffer_load_dwordx4 v[72:75], v0, s[8:11], s45 offen offset:2048 sc1
    buffer_load_dwordx4 v[76:79], v0, s[8:11], s45 offen offset:3072 sc1
    s_lshl_b32 s44, s71, 12
    s_add_u32 s44, s44, s72
    s_add_u32 s44, s44, 0x3000000
    buffer_load_dwordx4 v[80:83], v0, s[8:11], s44 offen offset:0 sc1
    buffer_load_dwordx4 v[84:87], v0, s[8:11], s44 offen offset:1024 sc1
    buffer_load_dwordx4 v[88:91], v0, s[8:11], s44 offen offset:2048 sc1
    buffer_load_dwordx4 v[92:95], v0, s[8:11], s44 offen offset:3072 sc1
    s_lshr_b32 s75, s72, 1
    s_add_u32 s75, s75, 0x800000
    s_lshl_b32 s44, s71, 11
    s_add_u32 s75, s75, s44
    s_xor_b32 s76, s75, 2048
    buffer_load_dwordx4 v[96:99], v0, s[8:11], s75 offen offset:0 sc1
    buffer_load_dwordx4 v[100:103], v0, s[8:11], s75 offen offset:1024 sc1
    buffer_load_dwordx4 v[104:107], v0, s[8:11], s76 offen offset:0 sc1
    buffer_load_dwordx4 v[108:111], v0, s[8:11], s76 offen offset:1024 sc1
    ds_write_b128 v14, v[24:27] offset:0
    ds_write_b128 v14, v[28:31] offset:1024
    s_waitcnt lgkmcnt(0)
    s_barrier
    ds_read_b32 v24, v15 offset:0
    ds_read_b32 v25, v15 offset:1024
    ds_read_b32 v26, v15 offset:2048
    ds_read_b32 v27, v15 offset:3072
    ds_read_b32 v28, v15 offset:4096
    ds_read_b32 v29, v15 offset:5120
    ds_read_b32 v30, v15 offset:6144
    ds_read_b32 v31, v15 offset:7168
    s_waitcnt lgkmcnt(4)
    v_pk_add_f32 v[24:25], v[24:25], v[26:27]
    s_waitcnt lgkmcnt(0)
    v_pk_add_f32 v[28:29], v[28:29], v[30:31]
    v_pk_add_f32 v[24:25], v[24:25], v[28:29]
    v_cvt_pk_bf16_f32 v30, v24, v25
    v_lshlrev_b32 v22, 16, v30
    v_and_b32 v23, 0xffff0000, v30
    s_waitcnt vmcnt(8)
    v_sub_f32 v19, 1.0, v18
    v_cvt_pk_bf16_f32 v19, v19, v19
    v_and_b32 v19, 0xffff0000, v19
    v_mfma_f32_16x16x32_bf16 v[156:159], v[48:51], v[32:35], v[4:7]
    v_mfma_f32_16x16x32_bf16 v[160:163], v[64:67], v[32:35], v[8:11]
    v_mfma_f32_16x16x32_bf16 v[156:159], v[52:55], v[36:39], v[156:159]
    v_mfma_f32_16x16x32_bf16 v[160:163], v[68:71], v[36:39], v[160:163]
    v_mfma_f32_16x16x32_bf16 v[156:159], v[56:59], v[40:43], v[156:159]
    v_mfma_f32_16x16x32_bf16 v[160:163], v[72:75], v[40:43], v[160:163]
    v_mfma_f32_16x16x32_bf16 v[156:159], v[60:63], v[44:47], v[156:159]
    v_mfma_f32_16x16x32_bf16 v[160:163], v[76:79], v[44:47], v[160:163]
    v_mul_f32 v22, v19, v22
    v_mul_f32 v23, v19, v23
    v_cvt_pk_bf16_f32 v30, v22, v23
    v_lshlrev_b32 v22, 16, v30
    v_and_b32 v23, 0xffff0000, v30
    v_mov_b32 v29, 0
    v_mov_b32 v30, 0
    v_max3_f32 v19, v156, v157, v158
    v_max3_f32 v21, v160, v161, v162
    v_max3_f32 v19, v19, v159, v163
    v_max_f32 v19, v19, v21
    s_waitcnt vmcnt(0)
    s_add_u32 s77, s65, 12
    s_min_u32 s77, s77, 127
    s_mul_i32 s44, s77, 0xac00
    s_add_u32 s44, s44, 0x5000000
    s_mul_i32 s45, s4, 11
    s_add_u32 s46, s45, 0
    s_min_u32 s46, s46, 42
    s_lshl_b32 s46, s46, 10
    s_add_u32 s46, s46, s44
    buffer_load_dwordx4 v[112:115], v0, s[8:11], s46 offen sc1
    s_add_u32 s46, s45, 1
    s_min_u32 s46, s46, 42
    s_lshl_b32 s46, s46, 10
    s_add_u32 s46, s46, s44
    buffer_load_dwordx4 v[116:119], v0, s[8:11], s46 offen sc1
    s_add_u32 s46, s45, 2
    s_min_u32 s46, s46, 42
    s_lshl_b32 s46, s46, 10
    s_add_u32 s46, s46, s44
    buffer_load_dwordx4 v[120:123], v0, s[8:11], s46 offen sc1
    s_add_u32 s46, s45, 3
    s_min_u32 s46, s46, 42
    s_lshl_b32 s46, s46, 10
    s_add_u32 s46, s46, s44
    buffer_load_dwordx4 v[124:127], v0, s[8:11], s46 offen sc1
    s_add_u32 s46, s45, 4
    s_min_u32 s46, s46, 42
    s_lshl_b32 s46, s46, 10
    s_add_u32 s46, s46, s44
    buffer_load_dwordx4 v[128:131], v0, s[8:11], s46 offen sc1
    s_add_u32 s46, s45, 5
    s_min_u32 s46, s46, 42
    s_lshl_b32 s46, s46, 10
    s_add_u32 s46, s46, s44
    buffer_load_dwordx4 v[132:135], v0, s[8:11], s46 offen sc1
    s_add_u32 s46, s45, 6
    s_min_u32 s46, s46, 42
    s_lshl_b32 s46, s46, 10
    s_add_u32 s46, s46, s44
    buffer_load_dwordx4 v[136:139], v0, s[8:11], s46 offen sc1
    s_add_u32 s46, s45, 7
    s_min_u32 s46, s46, 42
    s_lshl_b32 s46, s46, 10
    s_add_u32 s46, s46, s44
    buffer_load_dwordx4 v[140:143], v0, s[8:11], s46 offen sc1
    s_add_u32 s46, s45, 8
    s_min_u32 s46, s46, 42
    s_lshl_b32 s46, s46, 10
    s_add_u32 s46, s46, s44
    buffer_load_dwordx4 v[144:147], v0, s[8:11], s46 offen sc1
    s_add_u32 s46, s45, 9
    s_min_u32 s46, s46, 42
    s_lshl_b32 s46, s46, 10
    s_add_u32 s46, s46, s44
    buffer_load_dwordx4 v[148:151], v0, s[8:11], s46 offen sc1
    s_add_u32 s46, s45, 10
    s_min_u32 s46, s46, 42
    s_lshl_b32 s46, s46, 10
    s_add_u32 s46, s46, s44
    buffer_load_dwordx4 v[152:155], v0, s[8:11], s46 offen sc1
    s_mov_b32 s62, 0
    s_branch P2_k1
P2_kc:
    s_waitcnt vmcnt(0)
P2_k1:
    v_max3_u32 v20, v96, v97, v98
    v_max3_u32 v20, v20, v99, v100
    v_max3_u32 v20, v20, v101, v102
    v_max3_u32 v20, v20, v103, v104
    v_max3_u32 v20, v20, v105, v106
    v_max3_u32 v20, v20, v107, v108
    v_max3_u32 v20, v20, v109, v110
    v_max_u32 v20, v20, v111
    v_cmp_eq_u32 vcc, s74, v20
    s_cbranch_vccz P2_kok
    s_sleep 2
    buffer_load_dwordx4 v[96:99], v0, s[8:11], s75 offen offset:0 sc1
    buffer_load_dwordx4 v[100:103], v0, s[8:11], s75 offen offset:1024 sc1
    buffer_load_dwordx4 v[104:107], v0, s[8:11], s76 offen offset:0 sc1
    buffer_load_dwordx4 v[108:111], v0, s[8:11], s76 offen offset:1024 sc1
    s_add_u32 s62, s62, 1
    s_cmp_lt_u32 s62, 3000000
    s_cbranch_scc1 P2_kc
    s_branch L_fail
P2_kok:
    ds_write_b32 v16, v96 offset:0
    ds_write_b32 v16, v97 offset:288
    ds_write_b32 v16, v100 offset:64
    ds_write_b32 v16, v101 offset:352
    ds_write_b32 v12, v104 offset:0
    ds_write_b32 v12, v105 offset:288
    ds_write_b32 v12, v108 offset:64
    ds_write_b32 v12, v109 offset:352
    ds_read_b128 v[48:51], v13 offset:0
    ds_read_b128 v[52:55], v13 offset:64
    ds_read_b128 v[56:59], v13 offset:128
    ds_read_b128 v[60:63], v13 offset:192
    s_waitcnt lgkmcnt(3)
    v_mfma_f32_16x16x32_bf16 v[164:167], v[48:51], v[32:35], 0
    s_waitcnt lgkmcnt(2)
    v_mfma_f32_16x16x32_bf16 v[164:167], v[52:55], v[36:39], v[164:167]
    s_waitcnt lgkmcnt(1)
    v_mfma_f32_16x16x32_bf16 v[164:167], v[56:59], v[40:43], v[164:167]
    s_waitcnt lgkmcnt(0)
    v_mfma_f32_16x16x32_bf16 v[164:167], v[60:63], v[44:47], v[164:167]
    s_nop 7
    v_max3_f32 v25, v19, v164, v165
    v_max3_f32 v26, v19, v164, v165
    s_nop 1
    v_permlane32_swap_b32 v25, v26
    v_max_f32 v24, v25, v26
    v_max_f32 v27, v25, v26
    s_nop 1
    v_permlane16_swap_b32 v24, v27
    v_max_f32 v24, v24, v27
    v_pk_add_f32 v[156:157], v[156:157], v[24:25] op_sel_hi:[1,0] neg_lo:[0,1] neg_hi:[0,1]
    v_pk_add_f32 v[158:159], v[158:159], v[24:25] op_sel_hi:[1,0] neg_lo:[0,1] neg_hi:[0,1]
    v_pk_add_f32 v[160:161], v[160:161], v[24:25] op_sel_hi:[1,0] neg_lo:[0,1] neg_hi:[0,1]
    v_pk_add_f32 v[162:163], v[162:163], v[24:25] op_sel_hi:[1,0] neg_lo:[0,1] neg_hi:[0,1]
    v_pk_add_f32 v[164:165], v[164:165], v[24:25] op_sel_hi:[1,0] neg_lo:[0,1] neg_hi:[0,1]
    v_pk_mul_f32 v[156:157], v[156:157], s[70:71] op_sel_hi:[1,0]
    v_pk_mul_f32 v[158:159], v[158:159], s[70:71] op_sel_hi:[1,0]
    v_pk_mul_f32 v[160:161], v[160:161], s[70:71] op_sel_hi:[1,0]
    v_pk_mul_f32 v[162:163], v[162:163], s[70:71] op_sel_hi:[1,0]
    v_pk_mul_f32 v[164:165], v[164:165], s[70:71] op_sel_hi:[1,0]
    v_exp_f32 v156, v156
    v_exp_f32 v157, v157
    v_exp_f32 v158, v158
    v_exp_f32 v159, v159
    v_exp_f32 v160, v160
    v_exp_f32 v161, v161
    v_exp_f32 v162, v162
    v_exp_f32 v163, v163
    v_exp_f32 v164, v164
    v_exp_f32 v165, v165
    v_pk_add_f32 v[24:25], v[156:157], v[158:159]
    v_pk_add_f32 v[26:27], v[160:161], v[162:163]
    v_pk_add_f32 v[24:25], v[24:25], v[164:165]
    v_pk_add_f32 v[24:25], v[24:25], v[26:27]
    v_add_f32 v26, v24, v25
    v_add_f32 v27, v24, v25
    s_nop 1
    v_permlane32_swap_b32 v26, v27
    v_add_f32 v24, v26, v27
    v_add_f32 v25, v26, v27
    s_nop 1
    v_permlane16_swap_b32 v24, v25
    v_add_f32 v24, v24, v25
    v_rcp_f32 v24, v24
    s_nop 0
    v_mul_f32 v156, v156, v24
    v_mul_f32 v157, v157, v24
    v_mul_f32 v158, v158, v24
    v_mul_f32 v159, v159, v24
    v_mul_f32 v160, v160, v24
    v_mul_f32 v161, v161, v24
    v_mul_f32 v162, v162, v24
    v_mul_f32 v163, v163, v24
    v_mul_f32 v164, v164, v24
    v_mul_f32 v165, v165, v24
    v_cvt_pk_bf16_f32 v32, v156, v157
    v_cvt_pk_bf16_f32 v33, v158, v159
    v_cvt_pk_bf16_f32 v34, v160, v161
    v_cvt_pk_bf16_f32 v35, v162, v163
    v_cvt_pk_bf16_f32 v28, v164, v165
    v_cvt_pk_bf16_f32 v31, v164, v165
    v_mfma_f32_16x16x32_bf16 v[64:67], v[80:83], v[32:35], 0
    v_mfma_f32_16x16x32_bf16 v[68:71], v[84:87], v[32:35], 0
    v_mfma_f32_16x16x32_bf16 v[72:75], v[88:91], v[32:35], 0
    v_mfma_f32_16x16x32_bf16 v[76:79], v[92:95], v[32:35], 0
    v_mfma_f32_16x16x16_bf16 v[64:67], v[98:99], v[28:29], v[64:67]
    v_mfma_f32_16x16x16_bf16 v[68:71], v[98:99], v[30:31], v[68:71]
    v_mfma_f32_16x16x16_bf16 v[72:75], v[102:103], v[28:29], v[72:75]
    v_mfma_f32_16x16x16_bf16 v[76:79], v[102:103], v[30:31], v[76:79]
    s_lshl_b32 s44, s67, 12
    s_lshl_b32 s45, s71, 11
    s_add_u32 s44, s44, s45
    s_add_u32 s44, s44, s73
    s_lshl_b32 s45, s64, 4
    s_lshl_b32 s46, s4, 2
    s_add_u32 s45, s45, s46
    s_add_u32 s45, s45, s69
    v_mov_b32 v20, s66
    v_cvt_pk_bf16_f32 v40, v64, v68
    v_cvt_pk_bf16_f32 v41, v65, v69
    v_cvt_pk_bf16_f32 v42, v66, v70
    v_cvt_pk_bf16_f32 v43, v67, v71
    v_cvt_pk_bf16_f32 v44, v72, v76
    v_cvt_pk_bf16_f32 v45, v73, v77
    v_cvt_pk_bf16_f32 v46, v74, v78
    v_cvt_pk_bf16_f32 v47, v75, v79
    s_cmp_eq_u32 s7, 1
    s_cbranch_scc1 P2_sof
    buffer_store_dwordx4 v[40:43], v0, s[8:11], s44 offen offset:0 sc1
    buffer_store_dwordx4 v[44:47], v0, s[8:11], s44 offen offset:1024 sc1
    s_branch P2_soe
P2_sof:
    buffer_store_dwordx4 v[40:43], v0, s[8:11], s44 offen offset:0
    buffer_store_dwordx4 v[44:47], v0, s[8:11], s44 offen offset:1024
P2_soe:
    s_waitcnt vmcnt(0)
    s_cbranch_scc1 P2_sff
    buffer_store_dword v20, off, s[8:11], s45 sc1
    s_branch P2_sfe
P2_sff:
    buffer_store_dword v20, off, s[8:11], s45
P2_sfe:
    s_lshl_b32 s44, s4, 6
    s_add_u32 s44, s44, s69
    s_mov_b32 s62, 0
P2_gf:
    buffer_load_dword v20, v17, s[8:11], s44 offen sc1
    s_waitcnt vmcnt(0)
    v_cmp_gt_i32 vcc, s66, v20
    s_cbranch_vccz P2_gf_ok
    s_add_u32 s62, s62, 1
    s_cmp_lt_u32 s62, 3000000
    s_cbranch_scc1 P2_gf
    s_branch L_fail
P2_gf_ok:
    s_lshl_b32 s45, s4, 15
    s_add_u32 s44, s73, s45
    buffer_load_dwordx4 v[32:35], v0, s[8:11], s44 offen offset:0 sc1
    buffer_load_dwordx4 v[36:39], v0, s[8:11], s44 offen offset:1024 sc1
    buffer_load_dwordx4 v[40:43], v0, s[8:11], s44 offen offset:2048 sc1
    buffer_load_dwordx4 v[44:47], v0, s[8:11], s44 offen offset:3072 sc1
    s_add_u32 s44, s44, 4096
    buffer_load_dwordx4 v[48:51], v0, s[8:11], s44 offen offset:0 sc1
    buffer_load_dwordx4 v[52:55], v0, s[8:11], s44 offen offset:1024 sc1
    buffer_load_dwordx4 v[56:59], v0, s[8:11], s44 offen offset:2048 sc1
    buffer_load_dwordx4 v[60:63], v0, s[8:11], s44 offen offset:3072 sc1
    s_add_u32 s44, s44, 4096
    buffer_load_dwordx4 v[64:67], v0, s[8:11], s44 offen offset:0 sc1
    buffer_load_dwordx4 v[68:71], v0, s[8:11], s44 offen offset:1024 sc1
    buffer_load_dwordx4 v[72:75], v0, s[8:11], s44 offen offset:2048 sc1
    buffer_load_dwordx4 v[76:79], v0, s[8:11], s44 offen offset:3072 sc1
    s_add_u32 s44, s44, 4096
    buffer_load_dwordx4 v[80:83], v0, s[8:11], s44 offen offset:0 sc1
    buffer_load_dwordx4 v[84:87], v0, s[8:11], s44 offen offset:1024 sc1
    buffer_load_dwordx4 v[88:91], v0, s[8:11], s44 offen offset:2048 sc1
    buffer_load_dwordx4 v[92:95], v0, s[8:11], s44 offen offset:3072 sc1
    s_add_u32 s44, s44, 4096
    buffer_load_dwordx4 v[96:99], v0, s[8:11], s44 offen offset:0 sc1
    buffer_load_dwordx4 v[100:103], v0, s[8:11], s44 offen offset:1024 sc1
    buffer_load_dwordx4 v[104:107], v0, s[8:11], s44 offen offset:2048 sc1
    buffer_load_dwordx4 v[108:111], v0, s[8:11], s44 offen offset:3072 sc1
    s_waitcnt vmcnt(19)
    v_mfma_f32_16x16x32_bf16 v[24:27], a[0:3], v[32:35], 0
    v_mfma_f32_16x16x32_bf16 v[28:31], a[4:7], v[32:35], 0
    s_add_u32 s44, s44, 4096
    buffer_load_dwordx4 v[32:35], v0, s[8:11], s44 offen offset:0 sc1
    s_waitcnt vmcnt(19)
    v_mfma_f32_16x16x32_bf16 v[24:27], a[8:11], v[36:39], v[24:27]
    v_mfma_f32_16x16x32_bf16 v[28:31], a[12:15], v[36:39], v[28:31]
    buffer_load_dwordx4 v[36:39], v0, s[8:11], s44 offen offset:1024 sc1
    s_waitcnt vmcnt(19)
    v_mfma_f32_16x16x32_bf16 v[24:27], a[16:19], v[40:43], v[24:27]
    v_mfma_f32_16x16x32_bf16 v[28:31], a[20:23], v[40:43], v[28:31]
    buffer_load_dwordx4 v[40:43], v0, s[8:11], s44 offen offset:2048 sc1
    s_waitcnt vmcnt(19)
    v_mfma_f32_16x16x32_bf16 v[24:27], a[24:27], v[44:47], v[24:27]
    v_mfma_f32_16x16x32_bf16 v[28:31], a[28:31], v[44:47], v[28:31]
    buffer_load_dwordx4 v[44:47], v0, s[8:11], s44 offen offset:3072 sc1
    s_waitcnt vmcnt(19)
    v_mfma_f32_16x16x32_bf16 v[24:27], a[32:35], v[48:51], v[24:27]
    v_mfma_f32_16x16x32_bf16 v[28:31], a[36:39], v[48:51], v[28:31]
    s_add_u32 s44, s44, 4096
    buffer_load_dwordx4 v[48:51], v0, s[8:11], s44 offen offset:0 sc1
    s_waitcnt vmcnt(19)
    v_mfma_f32_16x16x32_bf16 v[24:27], a[40:43], v[52:55], v[24:27]
    v_mfma_f32_16x16x32_bf16 v[28:31], a[44:47], v[52:55], v[28:31]
    buffer_load_dwordx4 v[52:55], v0, s[8:11], s44 offen offset:1024 sc1
    s_waitcnt vmcnt(19)
    v_mfma_f32_16x16x32_bf16 v[24:27], a[48:51], v[56:59], v[24:27]
    v_mfma_f32_16x16x32_bf16 v[28:31], a[52:55], v[56:59], v[28:31]
    buffer_load_dwordx4 v[56:59], v0, s[8:11], s44 offen offset:2048 sc1
    s_waitcnt vmcnt(19)
    v_mfma_f32_16x16x32_bf16 v[24:27], a[56:59], v[60:63], v[24:27]
    v_mfma_f32_16x16x32_bf16 v[28:31], a[60:63], v[60:63], v[28:31]
    buffer_load_dwordx4 v[60:63], v0, s[8:11], s44 offen offset:3072 sc1
    s_waitcnt vmcnt(19)
    v_mfma_f32_16x16x32_bf16 v[24:27], a[64:67], v[64:67], v[24:27]
    v_mfma_f32_16x16x32_bf16 v[28:31], a[68:71], v[64:67], v[28:31]
    s_add_u32 s44, s44, 4096
    buffer_load_dwordx4 v[64:67], v0, s[8:11], s44 offen offset:0 sc1
    s_waitcnt vmcnt(19)
    v_mfma_f32_16x16x32_bf16 v[24:27], a[72:75], v[68:71], v[24:27]
    v_mfma_f32_16x16x32_bf16 v[28:31], a[76:79], v[68:71], v[28:31]
    buffer_load_dwordx4 v[68:71], v0, s[8:11], s44 offen offset:1024 sc1
    s_waitcnt vmcnt(19)
    v_mfma_f32_16x16x32_bf16 v[24:27], a[80:83], v[72:75], v[24:27]
    v_mfma_f32_16x16x32_bf16 v[28:31], a[84:87], v[72:75], v[28:31]
    buffer_load_dwordx4 v[72:75], v0, s[8:11], s44 offen offset:2048 sc1
    s_waitcnt vmcnt(19)
    v_mfma_f32_16x16x32_bf16 v[24:27], a[88:91], v[76:79], v[24:27]
    v_mfma_f32_16x16x32_bf16 v[28:31], a[92:95], v[76:79], v[28:31]
    buffer_load_dwordx4 v[76:79], v0, s[8:11], s44 offen offset:3072 sc1
    s_waitcnt vmcnt(19)
    v_mfma_f32_16x16x32_bf16 v[24:27], a[96:99], v[80:83], v[24:27]
    v_mfma_f32_16x16x32_bf16 v[28:31], a[100:103], v[80:83], v[28:31]
    s_waitcnt vmcnt(18)
    v_mfma_f32_16x16x32_bf16 v[24:27], a[104:107], v[84:87], v[24:27]
    v_mfma_f32_16x16x32_bf16 v[28:31], a[108:111], v[84:87], v[28:31]
    s_waitcnt vmcnt(17)
    v_mfma_f32_16x16x32_bf16 v[24:27], a[112:115], v[88:91], v[24:27]
    v_mfma_f32_16x16x32_bf16 v[28:31], a[116:119], v[88:91], v[28:31]
    s_waitcnt vmcnt(16)
    v_mfma_f32_16x16x32_bf16 v[24:27], a[120:123], v[92:95], v[24:27]
    v_mfma_f32_16x16x32_bf16 v[28:31], a[124:127], v[92:95], v[28:31]
    s_waitcnt vmcnt(15)
    v_mfma_f32_16x16x32_bf16 v[24:27], a[128:131], v[96:99], v[24:27]
    v_mfma_f32_16x16x32_bf16 v[28:31], a[132:135], v[96:99], v[28:31]
    s_waitcnt vmcnt(14)
    v_mfma_f32_16x16x32_bf16 v[24:27], a[136:139], v[100:103], v[24:27]
    v_mfma_f32_16x16x32_bf16 v[28:31], a[140:143], v[100:103], v[28:31]
    s_waitcnt vmcnt(13)
    v_mfma_f32_16x16x32_bf16 v[24:27], a[144:147], v[104:107], v[24:27]
    v_mfma_f32_16x16x32_bf16 v[28:31], a[148:151], v[104:107], v[28:31]
    s_waitcnt vmcnt(12)
    v_mfma_f32_16x16x32_bf16 v[24:27], a[152:155], v[108:111], v[24:27]
    v_mfma_f32_16x16x32_bf16 v[28:31], a[156:159], v[108:111], v[28:31]
    s_waitcnt vmcnt(11)
    v_mfma_f32_16x16x32_bf16 v[24:27], a[160:163], v[32:35], v[24:27]
    v_mfma_f32_16x16x32_bf16 v[28:31], a[164:167], v[32:35], v[28:31]
    s_waitcnt vmcnt(10)
    v_mfma_f32_16x16x32_bf16 v[24:27], a[168:171], v[36:39], v[24:27]
    v_mfma_f32_16x16x32_bf16 v[28:31], a[172:175], v[36:39], v[28:31]
    s_waitcnt vmcnt(9)
    v_mfma_f32_16x16x32_bf16 v[24:27], a[176:179], v[40:43], v[24:27]
    v_mfma_f32_16x16x32_bf16 v[28:31], a[180:183], v[40:43], v[28:31]
    s_waitcnt vmcnt(8)
    v_mfma_f32_16x16x32_bf16 v[24:27], a[184:187], v[44:47], v[24:27]
    v_mfma_f32_16x16x32_bf16 v[28:31], a[188:191], v[44:47], v[28:31]
    s_waitcnt vmcnt(7)
    v_mfma_f32_16x16x32_bf16 v[24:27], a[192:195], v[48:51], v[24:27]
    v_mfma_f32_16x16x32_bf16 v[28:31], a[196:199], v[48:51], v[28:31]
    s_waitcnt vmcnt(6)
    v_mfma_f32_16x16x32_bf16 v[24:27], a[200:203], v[52:55], v[24:27]
    v_mfma_f32_16x16x32_bf16 v[28:31], a[204:207], v[52:55], v[28:31]
    s_waitcnt vmcnt(5)
    v_mfma_f32_16x16x32_bf16 v[24:27], a[208:211], v[56:59], v[24:27]
    v_mfma_f32_16x16x32_bf16 v[28:31], a[212:215], v[56:59], v[28:31]
    s_waitcnt vmcnt(4)
    v_mfma_f32_16x16x32_bf16 v[24:27], a[216:219], v[60:63], v[24:27]
    v_mfma_f32_16x16x32_bf16 v[28:31], a[220:223], v[60:63], v[28:31]
    s_waitcnt vmcnt(3)
    v_mfma_f32_16x16x32_bf16 v[24:27], a[224:227], v[64:67], v[24:27]
    v_mfma_f32_16x16x32_bf16 v[28:31], a[228:231], v[64:67], v[28:31]
    s_waitcnt vmcnt(2)
    v_mfma_f32_16x16x32_bf16 v[24:27], a[232:235], v[68:71], v[24:27]
    v_mfma_f32_16x16x32_bf16 v[28:31], a[236:239], v[68:71], v[28:31]
    s_waitcnt vmcnt(1)
    v_mfma_f32_16x16x32_bf16 v[24:27], a[240:243], v[72:75], v[24:27]
    v_mfma_f32_16x16x32_bf16 v[28:31], a[244:247], v[72:75], v[28:31]
    s_waitcnt vmcnt(0)
    v_mfma_f32_16x16x32_bf16 v[24:27], a[248:251], v[76:79], v[24:27]
    v_mfma_f32_16x16x32_bf16 v[28:31], a[252:255], v[76:79], v[28:31]
    s_nop 6
    ds_write_b128 v14, v[24:27] offset:8192
    ds_write_b128 v14, v[28:31] offset:9216
    s_waitcnt lgkmcnt(0)
    s_barrier
    ds_read_b32 v24, v15 offset:8192
    ds_read_b32 v25, v15 offset:9216
    ds_read_b32 v26, v15 offset:10240
    ds_read_b32 v27, v15 offset:11264
    ds_read_b32 v28, v15 offset:12288
    ds_read_b32 v29, v15 offset:13312
    ds_read_b32 v30, v15 offset:14336
    ds_read_b32 v31, v15 offset:15360
    s_waitcnt lgkmcnt(4)
    v_pk_add_f32 v[24:25], v[24:25], v[26:27]
    s_waitcnt lgkmcnt(0)
    v_pk_add_f32 v[28:29], v[28:29], v[30:31]
    v_pk_add_f32 v[24:25], v[24:25], v[28:29]
    v_cvt_pk_bf16_f32 v30, v24, v25
    v_lshlrev_b32 v20, 16, v30
    v_and_b32 v21, 0xffff0000, v30
    v_mul_f32 v20, v18, v20
    v_mul_f32 v21, v18, v21
    v_cvt_pk_bf16_f32 v30, v20, v21
    v_lshlrev_b32 v20, 16, v30
    v_and_b32 v21, 0xffff0000, v30
    v_pk_add_f32 v[20:21], v[20:21], v[22:23]
    v_cvt_pk_bf16_f32 v20, v20, v21
    s_lshl_b32 s44, s65, 14
    buffer_store_dword v20, v3, s[28:31], s44 offen
    s_xor_b32 s73, s73, 0x20000
    s_add_u32 s65, s65, 12
    s_add_u32 s66, s66, 1
    s_cmp_lt_u32 s65, 128
    s_cbranch_scc1 P2_loop
    s_waitcnt vmcnt(0)
    s_endpgm
L_fail:
    s_mov_b64 exec, 1
    v_mov_b32 v1, 64
    v_mov_b32 v2, 1
    buffer_atomic_add v2, v1, s[12:15], 0 offen
    s_waitcnt vmcnt(0)
L_exit:
    s_endpgm
.section .rodata,"a"
.p2align 6
.amdhsa_kernel gated_mix__memory_aug_recurrent_mem_tr__swiglu_ffn__prompt_kernel
  .amdhsa_next_free_vgpr 512
  .amdhsa_next_free_sgpr 100
  .amdhsa_accum_offset 256
  .amdhsa_group_segment_fixed_size 0
  .amdhsa_kernarg_size 120
  .amdhsa_user_sgpr_count 2
  .amdhsa_user_sgpr_kernarg_segment_ptr 1
  .amdhsa_system_sgpr_workgroup_id_x 1
  .amdhsa_float_denorm_mode_32 3
.end_amdhsa_kernel
```
